```python
import torch

def _softmax(x, axis=-1):
    return torch.softmax(x, dim=axis)

def _gelu(x):
    return torch.nn.functional.gelu(x, approximate='tanh')

def _silu(x):
    return torch.nn.functional.silu(x)

def _sigmoid(x):
    return torch.sigmoid(x)

def _layernorm(x, axis=-1, eps=1e-05):
    m = x.mean(dim=axis, keepdim=True)
    v = x.var(dim=axis, keepdim=True, unbiased=False)
    return (x - m) / torch.sqrt(v + eps)

def _scatter_add(tgt, idx, src, axis=0):
    return tgt.clone().index_add_(axis, idx, src)

def _segment_sum(src, seg, n):
    out = torch.zeros((n,) + src.shape[1:], dtype=src.dtype)
    return out.index_add_(0, seg, src)

def _pad(x, pw):
    flat = tuple((v for pair in reversed(pw) for v in pair))
    return torch.nn.functional.pad(x, flat)
kernel_name = 'adaLN_cond__gqa_block_cached__glu_gated_bilinear__decode'

def setup_inputs():

    _w = lambda a: (lambda t: t.to(torch.bfloat16) if t.is_floating_point() else t)(torch.as_tensor(a))

    def _A_setup():
        B, Sq, D = (2, 1, 512)
        Hq, Hkv, Sk, Dh = (32, 8, 32768, 128)
        assert Hq % Hkv == 0, (Hq, Hkv)
        return {'x': _w((lambda *s: torch.randn(*s, dtype=torch.bfloat16) * 0.1)(B, Sq, D)), 'k_cache': _w((lambda *s: torch.randn(*s, dtype=torch.bfloat16) * 0.8)(B, Hkv, Sk, Dh)), 'v_cache': _w((lambda *s: torch.randn(*s, dtype=torch.bfloat16) * 12.8)(B, Hkv, Sk, Dh)), 'wq': _w((lambda *s: torch.randn(*s, dtype=torch.bfloat16) * 0.8)(D, Hq * Dh) * D ** (-0.5)), 'wo': _w((lambda *s: torch.randn(*s, dtype=torch.bfloat16) * 12.8)(Hq * Dh, D) * (Hq * Dh) ** (-0.5))}
    _A_in = _A_setup()

    def _B_setup():
        B, S, D, F = (2, 1, 512, 1792)
        return {'x': _w((lambda *s: torch.randn(*s, dtype=torch.bfloat16) * 0.1)(B, S, D)), 'w_gate': _w((lambda *s: torch.randn(*s, dtype=torch.bfloat16) * 12.8)(D, F) * D ** (-0.5)), 'w_up': _w((lambda *s: torch.randn(*s, dtype=torch.bfloat16) * 12.8)(D, F) * D ** (-0.5)), 'w_down': _w((lambda *s: torch.randn(*s, dtype=torch.bfloat16) * 12.8)(F, D) * F ** (-0.5))}
    _B_in = _B_setup()
    return {'A_x': _A_in['x'], 'A_k_cache': _A_in['k_cache'], 'A_v_cache': _A_in['v_cache'], 'A_wq': _A_in['wq'], 'A_wo': _A_in['wo'], 'B_x': _B_in['x'], 'B_w_gate': _B_in['w_gate'], 'B_w_up': _B_in['w_up'], 'B_w_down': _B_in['w_down'], 'c': _w((lambda *s: torch.randn(*s, dtype=torch.bfloat16) * 0.2)(2, 512) * 8.0), 'w_mod': _w((lambda *s: torch.randn(*s, dtype=torch.bfloat16) * 0.2)(512, 6 * 512) * 512 ** (-0.5) * 8.0)}

def reference(A_x, A_k_cache, A_v_cache, A_wq, A_wo, B_x, B_w_gate, B_w_up, B_w_down, c, w_mod):

    def _A_ref(x, k_cache, v_cache, wq, wo):
        B, Sq, D = x.shape
        Hq, Dh = (32, 128)
        Hkv = k_cache.shape[1]
        rep = Hq // Hkv
        q = (lambda x, *d: x.permute(*d))((x @ wq).reshape(B, Sq, Hq, Dh), 0, 2, 1, 3)
        k = (lambda x, n, axis: torch.repeat_interleave(x, n, dim=axis))(k_cache, rep, axis=1)
        v = (lambda x, n, axis: torch.repeat_interleave(x, n, dim=axis))(v_cache, rep, axis=1)
        scores = torch.einsum('bhqd,bhkd->bhqk', q, k) * Dh ** (-0.5)
        p = _softmax(scores, axis=-1)
        o = torch.einsum('bhqk,bhkd->bhqd', p, v)
        return (lambda x, *d: x.permute(*d))(o, 0, 2, 1, 3).reshape(B, Sq, Hq * Dh) @ wo

    def _B_ref(x, w_gate, w_up, w_down):
        g = torch.einsum('bsd,df->bsf', x, w_gate)
        u = torch.einsum('bsd,df->bsf', x, w_up)
        h = g * u
        return torch.einsum('bsf,fd->bsd', h, w_down)
    x = A_x
    mod = (_silu(c) @ w_mod).reshape(c.shape[0], 6, 1, -1)
    sa, ca, ga, sb, cb, gb = (mod[:, 0].clone(), mod[:, 1].clone(), mod[:, 2].clone(), mod[:, 3].clone(), mod[:, 4].clone(), mod[:, 5].clone())
    h = _layernorm(x, axis=-1) * (1 + ca) + sa
    x = x + ga * _A_ref(h, A_k_cache, A_v_cache, A_wq, A_wo)
    h = _layernorm(x, axis=-1) * (1 + cb) + sb
    x = x + gb * _B_ref(h, B_w_gate, B_w_up, B_w_down)
    return x
```

```asm
; @launch kernel=k0_mod_kernel grid=(96,1,1) block=(256,1,1) lds=21504
; @launch kernel=k1_q_kernel grid=(128,1,1) block=(256,1,1) lds=21504
; @launch kernel=k2_attn_kernel grid=(512,1,1) block=(256,1,1) lds=33280
; @launch kernel=k3_wo_kernel grid=(64,1,1) block=(512,1,1) lds=36864
; @launch kernel=k4_gu_kernel grid=(112,1,1) block=(256,1,1) lds=41024
; @launch kernel=k5_dn_kernel grid=(56,1,1) block=(256,1,1) lds=20480
.amdgcn_target "amdgcn-amd-amdhsa--gfx950"
.text
.globl k0_mod_kernel
.p2align 8
.type k0_mod_kernel,@function
k0_mod_kernel:
    s_cmp_ge_u32 s2, 96
    s_cbranch_scc1 k0_mod_kernel_end
    s_load_dwordx2 s[8:9], s[0:1], 72
    s_load_dwordx2 s[12:13], s[0:1], 80
    s_load_dwordx2 s[16:17], s[0:1], 104
    s_waitcnt lgkmcnt(0)
    s_mov_b32 s10, 2048
    s_mov_b32 s11, 0x00020000
    s_mov_b32 s14, 3145728
    s_mov_b32 s15, 0x00020000
    s_mov_b32 s18, 536870912
    s_mov_b32 s19, 0x00020000
    s_cmp_ge_u32 s2, 36
    s_cbranch_scc1 k0_mod_kernel_nozero
    s_lshl_b32 s21, s2, 10
    v_lshlrev_b32 v3, 2, v0
    v_add_u32 v3, s21, v3
    v_mov_b32 v6, 0
    s_mov_b32 s22, 65536
    buffer_store_dword v6, v3, s[16:19], s22 offen
k0_mod_kernel_nozero:
    v_lshlrev_b32 v2, 3, v0
    buffer_load_dwordx2 v[4:5], v2, s[8:11], 0 offen
    v_lshrrev_b32 v1, 2, v0
    s_mov_b32 s20, 6144
    v_mul_lo_u32 v1, v1, s20
    v_and_b32 v2, 3, v0
    v_lshl_add_u32 v1, v2, 4, v1
    s_lshl_b32 s21, s2, 6
    v_add_u32 v1, s21, v1
    s_mov_b32 s20, 0
    buffer_load_dwordx4 v[32:35], v1, s[12:15], s20 offen
    s_mov_b32 s20, 393216
    buffer_load_dwordx4 v[36:39], v1, s[12:15], s20 offen
    s_mov_b32 s20, 786432
    buffer_load_dwordx4 v[40:43], v1, s[12:15], s20 offen
    s_mov_b32 s20, 1179648
    buffer_load_dwordx4 v[44:47], v1, s[12:15], s20 offen
    s_mov_b32 s20, 1572864
    buffer_load_dwordx4 v[48:51], v1, s[12:15], s20 offen
    s_mov_b32 s20, 1966080
    buffer_load_dwordx4 v[52:55], v1, s[12:15], s20 offen
    s_mov_b32 s20, 2359296
    buffer_load_dwordx4 v[56:59], v1, s[12:15], s20 offen
    s_mov_b32 s20, 2752512
    buffer_load_dwordx4 v[60:63], v1, s[12:15], s20 offen
    s_waitcnt vmcnt(8)
    v_and_b32 v9, 0xffff0000, v4
    v_lshlrev_b32 v8, 16, v4
    v_and_b32 v11, 0xffff0000, v5
    v_lshlrev_b32 v10, 16, v5
    v_mul_f32 v12, 0xbfb8aa3b, v8
    v_exp_f32 v12, v12
    s_nop 0
    v_add_f32 v12, 1.0, v12
    v_rcp_f32 v12, v12
    s_nop 0
    v_mul_f32 v8, v8, v12
    v_cvt_pk_bf16_f32 v8, v8, v8
    v_lshlrev_b32 v8, 16, v8
    v_mul_f32 v12, 0xbfb8aa3b, v9
    v_exp_f32 v12, v12
    s_nop 0
    v_add_f32 v12, 1.0, v12
    v_rcp_f32 v12, v12
    s_nop 0
    v_mul_f32 v9, v9, v12
    v_cvt_pk_bf16_f32 v9, v9, v9
    v_lshlrev_b32 v9, 16, v9
    v_mul_f32 v12, 0xbfb8aa3b, v10
    v_exp_f32 v12, v12
    s_nop 0
    v_add_f32 v12, 1.0, v12
    v_rcp_f32 v12, v12
    s_nop 0
    v_mul_f32 v10, v10, v12
    v_cvt_pk_bf16_f32 v10, v10, v10
    v_lshlrev_b32 v10, 16, v10
    v_mul_f32 v12, 0xbfb8aa3b, v11
    v_exp_f32 v12, v12
    s_nop 0
    v_add_f32 v12, 1.0, v12
    v_rcp_f32 v12, v12
    s_nop 0
    v_mul_f32 v11, v11, v12
    v_cvt_pk_bf16_f32 v11, v11, v11
    v_lshlrev_b32 v11, 16, v11
    v_lshlrev_b32 v2, 4, v0
    ds_write_b128 v2, v[8:11]
    s_waitcnt lgkmcnt(0)
    s_barrier
    v_lshrrev_b32 v2, 2, v0
    v_lshlrev_b32 v2, 2, v2
    ds_read_b32 v80, v2 offset:0
    ds_read_b32 v81, v2 offset:256
    ds_read_b32 v82, v2 offset:512
    ds_read_b32 v83, v2 offset:768
    ds_read_b32 v84, v2 offset:1024
    ds_read_b32 v85, v2 offset:1280
    ds_read_b32 v86, v2 offset:1536
    ds_read_b32 v87, v2 offset:1792
    ds_read_b32 v88, v2 offset:2048
    ds_read_b32 v89, v2 offset:2304
    ds_read_b32 v90, v2 offset:2560
    ds_read_b32 v91, v2 offset:2816
    ds_read_b32 v92, v2 offset:3072
    ds_read_b32 v93, v2 offset:3328
    ds_read_b32 v94, v2 offset:3584
    ds_read_b32 v95, v2 offset:3840
    v_mov_b32 v64, 0
    v_mov_b32 v65, 0
    v_mov_b32 v66, 0
    v_mov_b32 v67, 0
    v_mov_b32 v68, 0
    v_mov_b32 v69, 0
    v_mov_b32 v70, 0
    v_mov_b32 v71, 0
    v_mov_b32 v72, 0
    v_mov_b32 v73, 0
    v_mov_b32 v74, 0
    v_mov_b32 v75, 0
    v_mov_b32 v76, 0
    v_mov_b32 v77, 0
    v_mov_b32 v78, 0
    v_mov_b32 v79, 0
    s_waitcnt vmcnt(0) lgkmcnt(0)
    v_lshlrev_b32 v12, 16, v32
    v_and_b32 v13, 0xffff0000, v32
    v_fmac_f32 v64, v12, v80
    v_fmac_f32 v65, v13, v80
    v_fmac_f32 v72, v12, v88
    v_fmac_f32 v73, v13, v88
    v_lshlrev_b32 v12, 16, v33
    v_and_b32 v13, 0xffff0000, v33
    v_fmac_f32 v66, v12, v80
    v_fmac_f32 v67, v13, v80
    v_fmac_f32 v74, v12, v88
    v_fmac_f32 v75, v13, v88
    v_lshlrev_b32 v12, 16, v34
    v_and_b32 v13, 0xffff0000, v34
    v_fmac_f32 v68, v12, v80
    v_fmac_f32 v69, v13, v80
    v_fmac_f32 v76, v12, v88
    v_fmac_f32 v77, v13, v88
    v_lshlrev_b32 v12, 16, v35
    v_and_b32 v13, 0xffff0000, v35
    v_fmac_f32 v70, v12, v80
    v_fmac_f32 v71, v13, v80
    v_fmac_f32 v78, v12, v88
    v_fmac_f32 v79, v13, v88
    v_lshlrev_b32 v12, 16, v36
    v_and_b32 v13, 0xffff0000, v36
    v_fmac_f32 v64, v12, v81
    v_fmac_f32 v65, v13, v81
    v_fmac_f32 v72, v12, v89
    v_fmac_f32 v73, v13, v89
    v_lshlrev_b32 v12, 16, v37
    v_and_b32 v13, 0xffff0000, v37
    v_fmac_f32 v66, v12, v81
    v_fmac_f32 v67, v13, v81
    v_fmac_f32 v74, v12, v89
    v_fmac_f32 v75, v13, v89
    v_lshlrev_b32 v12, 16, v38
    v_and_b32 v13, 0xffff0000, v38
    v_fmac_f32 v68, v12, v81
    v_fmac_f32 v69, v13, v81
    v_fmac_f32 v76, v12, v89
    v_fmac_f32 v77, v13, v89
    v_lshlrev_b32 v12, 16, v39
    v_and_b32 v13, 0xffff0000, v39
    v_fmac_f32 v70, v12, v81
    v_fmac_f32 v71, v13, v81
    v_fmac_f32 v78, v12, v89
    v_fmac_f32 v79, v13, v89
    v_lshlrev_b32 v12, 16, v40
    v_and_b32 v13, 0xffff0000, v40
    v_fmac_f32 v64, v12, v82
    v_fmac_f32 v65, v13, v82
    v_fmac_f32 v72, v12, v90
    v_fmac_f32 v73, v13, v90
    v_lshlrev_b32 v12, 16, v41
    v_and_b32 v13, 0xffff0000, v41
    v_fmac_f32 v66, v12, v82
    v_fmac_f32 v67, v13, v82
    v_fmac_f32 v74, v12, v90
    v_fmac_f32 v75, v13, v90
    v_lshlrev_b32 v12, 16, v42
    v_and_b32 v13, 0xffff0000, v42
    v_fmac_f32 v68, v12, v82
    v_fmac_f32 v69, v13, v82
    v_fmac_f32 v76, v12, v90
    v_fmac_f32 v77, v13, v90
    v_lshlrev_b32 v12, 16, v43
    v_and_b32 v13, 0xffff0000, v43
    v_fmac_f32 v70, v12, v82
    v_fmac_f32 v71, v13, v82
    v_fmac_f32 v78, v12, v90
    v_fmac_f32 v79, v13, v90
    v_lshlrev_b32 v12, 16, v44
    v_and_b32 v13, 0xffff0000, v44
    v_fmac_f32 v64, v12, v83
    v_fmac_f32 v65, v13, v83
    v_fmac_f32 v72, v12, v91
    v_fmac_f32 v73, v13, v91
    v_lshlrev_b32 v12, 16, v45
    v_and_b32 v13, 0xffff0000, v45
    v_fmac_f32 v66, v12, v83
    v_fmac_f32 v67, v13, v83
    v_fmac_f32 v74, v12, v91
    v_fmac_f32 v75, v13, v91
    v_lshlrev_b32 v12, 16, v46
    v_and_b32 v13, 0xffff0000, v46
    v_fmac_f32 v68, v12, v83
    v_fmac_f32 v69, v13, v83
    v_fmac_f32 v76, v12, v91
    v_fmac_f32 v77, v13, v91
    v_lshlrev_b32 v12, 16, v47
    v_and_b32 v13, 0xffff0000, v47
    v_fmac_f32 v70, v12, v83
    v_fmac_f32 v71, v13, v83
    v_fmac_f32 v78, v12, v91
    v_fmac_f32 v79, v13, v91
    v_lshlrev_b32 v12, 16, v48
    v_and_b32 v13, 0xffff0000, v48
    v_fmac_f32 v64, v12, v84
    v_fmac_f32 v65, v13, v84
    v_fmac_f32 v72, v12, v92
    v_fmac_f32 v73, v13, v92
    v_lshlrev_b32 v12, 16, v49
    v_and_b32 v13, 0xffff0000, v49
    v_fmac_f32 v66, v12, v84
    v_fmac_f32 v67, v13, v84
    v_fmac_f32 v74, v12, v92
    v_fmac_f32 v75, v13, v92
    v_lshlrev_b32 v12, 16, v50
    v_and_b32 v13, 0xffff0000, v50
    v_fmac_f32 v68, v12, v84
    v_fmac_f32 v69, v13, v84
    v_fmac_f32 v76, v12, v92
    v_fmac_f32 v77, v13, v92
    v_lshlrev_b32 v12, 16, v51
    v_and_b32 v13, 0xffff0000, v51
    v_fmac_f32 v70, v12, v84
    v_fmac_f32 v71, v13, v84
    v_fmac_f32 v78, v12, v92
    v_fmac_f32 v79, v13, v92
    v_lshlrev_b32 v12, 16, v52
    v_and_b32 v13, 0xffff0000, v52
    v_fmac_f32 v64, v12, v85
    v_fmac_f32 v65, v13, v85
    v_fmac_f32 v72, v12, v93
    v_fmac_f32 v73, v13, v93
    v_lshlrev_b32 v12, 16, v53
    v_and_b32 v13, 0xffff0000, v53
    v_fmac_f32 v66, v12, v85
    v_fmac_f32 v67, v13, v85
    v_fmac_f32 v74, v12, v93
    v_fmac_f32 v75, v13, v93
    v_lshlrev_b32 v12, 16, v54
    v_and_b32 v13, 0xffff0000, v54
    v_fmac_f32 v68, v12, v85
    v_fmac_f32 v69, v13, v85
    v_fmac_f32 v76, v12, v93
    v_fmac_f32 v77, v13, v93
    v_lshlrev_b32 v12, 16, v55
    v_and_b32 v13, 0xffff0000, v55
    v_fmac_f32 v70, v12, v85
    v_fmac_f32 v71, v13, v85
    v_fmac_f32 v78, v12, v93
    v_fmac_f32 v79, v13, v93
    v_lshlrev_b32 v12, 16, v56
    v_and_b32 v13, 0xffff0000, v56
    v_fmac_f32 v64, v12, v86
    v_fmac_f32 v65, v13, v86
    v_fmac_f32 v72, v12, v94
    v_fmac_f32 v73, v13, v94
    v_lshlrev_b32 v12, 16, v57
    v_and_b32 v13, 0xffff0000, v57
    v_fmac_f32 v66, v12, v86
    v_fmac_f32 v67, v13, v86
    v_fmac_f32 v74, v12, v94
    v_fmac_f32 v75, v13, v94
    v_lshlrev_b32 v12, 16, v58
    v_and_b32 v13, 0xffff0000, v58
    v_fmac_f32 v68, v12, v86
    v_fmac_f32 v69, v13, v86
    v_fmac_f32 v76, v12, v94
    v_fmac_f32 v77, v13, v94
    v_lshlrev_b32 v12, 16, v59
    v_and_b32 v13, 0xffff0000, v59
    v_fmac_f32 v70, v12, v86
    v_fmac_f32 v71, v13, v86
    v_fmac_f32 v78, v12, v94
    v_fmac_f32 v79, v13, v94
    v_lshlrev_b32 v12, 16, v60
    v_and_b32 v13, 0xffff0000, v60
    v_fmac_f32 v64, v12, v87
    v_fmac_f32 v65, v13, v87
    v_fmac_f32 v72, v12, v95
    v_fmac_f32 v73, v13, v95
    v_lshlrev_b32 v12, 16, v61
    v_and_b32 v13, 0xffff0000, v61
    v_fmac_f32 v66, v12, v87
    v_fmac_f32 v67, v13, v87
    v_fmac_f32 v74, v12, v95
    v_fmac_f32 v75, v13, v95
    v_lshlrev_b32 v12, 16, v62
    v_and_b32 v13, 0xffff0000, v62
    v_fmac_f32 v68, v12, v87
    v_fmac_f32 v69, v13, v87
    v_fmac_f32 v76, v12, v95
    v_fmac_f32 v77, v13, v95
    v_lshlrev_b32 v12, 16, v63
    v_and_b32 v13, 0xffff0000, v63
    v_fmac_f32 v70, v12, v87
    v_fmac_f32 v71, v13, v87
    v_fmac_f32 v78, v12, v95
    v_fmac_f32 v79, v13, v95
    v_lshlrev_b32 v2, 6, v0
    ds_write_b128 v2, v[64:67] offset:4096
    ds_write_b128 v2, v[68:71] offset:4112
    ds_write_b128 v2, v[72:75] offset:4128
    ds_write_b128 v2, v[76:79] offset:4144
    s_waitcnt lgkmcnt(0)
    s_barrier
    v_and_b32 v2, 63, v0
    v_lshrrev_b32 v3, 5, v2
    v_lshlrev_b32 v3, 5, v3
    v_and_b32 v4, 7, v2
    v_lshl_add_u32 v3, v4, 2, v3
    v_bfe_u32 v4, v2, 3, 2
    v_lshl_add_u32 v3, v4, 6, v3
    v_lshrrev_b32 v4, 6, v0
    v_lshl_add_u32 v3, v4, 12, v3
    ds_read_b32 v32, v3 offset:4096
    ds_read_b32 v33, v3 offset:4352
    ds_read_b32 v34, v3 offset:4608
    ds_read_b32 v35, v3 offset:4864
    ds_read_b32 v36, v3 offset:5120
    ds_read_b32 v37, v3 offset:5376
    ds_read_b32 v38, v3 offset:5632
    ds_read_b32 v39, v3 offset:5888
    ds_read_b32 v40, v3 offset:6144
    ds_read_b32 v41, v3 offset:6400
    ds_read_b32 v42, v3 offset:6656
    ds_read_b32 v43, v3 offset:6912
    ds_read_b32 v44, v3 offset:7168
    ds_read_b32 v45, v3 offset:7424
    ds_read_b32 v46, v3 offset:7680
    ds_read_b32 v47, v3 offset:7936
    s_waitcnt lgkmcnt(0)
    v_add_f32 v32, v32, v33
    v_add_f32 v32, v32, v34
    v_add_f32 v32, v32, v35
    v_add_f32 v32, v32, v36
    v_add_f32 v32, v32, v37
    v_add_f32 v32, v32, v38
    v_add_f32 v32, v32, v39
    v_add_f32 v32, v32, v40
    v_add_f32 v32, v32, v41
    v_add_f32 v32, v32, v42
    v_add_f32 v32, v32, v43
    v_add_f32 v32, v32, v44
    v_add_f32 v32, v32, v45
    v_add_f32 v32, v32, v46
    v_add_f32 v32, v32, v47
    v_lshlrev_b32 v3, 2, v0
    ds_write_b32 v3, v32 offset:0
    s_waitcnt lgkmcnt(0)
    s_barrier
    v_cmp_gt_u32 vcc, 64, v0
    s_and_saveexec_b64 s[24:25], vcc
    s_cbranch_execz k0_mod_kernel_end
    ds_read_b32 v32, v3 offset:0
    ds_read_b32 v33, v3 offset:256
    ds_read_b32 v34, v3 offset:512
    ds_read_b32 v35, v3 offset:768
    s_waitcnt lgkmcnt(0)
    v_add_f32 v32, v32, v33
    v_add_f32 v34, v34, v35
    v_add_f32 v32, v32, v34
    v_lshrrev_b32 v4, 5, v0
    v_and_b32 v5, 31, v0
    s_lshl_b32 s21, s2, 5
    v_add_u32 v5, s21, v5
    v_cvt_pk_bf16_f32 v32, v32, v32
    v_lshlrev_b32 v32, 16, v32
    v_mul_u32_u24 v4, 3072, v4
    v_add_lshl_u32 v5, v4, v5, 2
    buffer_store_dword v32, v5, s[16:19], 0 offen offset:0
k0_mod_kernel_end:
    s_endpgm
.globl k1_q_kernel
.p2align 8
.type k1_q_kernel,@function
k1_q_kernel:
    s_cmp_ge_u32 s2, 128
    s_cbranch_scc1 k1_q_kernel_end
    s_load_dwordx2 s[8:9], s[0:1], 0
    s_load_dwordx2 s[12:13], s[0:1], 24
    s_load_dwordx2 s[16:17], s[0:1], 104
    s_waitcnt lgkmcnt(0)
    s_mov_b32 s10, 2048
    s_mov_b32 s11, 0x00020000
    s_mov_b32 s14, 4194304
    s_mov_b32 s15, 0x00020000
    s_mov_b32 s18, 536870912
    s_mov_b32 s19, 0x00020000
    v_lshlrev_b32 v2, 3, v0
    buffer_load_dwordx2 v[4:5], v2, s[8:11], 0 offen
    v_lshrrev_b32 v1, 2, v0
    s_mov_b32 s20, 8192
    v_mul_lo_u32 v1, v1, s20
    v_and_b32 v2, 3, v0
    v_lshl_add_u32 v1, v2, 4, v1
    s_lshl_b32 s21, s2, 6
    v_add_u32 v1, s21, v1
    s_mov_b32 s20, 0
    buffer_load_dwordx4 v[32:35], v1, s[12:15], s20 offen
    s_mov_b32 s20, 524288
    buffer_load_dwordx4 v[36:39], v1, s[12:15], s20 offen
    s_mov_b32 s20, 1048576
    buffer_load_dwordx4 v[40:43], v1, s[12:15], s20 offen
    s_mov_b32 s20, 1572864
    buffer_load_dwordx4 v[44:47], v1, s[12:15], s20 offen
    s_mov_b32 s20, 2097152
    buffer_load_dwordx4 v[48:51], v1, s[12:15], s20 offen
    s_mov_b32 s20, 2621440
    buffer_load_dwordx4 v[52:55], v1, s[12:15], s20 offen
    s_mov_b32 s20, 3145728
    buffer_load_dwordx4 v[56:59], v1, s[12:15], s20 offen
    s_mov_b32 s20, 3670016
    buffer_load_dwordx4 v[60:63], v1, s[12:15], s20 offen
    s_waitcnt vmcnt(8)
    v_and_b32 v9, 0xffff0000, v4
    v_lshlrev_b32 v8, 16, v4
    v_and_b32 v11, 0xffff0000, v5
    v_lshlrev_b32 v10, 16, v5
    v_lshrrev_b32 v12, 7, v0
    v_mul_u32_u24 v12, 12288, v12
    v_and_b32 v13, 127, v0
    v_lshl_add_u32 v12, v13, 4, v12
    s_mov_b32 s42, 0
    s_mov_b32 s43, 2048
    buffer_load_dwordx4 v[16:19], v12, s[16:19], s42 offen
    buffer_load_dwordx4 v[20:23], v12, s[16:19], s43 offen
    v_add_f32 v12, v8, v9
    v_add_f32 v13, v10, v11
    v_add_f32 v12, v12, v13
    s_nop 1
    v_add_f32_dpp v12, v12, v12 quad_perm:[1,0,3,2] row_mask:0xf bank_mask:0xf
    s_nop 1
    v_add_f32_dpp v12, v12, v12 quad_perm:[2,3,0,1] row_mask:0xf bank_mask:0xf
    s_nop 1
    v_add_f32_dpp v12, v12, v12 row_half_mirror row_mask:0xf bank_mask:0xf
    s_nop 1
    v_add_f32_dpp v12, v12, v12 row_mirror row_mask:0xf bank_mask:0xf
    s_nop 1
    v_add_f32_dpp v12, v12, v12 row_bcast:15 row_mask:0xa bank_mask:0xf
    s_nop 1
    v_add_f32_dpp v12, v12, v12 row_bcast:31 row_mask:0xc bank_mask:0xf
    s_nop 1
    v_readlane_b32 s40, v12, 63
    v_lshrrev_b32 v13, 6, v0
    v_lshlrev_b32 v13, 2, v13
    v_mov_b32 v12, s40
    ds_write_b32 v13, v12 offset:20480
    s_waitcnt lgkmcnt(0)
    s_barrier
    v_lshrrev_b32 v13, 7, v0
    v_lshlrev_b32 v13, 3, v13
    ds_read_b64 v[14:15], v13 offset:20480
    s_waitcnt lgkmcnt(0)
    v_add_f32 v14, v14, v15
    v_mul_f32 v14, 0x3b000000, v14
    v_sub_f32 v15, v8, v14
    v_mul_f32 v12, v15, v15
    v_sub_f32 v15, v9, v14
    v_fmac_f32 v12, v15, v15
    v_sub_f32 v15, v10, v14
    v_fmac_f32 v12, v15, v15
    v_sub_f32 v15, v11, v14
    v_fmac_f32 v12, v15, v15
    s_nop 1
    v_add_f32_dpp v12, v12, v12 quad_perm:[1,0,3,2] row_mask:0xf bank_mask:0xf
    s_nop 1
    v_add_f32_dpp v12, v12, v12 quad_perm:[2,3,0,1] row_mask:0xf bank_mask:0xf
    s_nop 1
    v_add_f32_dpp v12, v12, v12 row_half_mirror row_mask:0xf bank_mask:0xf
    s_nop 1
    v_add_f32_dpp v12, v12, v12 row_mirror row_mask:0xf bank_mask:0xf
    s_nop 1
    v_add_f32_dpp v12, v12, v12 row_bcast:15 row_mask:0xa bank_mask:0xf
    s_nop 1
    v_add_f32_dpp v12, v12, v12 row_bcast:31 row_mask:0xc bank_mask:0xf
    s_nop 1
    v_readlane_b32 s41, v12, 63
    v_lshrrev_b32 v13, 6, v0
    v_lshlrev_b32 v13, 2, v13
    v_mov_b32 v12, s41
    ds_write_b32 v13, v12 offset:20496
    s_waitcnt lgkmcnt(0)
    s_barrier
    v_lshrrev_b32 v13, 7, v0
    v_lshlrev_b32 v13, 3, v13
    ds_read_b64 v[12:13], v13 offset:20496
    s_waitcnt lgkmcnt(0)
    v_add_f32 v12, v12, v13
    v_mul_f32 v12, 0x3b000000, v12
    v_cvt_pk_bf16_f32 v12, v12, v12
    v_lshlrev_b32 v12, 16, v12
    v_cvt_pk_bf16_f32 v14, v14, v14
    v_lshlrev_b32 v14, 16, v14
    v_add_f32 v12, 0x3727c5ac, v12
    v_cvt_pk_bf16_f32 v12, v12, v12
    v_lshlrev_b32 v12, 16, v12
    v_sqrt_f32 v12, v12
    s_nop 0
    v_cvt_pk_bf16_f32 v12, v12, v12
    v_lshlrev_b32 v12, 16, v12
    v_rcp_f32 v12, v12
    s_waitcnt vmcnt(0)
    v_sub_f32 v8, v8, v14
    v_cvt_pk_bf16_f32 v8, v8, v8
    v_lshlrev_b32 v8, 16, v8
    v_mul_f32 v8, v8, v12
    v_cvt_pk_bf16_f32 v8, v8, v8
    v_lshlrev_b32 v8, 16, v8
    v_add_f32 v20, 1.0, v20
    v_cvt_pk_bf16_f32 v20, v20, v20
    v_lshlrev_b32 v20, 16, v20
    v_mul_f32 v8, v8, v20
    v_cvt_pk_bf16_f32 v8, v8, v8
    v_lshlrev_b32 v8, 16, v8
    v_add_f32 v8, v8, v16
    v_cvt_pk_bf16_f32 v8, v8, v8
    v_lshlrev_b32 v8, 16, v8
    v_sub_f32 v9, v9, v14
    v_cvt_pk_bf16_f32 v9, v9, v9
    v_lshlrev_b32 v9, 16, v9
    v_mul_f32 v9, v9, v12
    v_cvt_pk_bf16_f32 v9, v9, v9
    v_lshlrev_b32 v9, 16, v9
    v_add_f32 v21, 1.0, v21
    v_cvt_pk_bf16_f32 v21, v21, v21
    v_lshlrev_b32 v21, 16, v21
    v_mul_f32 v9, v9, v21
    v_cvt_pk_bf16_f32 v9, v9, v9
    v_lshlrev_b32 v9, 16, v9
    v_add_f32 v9, v9, v17
    v_cvt_pk_bf16_f32 v9, v9, v9
    v_lshlrev_b32 v9, 16, v9
    v_sub_f32 v10, v10, v14
    v_cvt_pk_bf16_f32 v10, v10, v10
    v_lshlrev_b32 v10, 16, v10
    v_mul_f32 v10, v10, v12
    v_cvt_pk_bf16_f32 v10, v10, v10
    v_lshlrev_b32 v10, 16, v10
    v_add_f32 v22, 1.0, v22
    v_cvt_pk_bf16_f32 v22, v22, v22
    v_lshlrev_b32 v22, 16, v22
    v_mul_f32 v10, v10, v22
    v_cvt_pk_bf16_f32 v10, v10, v10
    v_lshlrev_b32 v10, 16, v10
    v_add_f32 v10, v10, v18
    v_cvt_pk_bf16_f32 v10, v10, v10
    v_lshlrev_b32 v10, 16, v10
    v_sub_f32 v11, v11, v14
    v_cvt_pk_bf16_f32 v11, v11, v11
    v_lshlrev_b32 v11, 16, v11
    v_mul_f32 v11, v11, v12
    v_cvt_pk_bf16_f32 v11, v11, v11
    v_lshlrev_b32 v11, 16, v11
    v_add_f32 v23, 1.0, v23
    v_cvt_pk_bf16_f32 v23, v23, v23
    v_lshlrev_b32 v23, 16, v23
    v_mul_f32 v11, v11, v23
    v_cvt_pk_bf16_f32 v11, v11, v11
    v_lshlrev_b32 v11, 16, v11
    v_add_f32 v11, v11, v19
    v_cvt_pk_bf16_f32 v11, v11, v11
    v_lshlrev_b32 v11, 16, v11
    v_lshlrev_b32 v2, 4, v0
    ds_write_b128 v2, v[8:11]
    s_waitcnt lgkmcnt(0)
    s_barrier
    v_lshrrev_b32 v2, 2, v0
    v_lshlrev_b32 v2, 2, v2
    ds_read_b32 v80, v2 offset:0
    ds_read_b32 v81, v2 offset:256
    ds_read_b32 v82, v2 offset:512
    ds_read_b32 v83, v2 offset:768
    ds_read_b32 v84, v2 offset:1024
    ds_read_b32 v85, v2 offset:1280
    ds_read_b32 v86, v2 offset:1536
    ds_read_b32 v87, v2 offset:1792
    ds_read_b32 v88, v2 offset:2048
    ds_read_b32 v89, v2 offset:2304
    ds_read_b32 v90, v2 offset:2560
    ds_read_b32 v91, v2 offset:2816
    ds_read_b32 v92, v2 offset:3072
    ds_read_b32 v93, v2 offset:3328
    ds_read_b32 v94, v2 offset:3584
    ds_read_b32 v95, v2 offset:3840
    v_mov_b32 v64, 0
    v_mov_b32 v65, 0
    v_mov_b32 v66, 0
    v_mov_b32 v67, 0
    v_mov_b32 v68, 0
    v_mov_b32 v69, 0
    v_mov_b32 v70, 0
    v_mov_b32 v71, 0
    v_mov_b32 v72, 0
    v_mov_b32 v73, 0
    v_mov_b32 v74, 0
    v_mov_b32 v75, 0
    v_mov_b32 v76, 0
    v_mov_b32 v77, 0
    v_mov_b32 v78, 0
    v_mov_b32 v79, 0
    s_waitcnt vmcnt(0) lgkmcnt(0)
    v_lshlrev_b32 v12, 16, v32
    v_and_b32 v13, 0xffff0000, v32
    v_fmac_f32 v64, v12, v80
    v_fmac_f32 v65, v13, v80
    v_fmac_f32 v72, v12, v88
    v_fmac_f32 v73, v13, v88
    v_lshlrev_b32 v12, 16, v33
    v_and_b32 v13, 0xffff0000, v33
    v_fmac_f32 v66, v12, v80
    v_fmac_f32 v67, v13, v80
    v_fmac_f32 v74, v12, v88
    v_fmac_f32 v75, v13, v88
    v_lshlrev_b32 v12, 16, v34
    v_and_b32 v13, 0xffff0000, v34
    v_fmac_f32 v68, v12, v80
    v_fmac_f32 v69, v13, v80
    v_fmac_f32 v76, v12, v88
    v_fmac_f32 v77, v13, v88
    v_lshlrev_b32 v12, 16, v35
    v_and_b32 v13, 0xffff0000, v35
    v_fmac_f32 v70, v12, v80
    v_fmac_f32 v71, v13, v80
    v_fmac_f32 v78, v12, v88
    v_fmac_f32 v79, v13, v88
    v_lshlrev_b32 v12, 16, v36
    v_and_b32 v13, 0xffff0000, v36
    v_fmac_f32 v64, v12, v81
    v_fmac_f32 v65, v13, v81
    v_fmac_f32 v72, v12, v89
    v_fmac_f32 v73, v13, v89
    v_lshlrev_b32 v12, 16, v37
    v_and_b32 v13, 0xffff0000, v37
    v_fmac_f32 v66, v12, v81
    v_fmac_f32 v67, v13, v81
    v_fmac_f32 v74, v12, v89
    v_fmac_f32 v75, v13, v89
    v_lshlrev_b32 v12, 16, v38
    v_and_b32 v13, 0xffff0000, v38
    v_fmac_f32 v68, v12, v81
    v_fmac_f32 v69, v13, v81
    v_fmac_f32 v76, v12, v89
    v_fmac_f32 v77, v13, v89
    v_lshlrev_b32 v12, 16, v39
    v_and_b32 v13, 0xffff0000, v39
    v_fmac_f32 v70, v12, v81
    v_fmac_f32 v71, v13, v81
    v_fmac_f32 v78, v12, v89
    v_fmac_f32 v79, v13, v89
    v_lshlrev_b32 v12, 16, v40
    v_and_b32 v13, 0xffff0000, v40
    v_fmac_f32 v64, v12, v82
    v_fmac_f32 v65, v13, v82
    v_fmac_f32 v72, v12, v90
    v_fmac_f32 v73, v13, v90
    v_lshlrev_b32 v12, 16, v41
    v_and_b32 v13, 0xffff0000, v41
    v_fmac_f32 v66, v12, v82
    v_fmac_f32 v67, v13, v82
    v_fmac_f32 v74, v12, v90
    v_fmac_f32 v75, v13, v90
    v_lshlrev_b32 v12, 16, v42
    v_and_b32 v13, 0xffff0000, v42
    v_fmac_f32 v68, v12, v82
    v_fmac_f32 v69, v13, v82
    v_fmac_f32 v76, v12, v90
    v_fmac_f32 v77, v13, v90
    v_lshlrev_b32 v12, 16, v43
    v_and_b32 v13, 0xffff0000, v43
    v_fmac_f32 v70, v12, v82
    v_fmac_f32 v71, v13, v82
    v_fmac_f32 v78, v12, v90
    v_fmac_f32 v79, v13, v90
    v_lshlrev_b32 v12, 16, v44
    v_and_b32 v13, 0xffff0000, v44
    v_fmac_f32 v64, v12, v83
    v_fmac_f32 v65, v13, v83
    v_fmac_f32 v72, v12, v91
    v_fmac_f32 v73, v13, v91
    v_lshlrev_b32 v12, 16, v45
    v_and_b32 v13, 0xffff0000, v45
    v_fmac_f32 v66, v12, v83
    v_fmac_f32 v67, v13, v83
    v_fmac_f32 v74, v12, v91
    v_fmac_f32 v75, v13, v91
    v_lshlrev_b32 v12, 16, v46
    v_and_b32 v13, 0xffff0000, v46
    v_fmac_f32 v68, v12, v83
    v_fmac_f32 v69, v13, v83
    v_fmac_f32 v76, v12, v91
    v_fmac_f32 v77, v13, v91
    v_lshlrev_b32 v12, 16, v47
    v_and_b32 v13, 0xffff0000, v47
    v_fmac_f32 v70, v12, v83
    v_fmac_f32 v71, v13, v83
    v_fmac_f32 v78, v12, v91
    v_fmac_f32 v79, v13, v91
    v_lshlrev_b32 v12, 16, v48
    v_and_b32 v13, 0xffff0000, v48
    v_fmac_f32 v64, v12, v84
    v_fmac_f32 v65, v13, v84
    v_fmac_f32 v72, v12, v92
    v_fmac_f32 v73, v13, v92
    v_lshlrev_b32 v12, 16, v49
    v_and_b32 v13, 0xffff0000, v49
    v_fmac_f32 v66, v12, v84
    v_fmac_f32 v67, v13, v84
    v_fmac_f32 v74, v12, v92
    v_fmac_f32 v75, v13, v92
    v_lshlrev_b32 v12, 16, v50
    v_and_b32 v13, 0xffff0000, v50
    v_fmac_f32 v68, v12, v84
    v_fmac_f32 v69, v13, v84
    v_fmac_f32 v76, v12, v92
    v_fmac_f32 v77, v13, v92
    v_lshlrev_b32 v12, 16, v51
    v_and_b32 v13, 0xffff0000, v51
    v_fmac_f32 v70, v12, v84
    v_fmac_f32 v71, v13, v84
    v_fmac_f32 v78, v12, v92
    v_fmac_f32 v79, v13, v92
    v_lshlrev_b32 v12, 16, v52
    v_and_b32 v13, 0xffff0000, v52
    v_fmac_f32 v64, v12, v85
    v_fmac_f32 v65, v13, v85
    v_fmac_f32 v72, v12, v93
    v_fmac_f32 v73, v13, v93
    v_lshlrev_b32 v12, 16, v53
    v_and_b32 v13, 0xffff0000, v53
    v_fmac_f32 v66, v12, v85
    v_fmac_f32 v67, v13, v85
    v_fmac_f32 v74, v12, v93
    v_fmac_f32 v75, v13, v93
    v_lshlrev_b32 v12, 16, v54
    v_and_b32 v13, 0xffff0000, v54
    v_fmac_f32 v68, v12, v85
    v_fmac_f32 v69, v13, v85
    v_fmac_f32 v76, v12, v93
    v_fmac_f32 v77, v13, v93
    v_lshlrev_b32 v12, 16, v55
    v_and_b32 v13, 0xffff0000, v55
    v_fmac_f32 v70, v12, v85
    v_fmac_f32 v71, v13, v85
    v_fmac_f32 v78, v12, v93
    v_fmac_f32 v79, v13, v93
    v_lshlrev_b32 v12, 16, v56
    v_and_b32 v13, 0xffff0000, v56
    v_fmac_f32 v64, v12, v86
    v_fmac_f32 v65, v13, v86
    v_fmac_f32 v72, v12, v94
    v_fmac_f32 v73, v13, v94
    v_lshlrev_b32 v12, 16, v57
    v_and_b32 v13, 0xffff0000, v57
    v_fmac_f32 v66, v12, v86
    v_fmac_f32 v67, v13, v86
    v_fmac_f32 v74, v12, v94
    v_fmac_f32 v75, v13, v94
    v_lshlrev_b32 v12, 16, v58
    v_and_b32 v13, 0xffff0000, v58
    v_fmac_f32 v68, v12, v86
    v_fmac_f32 v69, v13, v86
    v_fmac_f32 v76, v12, v94
    v_fmac_f32 v77, v13, v94
    v_lshlrev_b32 v12, 16, v59
    v_and_b32 v13, 0xffff0000, v59
    v_fmac_f32 v70, v12, v86
    v_fmac_f32 v71, v13, v86
    v_fmac_f32 v78, v12, v94
    v_fmac_f32 v79, v13, v94
    v_lshlrev_b32 v12, 16, v60
    v_and_b32 v13, 0xffff0000, v60
    v_fmac_f32 v64, v12, v87
    v_fmac_f32 v65, v13, v87
    v_fmac_f32 v72, v12, v95
    v_fmac_f32 v73, v13, v95
    v_lshlrev_b32 v12, 16, v61
    v_and_b32 v13, 0xffff0000, v61
    v_fmac_f32 v66, v12, v87
    v_fmac_f32 v67, v13, v87
    v_fmac_f32 v74, v12, v95
    v_fmac_f32 v75, v13, v95
    v_lshlrev_b32 v12, 16, v62
    v_and_b32 v13, 0xffff0000, v62
    v_fmac_f32 v68, v12, v87
    v_fmac_f32 v69, v13, v87
    v_fmac_f32 v76, v12, v95
    v_fmac_f32 v77, v13, v95
    v_lshlrev_b32 v12, 16, v63
    v_and_b32 v13, 0xffff0000, v63
    v_fmac_f32 v70, v12, v87
    v_fmac_f32 v71, v13, v87
    v_fmac_f32 v78, v12, v95
    v_fmac_f32 v79, v13, v95
    v_lshlrev_b32 v2, 6, v0
    ds_write_b128 v2, v[64:67] offset:4096
    ds_write_b128 v2, v[68:71] offset:4112
    ds_write_b128 v2, v[72:75] offset:4128
    ds_write_b128 v2, v[76:79] offset:4144
    s_waitcnt lgkmcnt(0)
    s_barrier
    v_and_b32 v2, 63, v0
    v_lshrrev_b32 v3, 5, v2
    v_lshlrev_b32 v3, 5, v3
    v_and_b32 v4, 7, v2
    v_lshl_add_u32 v3, v4, 2, v3
    v_bfe_u32 v4, v2, 3, 2
    v_lshl_add_u32 v3, v4, 6, v3
    v_lshrrev_b32 v4, 6, v0
    v_lshl_add_u32 v3, v4, 12, v3
    ds_read_b32 v32, v3 offset:4096
    ds_read_b32 v33, v3 offset:4352
    ds_read_b32 v34, v3 offset:4608
    ds_read_b32 v35, v3 offset:4864
    ds_read_b32 v36, v3 offset:5120
    ds_read_b32 v37, v3 offset:5376
    ds_read_b32 v38, v3 offset:5632
    ds_read_b32 v39, v3 offset:5888
    ds_read_b32 v40, v3 offset:6144
    ds_read_b32 v41, v3 offset:6400
    ds_read_b32 v42, v3 offset:6656
    ds_read_b32 v43, v3 offset:6912
    ds_read_b32 v44, v3 offset:7168
    ds_read_b32 v45, v3 offset:7424
    ds_read_b32 v46, v3 offset:7680
    ds_read_b32 v47, v3 offset:7936
    s_waitcnt lgkmcnt(0)
    v_add_f32 v32, v32, v33
    v_add_f32 v32, v32, v34
    v_add_f32 v32, v32, v35
    v_add_f32 v32, v32, v36
    v_add_f32 v32, v32, v37
    v_add_f32 v32, v32, v38
    v_add_f32 v32, v32, v39
    v_add_f32 v32, v32, v40
    v_add_f32 v32, v32, v41
    v_add_f32 v32, v32, v42
    v_add_f32 v32, v32, v43
    v_add_f32 v32, v32, v44
    v_add_f32 v32, v32, v45
    v_add_f32 v32, v32, v46
    v_add_f32 v32, v32, v47
    v_lshlrev_b32 v3, 2, v0
    ds_write_b32 v3, v32 offset:0
    s_waitcnt lgkmcnt(0)
    s_barrier
    v_cmp_gt_u32 vcc, 64, v0
    s_and_saveexec_b64 s[24:25], vcc
    s_cbranch_execz k1_q_kernel_end
    ds_read_b32 v32, v3 offset:0
    ds_read_b32 v33, v3 offset:256
    ds_read_b32 v34, v3 offset:512
    ds_read_b32 v35, v3 offset:768
    s_waitcnt lgkmcnt(0)
    v_add_f32 v32, v32, v33
    v_add_f32 v34, v34, v35
    v_add_f32 v32, v32, v34
    v_lshrrev_b32 v4, 5, v0
    v_and_b32 v5, 31, v0
    s_lshl_b32 s21, s2, 5
    v_add_u32 v5, s21, v5
    v_cvt_pk_bf16_f32 v32, v32, v32
    v_lshlrev_b32 v4, 12, v4
    v_add_lshl_u32 v5, v4, v5, 1
    s_mov_b32 s22, 32768
    buffer_store_short v32, v5, s[16:19], s22 offen
k1_q_kernel_end:
    s_endpgm
.globl k2_attn_kernel
.p2align 8
.type k2_attn_kernel,@function
k2_attn_kernel:
    s_cmp_ge_u32 s2, 512
    s_cbranch_scc1 k2_attn_kernel_end
    s_load_dwordx2 s[4:5], s[0:1], 8
    s_load_dwordx2 s[8:9], s[0:1], 16
    s_load_dwordx2 s[12:13], s[0:1], 104
    s_load_dwordx2 s[36:37], s[0:1], 96
    v_lshrrev_b32 v3, 6, v0
    s_nop 0
    v_readfirstlane_b32 s16, v3
    s_waitcnt lgkmcnt(0)
    s_mov_b32 s6, 134217728
    s_mov_b32 s7, 0x00020000
    s_mov_b32 s10, 134217728
    s_mov_b32 s11, 0x00020000
    s_mov_b32 s14, 536870912
    s_mov_b32 s15, 0x00020000
    s_mov_b32 s38, 256
    s_mov_b32 s39, 0x00020000
    s_lshl_b32 s17, s2, 18
    s_lshl_b32 s18, s16, 16
    s_add_u32 s17, s17, s18
    v_and_b32 v3, 63, v0
    v_and_b32 v1, 15, v3
    v_lshlrev_b32 v1, 8, v1
    v_lshrrev_b32 v2, 4, v3
    v_lshl_add_u32 v1, v2, 4, v1
    v_lshlrev_b32 v2, 10, v2
    v_and_b32 v73, 15, v3
    v_lshl_add_u32 v2, v73, 4, v2
    s_add_u32 s18, s17, 0
    buffer_load_dwordx4 v[80:83], v1, s[4:7], s18 offen offset:0 nt
    buffer_load_dwordx4 v[84:87], v1, s[4:7], s18 offen offset:64 nt
    buffer_load_dwordx4 v[88:91], v1, s[4:7], s18 offen offset:128 nt
    buffer_load_dwordx4 v[92:95], v1, s[4:7], s18 offen offset:192 nt
    s_add_u32 s19, s17, 0
    buffer_load_dwordx4 v[144:147], v2, s[8:11], s19 offen offset:0 nt
    buffer_load_dwordx4 v[148:151], v2, s[8:11], s19 offen offset:256 nt
    buffer_load_dwordx4 v[152:155], v2, s[8:11], s19 offen offset:512 nt
    buffer_load_dwordx4 v[156:159], v2, s[8:11], s19 offen offset:768 nt
    s_add_u32 s18, s17, 4096
    buffer_load_dwordx4 v[96:99], v1, s[4:7], s18 offen offset:0 nt
    buffer_load_dwordx4 v[100:103], v1, s[4:7], s18 offen offset:64 nt
    buffer_load_dwordx4 v[104:107], v1, s[4:7], s18 offen offset:128 nt
    buffer_load_dwordx4 v[108:111], v1, s[4:7], s18 offen offset:192 nt
    s_add_u32 s19, s17, 4096
    buffer_load_dwordx4 v[160:163], v2, s[8:11], s19 offen offset:0 nt
    buffer_load_dwordx4 v[164:167], v2, s[8:11], s19 offen offset:256 nt
    buffer_load_dwordx4 v[168:171], v2, s[8:11], s19 offen offset:512 nt
    buffer_load_dwordx4 v[172:175], v2, s[8:11], s19 offen offset:768 nt
    s_add_u32 s18, s17, 8192
    buffer_load_dwordx4 v[112:115], v1, s[4:7], s18 offen offset:0 nt
    buffer_load_dwordx4 v[116:119], v1, s[4:7], s18 offen offset:64 nt
    buffer_load_dwordx4 v[120:123], v1, s[4:7], s18 offen offset:128 nt
    buffer_load_dwordx4 v[124:127], v1, s[4:7], s18 offen offset:192 nt
    s_add_u32 s19, s17, 8192
    buffer_load_dwordx4 v[176:179], v2, s[8:11], s19 offen offset:0 nt
    buffer_load_dwordx4 v[180:183], v2, s[8:11], s19 offen offset:256 nt
    buffer_load_dwordx4 v[184:187], v2, s[8:11], s19 offen offset:512 nt
    buffer_load_dwordx4 v[188:191], v2, s[8:11], s19 offen offset:768 nt
    s_add_u32 s18, s17, 12288
    buffer_load_dwordx4 v[128:131], v1, s[4:7], s18 offen offset:0 nt
    buffer_load_dwordx4 v[132:135], v1, s[4:7], s18 offen offset:64 nt
    buffer_load_dwordx4 v[136:139], v1, s[4:7], s18 offen offset:128 nt
    buffer_load_dwordx4 v[140:143], v1, s[4:7], s18 offen offset:192 nt
    s_add_u32 s19, s17, 12288
    buffer_load_dwordx4 v[192:195], v2, s[8:11], s19 offen offset:0 nt
    buffer_load_dwordx4 v[196:199], v2, s[8:11], s19 offen offset:256 nt
    buffer_load_dwordx4 v[200:203], v2, s[8:11], s19 offen offset:512 nt
    buffer_load_dwordx4 v[204:207], v2, s[8:11], s19 offen offset:768 nt
    s_lshr_b32 s20, s2, 5
    s_lshl_b32 s20, s20, 10
    s_add_u32 s20, s20, 32768
    v_and_b32 v73, 15, v3
    v_lshlrev_b32 v74, 8, v73
    v_lshrrev_b32 v75, 4, v3
    v_lshl_add_u32 v74, v75, 4, v74
    v_mov_b32 v75, 0x40000000
    v_cmp_gt_u32 vcc, 4, v73
    s_nop 1
    v_cndmask_b32 v74, v75, v74, vcc
    buffer_load_dwordx4 v[4:7], v74, s[12:15], s20 offen offset:0 sc1
    buffer_load_dwordx4 v[8:11], v74, s[12:15], s20 offen offset:64 sc1
    buffer_load_dwordx4 v[12:15], v74, s[12:15], s20 offen offset:128 sc1
    buffer_load_dwordx4 v[16:19], v74, s[12:15], s20 offen offset:192 sc1
    s_waitcnt vmcnt(0)
    v_mov_b32 v20, 0
    v_mov_b32 v21, 0
    v_mov_b32 v22, 0
    v_mov_b32 v23, 0
    v_mov_b32 v24, 0
    v_mov_b32 v25, 0
    v_mov_b32 v26, 0
    v_mov_b32 v27, 0
    v_mov_b32 v28, 0
    v_mov_b32 v29, 0
    v_mov_b32 v30, 0
    v_mov_b32 v31, 0
    v_mov_b32 v32, 0
    v_mov_b32 v33, 0
    v_mov_b32 v34, 0
    v_mov_b32 v35, 0
    v_mov_b32 v36, 0
    v_mov_b32 v37, 0
    v_mov_b32 v38, 0
    v_mov_b32 v39, 0
    v_mov_b32 v40, 0
    v_mov_b32 v41, 0
    v_mov_b32 v42, 0
    v_mov_b32 v43, 0
    v_mov_b32 v44, 0
    v_mov_b32 v45, 0
    v_mov_b32 v46, 0
    v_mov_b32 v47, 0
    v_mov_b32 v48, 0
    v_mov_b32 v49, 0
    v_mov_b32 v50, 0
    v_mov_b32 v51, 0
    v_mov_b32 v60, 0xff800000
    v_mov_b32 v61, 0
    s_mov_b32 s21, 0x3e0293ee
    s_waitcnt vmcnt(28)
    v_mfma_f32_16x16x32_bf16 v[52:55], v[80:83], v[4:7], 0
    v_mfma_f32_16x16x32_bf16 v[52:55], v[84:87], v[8:11], v[52:55]
    v_mfma_f32_16x16x32_bf16 v[52:55], v[88:91], v[12:15], v[52:55]
    v_mfma_f32_16x16x32_bf16 v[52:55], v[92:95], v[16:19], v[52:55]
    s_add_u32 s18, s17, 16384
    buffer_load_dwordx4 v[80:83], v1, s[4:7], s18 offen offset:0 nt
    buffer_load_dwordx4 v[84:87], v1, s[4:7], s18 offen offset:64 nt
    buffer_load_dwordx4 v[88:91], v1, s[4:7], s18 offen offset:128 nt
    buffer_load_dwordx4 v[92:95], v1, s[4:7], s18 offen offset:192 nt
    s_nop 3
    s_nop 1
    v_max3_f32 v62, v52, v53, v54
    v_max3_f32 v62, v62, v55, v60
    v_cmp_gt_f32 vcc, v62, v60
    s_nop 1
    s_cbranch_vccz k2_attn_kernel_nr0
    v_sub_f32 v63, v60, v62
    v_mul_f32 v63, s21, v63
    v_exp_f32 v63, v63
    v_mov_b32 v60, v62
    v_mul_f32 v61, v61, v63
    s_nop 0
    v_mul_f32_dpp v20, v63, v20 row_newbcast:0 row_mask:0xf bank_mask:0xf
    v_mul_f32_dpp v21, v63, v21 row_newbcast:0 row_mask:0xf bank_mask:0xf
    v_mul_f32_dpp v22, v63, v22 row_newbcast:0 row_mask:0xf bank_mask:0xf
    v_mul_f32_dpp v23, v63, v23 row_newbcast:0 row_mask:0xf bank_mask:0xf
    v_mul_f32_dpp v24, v63, v24 row_newbcast:0 row_mask:0xf bank_mask:0xf
    v_mul_f32_dpp v25, v63, v25 row_newbcast:0 row_mask:0xf bank_mask:0xf
    v_mul_f32_dpp v26, v63, v26 row_newbcast:0 row_mask:0xf bank_mask:0xf
    v_mul_f32_dpp v27, v63, v27 row_newbcast:0 row_mask:0xf bank_mask:0xf
    v_mul_f32_dpp v28, v63, v28 row_newbcast:1 row_mask:0xf bank_mask:0xf
    v_mul_f32_dpp v29, v63, v29 row_newbcast:1 row_mask:0xf bank_mask:0xf
    v_mul_f32_dpp v30, v63, v30 row_newbcast:1 row_mask:0xf bank_mask:0xf
    v_mul_f32_dpp v31, v63, v31 row_newbcast:1 row_mask:0xf bank_mask:0xf
    v_mul_f32_dpp v32, v63, v32 row_newbcast:1 row_mask:0xf bank_mask:0xf
    v_mul_f32_dpp v33, v63, v33 row_newbcast:1 row_mask:0xf bank_mask:0xf
    v_mul_f32_dpp v34, v63, v34 row_newbcast:1 row_mask:0xf bank_mask:0xf
    v_mul_f32_dpp v35, v63, v35 row_newbcast:1 row_mask:0xf bank_mask:0xf
    v_mul_f32_dpp v36, v63, v36 row_newbcast:2 row_mask:0xf bank_mask:0xf
    v_mul_f32_dpp v37, v63, v37 row_newbcast:2 row_mask:0xf bank_mask:0xf
    v_mul_f32_dpp v38, v63, v38 row_newbcast:2 row_mask:0xf bank_mask:0xf
    v_mul_f32_dpp v39, v63, v39 row_newbcast:2 row_mask:0xf bank_mask:0xf
    v_mul_f32_dpp v40, v63, v40 row_newbcast:2 row_mask:0xf bank_mask:0xf
    v_mul_f32_dpp v41, v63, v41 row_newbcast:2 row_mask:0xf bank_mask:0xf
    v_mul_f32_dpp v42, v63, v42 row_newbcast:2 row_mask:0xf bank_mask:0xf
    v_mul_f32_dpp v43, v63, v43 row_newbcast:2 row_mask:0xf bank_mask:0xf
    v_mul_f32_dpp v44, v63, v44 row_newbcast:3 row_mask:0xf bank_mask:0xf
    v_mul_f32_dpp v45, v63, v45 row_newbcast:3 row_mask:0xf bank_mask:0xf
    v_mul_f32_dpp v46, v63, v46 row_newbcast:3 row_mask:0xf bank_mask:0xf
    v_mul_f32_dpp v47, v63, v47 row_newbcast:3 row_mask:0xf bank_mask:0xf
    v_mul_f32_dpp v48, v63, v48 row_newbcast:3 row_mask:0xf bank_mask:0xf
    v_mul_f32_dpp v49, v63, v49 row_newbcast:3 row_mask:0xf bank_mask:0xf
    v_mul_f32_dpp v50, v63, v50 row_newbcast:3 row_mask:0xf bank_mask:0xf
    v_mul_f32_dpp v51, v63, v51 row_newbcast:3 row_mask:0xf bank_mask:0xf
k2_attn_kernel_nr0:
    v_mul_f32 v72, s21, v60
    v_fma_f32 v56, v52, s21, -v72
    v_fma_f32 v57, v53, s21, -v72
    v_fma_f32 v58, v54, s21, -v72
    v_fma_f32 v59, v55, s21, -v72
    v_exp_f32 v56, v56
    v_exp_f32 v57, v57
    v_exp_f32 v58, v58
    v_exp_f32 v59, v59
    s_waitcnt vmcnt(28)
    v_add_f32 v62, v56, v57
    v_add_f32 v63, v58, v59
    v_add_f32 v61, v61, v62
    v_add_f32 v61, v61, v63
    v_lshlrev_b32 v64, 16, v144
    v_and_b32 v65, 0xffff0000, v144
    v_lshlrev_b32 v66, 16, v145
    v_and_b32 v67, 0xffff0000, v145
    v_lshlrev_b32 v68, 16, v146
    v_and_b32 v69, 0xffff0000, v146
    v_lshlrev_b32 v70, 16, v147
    v_and_b32 v71, 0xffff0000, v147
    v_fmac_f32_dpp v20, v56, v64 row_newbcast:0 row_mask:0xf bank_mask:0xf
    v_fmac_f32_dpp v21, v56, v65 row_newbcast:0 row_mask:0xf bank_mask:0xf
    v_fmac_f32_dpp v22, v56, v66 row_newbcast:0 row_mask:0xf bank_mask:0xf
    v_fmac_f32_dpp v23, v56, v67 row_newbcast:0 row_mask:0xf bank_mask:0xf
    v_fmac_f32_dpp v24, v56, v68 row_newbcast:0 row_mask:0xf bank_mask:0xf
    v_fmac_f32_dpp v25, v56, v69 row_newbcast:0 row_mask:0xf bank_mask:0xf
    v_fmac_f32_dpp v26, v56, v70 row_newbcast:0 row_mask:0xf bank_mask:0xf
    v_fmac_f32_dpp v27, v56, v71 row_newbcast:0 row_mask:0xf bank_mask:0xf
    v_fmac_f32_dpp v28, v56, v64 row_newbcast:1 row_mask:0xf bank_mask:0xf
    v_fmac_f32_dpp v29, v56, v65 row_newbcast:1 row_mask:0xf bank_mask:0xf
    v_fmac_f32_dpp v30, v56, v66 row_newbcast:1 row_mask:0xf bank_mask:0xf
    v_fmac_f32_dpp v31, v56, v67 row_newbcast:1 row_mask:0xf bank_mask:0xf
    v_fmac_f32_dpp v32, v56, v68 row_newbcast:1 row_mask:0xf bank_mask:0xf
    v_fmac_f32_dpp v33, v56, v69 row_newbcast:1 row_mask:0xf bank_mask:0xf
    v_fmac_f32_dpp v34, v56, v70 row_newbcast:1 row_mask:0xf bank_mask:0xf
    v_fmac_f32_dpp v35, v56, v71 row_newbcast:1 row_mask:0xf bank_mask:0xf
    v_fmac_f32_dpp v36, v56, v64 row_newbcast:2 row_mask:0xf bank_mask:0xf
    v_fmac_f32_dpp v37, v56, v65 row_newbcast:2 row_mask:0xf bank_mask:0xf
    v_fmac_f32_dpp v38, v56, v66 row_newbcast:2 row_mask:0xf bank_mask:0xf
    v_fmac_f32_dpp v39, v56, v67 row_newbcast:2 row_mask:0xf bank_mask:0xf
    v_fmac_f32_dpp v40, v56, v68 row_newbcast:2 row_mask:0xf bank_mask:0xf
    v_fmac_f32_dpp v41, v56, v69 row_newbcast:2 row_mask:0xf bank_mask:0xf
    v_fmac_f32_dpp v42, v56, v70 row_newbcast:2 row_mask:0xf bank_mask:0xf
    v_fmac_f32_dpp v43, v56, v71 row_newbcast:2 row_mask:0xf bank_mask:0xf
    v_fmac_f32_dpp v44, v56, v64 row_newbcast:3 row_mask:0xf bank_mask:0xf
    v_fmac_f32_dpp v45, v56, v65 row_newbcast:3 row_mask:0xf bank_mask:0xf
    v_fmac_f32_dpp v46, v56, v66 row_newbcast:3 row_mask:0xf bank_mask:0xf
    v_fmac_f32_dpp v47, v56, v67 row_newbcast:3 row_mask:0xf bank_mask:0xf
    v_fmac_f32_dpp v48, v56, v68 row_newbcast:3 row_mask:0xf bank_mask:0xf
    v_fmac_f32_dpp v49, v56, v69 row_newbcast:3 row_mask:0xf bank_mask:0xf
    v_fmac_f32_dpp v50, v56, v70 row_newbcast:3 row_mask:0xf bank_mask:0xf
    v_fmac_f32_dpp v51, v56, v71 row_newbcast:3 row_mask:0xf bank_mask:0xf
    v_lshlrev_b32 v64, 16, v148
    v_and_b32 v65, 0xffff0000, v148
    v_lshlrev_b32 v66, 16, v149
    v_and_b32 v67, 0xffff0000, v149
    v_lshlrev_b32 v68, 16, v150
    v_and_b32 v69, 0xffff0000, v150
    v_lshlrev_b32 v70, 16, v151
    v_and_b32 v71, 0xffff0000, v151
    v_fmac_f32_dpp v20, v57, v64 row_newbcast:0 row_mask:0xf bank_mask:0xf
    v_fmac_f32_dpp v21, v57, v65 row_newbcast:0 row_mask:0xf bank_mask:0xf
    v_fmac_f32_dpp v22, v57, v66 row_newbcast:0 row_mask:0xf bank_mask:0xf
    v_fmac_f32_dpp v23, v57, v67 row_newbcast:0 row_mask:0xf bank_mask:0xf
    v_fmac_f32_dpp v24, v57, v68 row_newbcast:0 row_mask:0xf bank_mask:0xf
    v_fmac_f32_dpp v25, v57, v69 row_newbcast:0 row_mask:0xf bank_mask:0xf
    v_fmac_f32_dpp v26, v57, v70 row_newbcast:0 row_mask:0xf bank_mask:0xf
    v_fmac_f32_dpp v27, v57, v71 row_newbcast:0 row_mask:0xf bank_mask:0xf
    v_fmac_f32_dpp v28, v57, v64 row_newbcast:1 row_mask:0xf bank_mask:0xf
    v_fmac_f32_dpp v29, v57, v65 row_newbcast:1 row_mask:0xf bank_mask:0xf
    v_fmac_f32_dpp v30, v57, v66 row_newbcast:1 row_mask:0xf bank_mask:0xf
    v_fmac_f32_dpp v31, v57, v67 row_newbcast:1 row_mask:0xf bank_mask:0xf
    v_fmac_f32_dpp v32, v57, v68 row_newbcast:1 row_mask:0xf bank_mask:0xf
    v_fmac_f32_dpp v33, v57, v69 row_newbcast:1 row_mask:0xf bank_mask:0xf
    v_fmac_f32_dpp v34, v57, v70 row_newbcast:1 row_mask:0xf bank_mask:0xf
    v_fmac_f32_dpp v35, v57, v71 row_newbcast:1 row_mask:0xf bank_mask:0xf
    v_fmac_f32_dpp v36, v57, v64 row_newbcast:2 row_mask:0xf bank_mask:0xf
    v_fmac_f32_dpp v37, v57, v65 row_newbcast:2 row_mask:0xf bank_mask:0xf
    v_fmac_f32_dpp v38, v57, v66 row_newbcast:2 row_mask:0xf bank_mask:0xf
    v_fmac_f32_dpp v39, v57, v67 row_newbcast:2 row_mask:0xf bank_mask:0xf
    v_fmac_f32_dpp v40, v57, v68 row_newbcast:2 row_mask:0xf bank_mask:0xf
    v_fmac_f32_dpp v41, v57, v69 row_newbcast:2 row_mask:0xf bank_mask:0xf
    v_fmac_f32_dpp v42, v57, v70 row_newbcast:2 row_mask:0xf bank_mask:0xf
    v_fmac_f32_dpp v43, v57, v71 row_newbcast:2 row_mask:0xf bank_mask:0xf
    v_fmac_f32_dpp v44, v57, v64 row_newbcast:3 row_mask:0xf bank_mask:0xf
    v_fmac_f32_dpp v45, v57, v65 row_newbcast:3 row_mask:0xf bank_mask:0xf
    v_fmac_f32_dpp v46, v57, v66 row_newbcast:3 row_mask:0xf bank_mask:0xf
    v_fmac_f32_dpp v47, v57, v67 row_newbcast:3 row_mask:0xf bank_mask:0xf
    v_fmac_f32_dpp v48, v57, v68 row_newbcast:3 row_mask:0xf bank_mask:0xf
    v_fmac_f32_dpp v49, v57, v69 row_newbcast:3 row_mask:0xf bank_mask:0xf
    v_fmac_f32_dpp v50, v57, v70 row_newbcast:3 row_mask:0xf bank_mask:0xf
    v_fmac_f32_dpp v51, v57, v71 row_newbcast:3 row_mask:0xf bank_mask:0xf
    v_lshlrev_b32 v64, 16, v152
    v_and_b32 v65, 0xffff0000, v152
    v_lshlrev_b32 v66, 16, v153
    v_and_b32 v67, 0xffff0000, v153
    v_lshlrev_b32 v68, 16, v154
    v_and_b32 v69, 0xffff0000, v154
    v_lshlrev_b32 v70, 16, v155
    v_and_b32 v71, 0xffff0000, v155
    v_fmac_f32_dpp v20, v58, v64 row_newbcast:0 row_mask:0xf bank_mask:0xf
    v_fmac_f32_dpp v21, v58, v65 row_newbcast:0 row_mask:0xf bank_mask:0xf
    v_fmac_f32_dpp v22, v58, v66 row_newbcast:0 row_mask:0xf bank_mask:0xf
    v_fmac_f32_dpp v23, v58, v67 row_newbcast:0 row_mask:0xf bank_mask:0xf
    v_fmac_f32_dpp v24, v58, v68 row_newbcast:0 row_mask:0xf bank_mask:0xf
    v_fmac_f32_dpp v25, v58, v69 row_newbcast:0 row_mask:0xf bank_mask:0xf
    v_fmac_f32_dpp v26, v58, v70 row_newbcast:0 row_mask:0xf bank_mask:0xf
    v_fmac_f32_dpp v27, v58, v71 row_newbcast:0 row_mask:0xf bank_mask:0xf
    v_fmac_f32_dpp v28, v58, v64 row_newbcast:1 row_mask:0xf bank_mask:0xf
    v_fmac_f32_dpp v29, v58, v65 row_newbcast:1 row_mask:0xf bank_mask:0xf
    v_fmac_f32_dpp v30, v58, v66 row_newbcast:1 row_mask:0xf bank_mask:0xf
    v_fmac_f32_dpp v31, v58, v67 row_newbcast:1 row_mask:0xf bank_mask:0xf
    v_fmac_f32_dpp v32, v58, v68 row_newbcast:1 row_mask:0xf bank_mask:0xf
    v_fmac_f32_dpp v33, v58, v69 row_newbcast:1 row_mask:0xf bank_mask:0xf
    v_fmac_f32_dpp v34, v58, v70 row_newbcast:1 row_mask:0xf bank_mask:0xf
    v_fmac_f32_dpp v35, v58, v71 row_newbcast:1 row_mask:0xf bank_mask:0xf
    v_fmac_f32_dpp v36, v58, v64 row_newbcast:2 row_mask:0xf bank_mask:0xf
    v_fmac_f32_dpp v37, v58, v65 row_newbcast:2 row_mask:0xf bank_mask:0xf
    v_fmac_f32_dpp v38, v58, v66 row_newbcast:2 row_mask:0xf bank_mask:0xf
    v_fmac_f32_dpp v39, v58, v67 row_newbcast:2 row_mask:0xf bank_mask:0xf
    v_fmac_f32_dpp v40, v58, v68 row_newbcast:2 row_mask:0xf bank_mask:0xf
    v_fmac_f32_dpp v41, v58, v69 row_newbcast:2 row_mask:0xf bank_mask:0xf
    v_fmac_f32_dpp v42, v58, v70 row_newbcast:2 row_mask:0xf bank_mask:0xf
    v_fmac_f32_dpp v43, v58, v71 row_newbcast:2 row_mask:0xf bank_mask:0xf
    v_fmac_f32_dpp v44, v58, v64 row_newbcast:3 row_mask:0xf bank_mask:0xf
    v_fmac_f32_dpp v45, v58, v65 row_newbcast:3 row_mask:0xf bank_mask:0xf
    v_fmac_f32_dpp v46, v58, v66 row_newbcast:3 row_mask:0xf bank_mask:0xf
    v_fmac_f32_dpp v47, v58, v67 row_newbcast:3 row_mask:0xf bank_mask:0xf
    v_fmac_f32_dpp v48, v58, v68 row_newbcast:3 row_mask:0xf bank_mask:0xf
    v_fmac_f32_dpp v49, v58, v69 row_newbcast:3 row_mask:0xf bank_mask:0xf
    v_fmac_f32_dpp v50, v58, v70 row_newbcast:3 row_mask:0xf bank_mask:0xf
    v_fmac_f32_dpp v51, v58, v71 row_newbcast:3 row_mask:0xf bank_mask:0xf
    v_lshlrev_b32 v64, 16, v156
    v_and_b32 v65, 0xffff0000, v156
    v_lshlrev_b32 v66, 16, v157
    v_and_b32 v67, 0xffff0000, v157
    v_lshlrev_b32 v68, 16, v158
    v_and_b32 v69, 0xffff0000, v158
    v_lshlrev_b32 v70, 16, v159
    v_and_b32 v71, 0xffff0000, v159
    v_fmac_f32_dpp v20, v59, v64 row_newbcast:0 row_mask:0xf bank_mask:0xf
    v_fmac_f32_dpp v21, v59, v65 row_newbcast:0 row_mask:0xf bank_mask:0xf
    v_fmac_f32_dpp v22, v59, v66 row_newbcast:0 row_mask:0xf bank_mask:0xf
    v_fmac_f32_dpp v23, v59, v67 row_newbcast:0 row_mask:0xf bank_mask:0xf
    v_fmac_f32_dpp v24, v59, v68 row_newbcast:0 row_mask:0xf bank_mask:0xf
    v_fmac_f32_dpp v25, v59, v69 row_newbcast:0 row_mask:0xf bank_mask:0xf
    v_fmac_f32_dpp v26, v59, v70 row_newbcast:0 row_mask:0xf bank_mask:0xf
    v_fmac_f32_dpp v27, v59, v71 row_newbcast:0 row_mask:0xf bank_mask:0xf
    v_fmac_f32_dpp v28, v59, v64 row_newbcast:1 row_mask:0xf bank_mask:0xf
    v_fmac_f32_dpp v29, v59, v65 row_newbcast:1 row_mask:0xf bank_mask:0xf
    v_fmac_f32_dpp v30, v59, v66 row_newbcast:1 row_mask:0xf bank_mask:0xf
    v_fmac_f32_dpp v31, v59, v67 row_newbcast:1 row_mask:0xf bank_mask:0xf
    v_fmac_f32_dpp v32, v59, v68 row_newbcast:1 row_mask:0xf bank_mask:0xf
    v_fmac_f32_dpp v33, v59, v69 row_newbcast:1 row_mask:0xf bank_mask:0xf
    v_fmac_f32_dpp v34, v59, v70 row_newbcast:1 row_mask:0xf bank_mask:0xf
    v_fmac_f32_dpp v35, v59, v71 row_newbcast:1 row_mask:0xf bank_mask:0xf
    v_fmac_f32_dpp v36, v59, v64 row_newbcast:2 row_mask:0xf bank_mask:0xf
    v_fmac_f32_dpp v37, v59, v65 row_newbcast:2 row_mask:0xf bank_mask:0xf
    v_fmac_f32_dpp v38, v59, v66 row_newbcast:2 row_mask:0xf bank_mask:0xf
    v_fmac_f32_dpp v39, v59, v67 row_newbcast:2 row_mask:0xf bank_mask:0xf
    v_fmac_f32_dpp v40, v59, v68 row_newbcast:2 row_mask:0xf bank_mask:0xf
    v_fmac_f32_dpp v41, v59, v69 row_newbcast:2 row_mask:0xf bank_mask:0xf
    v_fmac_f32_dpp v42, v59, v70 row_newbcast:2 row_mask:0xf bank_mask:0xf
    v_fmac_f32_dpp v43, v59, v71 row_newbcast:2 row_mask:0xf bank_mask:0xf
    v_fmac_f32_dpp v44, v59, v64 row_newbcast:3 row_mask:0xf bank_mask:0xf
    v_fmac_f32_dpp v45, v59, v65 row_newbcast:3 row_mask:0xf bank_mask:0xf
    v_fmac_f32_dpp v46, v59, v66 row_newbcast:3 row_mask:0xf bank_mask:0xf
    v_fmac_f32_dpp v47, v59, v67 row_newbcast:3 row_mask:0xf bank_mask:0xf
    v_fmac_f32_dpp v48, v59, v68 row_newbcast:3 row_mask:0xf bank_mask:0xf
    v_fmac_f32_dpp v49, v59, v69 row_newbcast:3 row_mask:0xf bank_mask:0xf
    v_fmac_f32_dpp v50, v59, v70 row_newbcast:3 row_mask:0xf bank_mask:0xf
    v_fmac_f32_dpp v51, v59, v71 row_newbcast:3 row_mask:0xf bank_mask:0xf
    s_add_u32 s19, s17, 16384
    buffer_load_dwordx4 v[144:147], v2, s[8:11], s19 offen offset:0 nt
    buffer_load_dwordx4 v[148:151], v2, s[8:11], s19 offen offset:256 nt
    buffer_load_dwordx4 v[152:155], v2, s[8:11], s19 offen offset:512 nt
    buffer_load_dwordx4 v[156:159], v2, s[8:11], s19 offen offset:768 nt
    s_waitcnt vmcnt(28)
    v_mfma_f32_16x16x32_bf16 v[52:55], v[96:99], v[4:7], 0
    v_mfma_f32_16x16x32_bf16 v[52:55], v[100:103], v[8:11], v[52:55]
    v_mfma_f32_16x16x32_bf16 v[52:55], v[104:107], v[12:15], v[52:55]
    v_mfma_f32_16x16x32_bf16 v[52:55], v[108:111], v[16:19], v[52:55]
    s_add_u32 s18, s17, 20480
    buffer_load_dwordx4 v[96:99], v1, s[4:7], s18 offen offset:0 nt
    buffer_load_dwordx4 v[100:103], v1, s[4:7], s18 offen offset:64 nt
    buffer_load_dwordx4 v[104:107], v1, s[4:7], s18 offen offset:128 nt
    buffer_load_dwordx4 v[108:111], v1, s[4:7], s18 offen offset:192 nt
    s_nop 3
    s_nop 1
    v_max3_f32 v62, v52, v53, v54
    v_max3_f32 v62, v62, v55, v60
    v_cmp_gt_f32 vcc, v62, v60
    s_nop 1
    s_cbranch_vccz k2_attn_kernel_nr1
    v_sub_f32 v63, v60, v62
    v_mul_f32 v63, s21, v63
    v_exp_f32 v63, v63
    v_mov_b32 v60, v62
    v_mul_f32 v61, v61, v63
    s_nop 0
    v_mul_f32_dpp v20, v63, v20 row_newbcast:0 row_mask:0xf bank_mask:0xf
    v_mul_f32_dpp v21, v63, v21 row_newbcast:0 row_mask:0xf bank_mask:0xf
    v_mul_f32_dpp v22, v63, v22 row_newbcast:0 row_mask:0xf bank_mask:0xf
    v_mul_f32_dpp v23, v63, v23 row_newbcast:0 row_mask:0xf bank_mask:0xf
    v_mul_f32_dpp v24, v63, v24 row_newbcast:0 row_mask:0xf bank_mask:0xf
    v_mul_f32_dpp v25, v63, v25 row_newbcast:0 row_mask:0xf bank_mask:0xf
    v_mul_f32_dpp v26, v63, v26 row_newbcast:0 row_mask:0xf bank_mask:0xf
    v_mul_f32_dpp v27, v63, v27 row_newbcast:0 row_mask:0xf bank_mask:0xf
    v_mul_f32_dpp v28, v63, v28 row_newbcast:1 row_mask:0xf bank_mask:0xf
    v_mul_f32_dpp v29, v63, v29 row_newbcast:1 row_mask:0xf bank_mask:0xf
    v_mul_f32_dpp v30, v63, v30 row_newbcast:1 row_mask:0xf bank_mask:0xf
    v_mul_f32_dpp v31, v63, v31 row_newbcast:1 row_mask:0xf bank_mask:0xf
    v_mul_f32_dpp v32, v63, v32 row_newbcast:1 row_mask:0xf bank_mask:0xf
    v_mul_f32_dpp v33, v63, v33 row_newbcast:1 row_mask:0xf bank_mask:0xf
    v_mul_f32_dpp v34, v63, v34 row_newbcast:1 row_mask:0xf bank_mask:0xf
    v_mul_f32_dpp v35, v63, v35 row_newbcast:1 row_mask:0xf bank_mask:0xf
    v_mul_f32_dpp v36, v63, v36 row_newbcast:2 row_mask:0xf bank_mask:0xf
    v_mul_f32_dpp v37, v63, v37 row_newbcast:2 row_mask:0xf bank_mask:0xf
    v_mul_f32_dpp v38, v63, v38 row_newbcast:2 row_mask:0xf bank_mask:0xf
    v_mul_f32_dpp v39, v63, v39 row_newbcast:2 row_mask:0xf bank_mask:0xf
    v_mul_f32_dpp v40, v63, v40 row_newbcast:2 row_mask:0xf bank_mask:0xf
    v_mul_f32_dpp v41, v63, v41 row_newbcast:2 row_mask:0xf bank_mask:0xf
    v_mul_f32_dpp v42, v63, v42 row_newbcast:2 row_mask:0xf bank_mask:0xf
    v_mul_f32_dpp v43, v63, v43 row_newbcast:2 row_mask:0xf bank_mask:0xf
    v_mul_f32_dpp v44, v63, v44 row_newbcast:3 row_mask:0xf bank_mask:0xf
    v_mul_f32_dpp v45, v63, v45 row_newbcast:3 row_mask:0xf bank_mask:0xf
    v_mul_f32_dpp v46, v63, v46 row_newbcast:3 row_mask:0xf bank_mask:0xf
    v_mul_f32_dpp v47, v63, v47 row_newbcast:3 row_mask:0xf bank_mask:0xf
    v_mul_f32_dpp v48, v63, v48 row_newbcast:3 row_mask:0xf bank_mask:0xf
    v_mul_f32_dpp v49, v63, v49 row_newbcast:3 row_mask:0xf bank_mask:0xf
    v_mul_f32_dpp v50, v63, v50 row_newbcast:3 row_mask:0xf bank_mask:0xf
    v_mul_f32_dpp v51, v63, v51 row_newbcast:3 row_mask:0xf bank_mask:0xf
k2_attn_kernel_nr1:
    v_mul_f32 v72, s21, v60
    v_fma_f32 v56, v52, s21, -v72
    v_fma_f32 v57, v53, s21, -v72
    v_fma_f32 v58, v54, s21, -v72
    v_fma_f32 v59, v55, s21, -v72
    v_exp_f32 v56, v56
    v_exp_f32 v57, v57
    v_exp_f32 v58, v58
    v_exp_f32 v59, v59
    s_waitcnt vmcnt(28)
    v_add_f32 v62, v56, v57
    v_add_f32 v63, v58, v59
    v_add_f32 v61, v61, v62
    v_add_f32 v61, v61, v63
    v_lshlrev_b32 v64, 16, v160
    v_and_b32 v65, 0xffff0000, v160
    v_lshlrev_b32 v66, 16, v161
    v_and_b32 v67, 0xffff0000, v161
    v_lshlrev_b32 v68, 16, v162
    v_and_b32 v69, 0xffff0000, v162
    v_lshlrev_b32 v70, 16, v163
    v_and_b32 v71, 0xffff0000, v163
    v_fmac_f32_dpp v20, v56, v64 row_newbcast:0 row_mask:0xf bank_mask:0xf
    v_fmac_f32_dpp v21, v56, v65 row_newbcast:0 row_mask:0xf bank_mask:0xf
    v_fmac_f32_dpp v22, v56, v66 row_newbcast:0 row_mask:0xf bank_mask:0xf
    v_fmac_f32_dpp v23, v56, v67 row_newbcast:0 row_mask:0xf bank_mask:0xf
    v_fmac_f32_dpp v24, v56, v68 row_newbcast:0 row_mask:0xf bank_mask:0xf
    v_fmac_f32_dpp v25, v56, v69 row_newbcast:0 row_mask:0xf bank_mask:0xf
    v_fmac_f32_dpp v26, v56, v70 row_newbcast:0 row_mask:0xf bank_mask:0xf
    v_fmac_f32_dpp v27, v56, v71 row_newbcast:0 row_mask:0xf bank_mask:0xf
    v_fmac_f32_dpp v28, v56, v64 row_newbcast:1 row_mask:0xf bank_mask:0xf
    v_fmac_f32_dpp v29, v56, v65 row_newbcast:1 row_mask:0xf bank_mask:0xf
    v_fmac_f32_dpp v30, v56, v66 row_newbcast:1 row_mask:0xf bank_mask:0xf
    v_fmac_f32_dpp v31, v56, v67 row_newbcast:1 row_mask:0xf bank_mask:0xf
    v_fmac_f32_dpp v32, v56, v68 row_newbcast:1 row_mask:0xf bank_mask:0xf
    v_fmac_f32_dpp v33, v56, v69 row_newbcast:1 row_mask:0xf bank_mask:0xf
    v_fmac_f32_dpp v34, v56, v70 row_newbcast:1 row_mask:0xf bank_mask:0xf
    v_fmac_f32_dpp v35, v56, v71 row_newbcast:1 row_mask:0xf bank_mask:0xf
    v_fmac_f32_dpp v36, v56, v64 row_newbcast:2 row_mask:0xf bank_mask:0xf
    v_fmac_f32_dpp v37, v56, v65 row_newbcast:2 row_mask:0xf bank_mask:0xf
    v_fmac_f32_dpp v38, v56, v66 row_newbcast:2 row_mask:0xf bank_mask:0xf
    v_fmac_f32_dpp v39, v56, v67 row_newbcast:2 row_mask:0xf bank_mask:0xf
    v_fmac_f32_dpp v40, v56, v68 row_newbcast:2 row_mask:0xf bank_mask:0xf
    v_fmac_f32_dpp v41, v56, v69 row_newbcast:2 row_mask:0xf bank_mask:0xf
    v_fmac_f32_dpp v42, v56, v70 row_newbcast:2 row_mask:0xf bank_mask:0xf
    v_fmac_f32_dpp v43, v56, v71 row_newbcast:2 row_mask:0xf bank_mask:0xf
    v_fmac_f32_dpp v44, v56, v64 row_newbcast:3 row_mask:0xf bank_mask:0xf
    v_fmac_f32_dpp v45, v56, v65 row_newbcast:3 row_mask:0xf bank_mask:0xf
    v_fmac_f32_dpp v46, v56, v66 row_newbcast:3 row_mask:0xf bank_mask:0xf
    v_fmac_f32_dpp v47, v56, v67 row_newbcast:3 row_mask:0xf bank_mask:0xf
    v_fmac_f32_dpp v48, v56, v68 row_newbcast:3 row_mask:0xf bank_mask:0xf
    v_fmac_f32_dpp v49, v56, v69 row_newbcast:3 row_mask:0xf bank_mask:0xf
    v_fmac_f32_dpp v50, v56, v70 row_newbcast:3 row_mask:0xf bank_mask:0xf
    v_fmac_f32_dpp v51, v56, v71 row_newbcast:3 row_mask:0xf bank_mask:0xf
    v_lshlrev_b32 v64, 16, v164
    v_and_b32 v65, 0xffff0000, v164
    v_lshlrev_b32 v66, 16, v165
    v_and_b32 v67, 0xffff0000, v165
    v_lshlrev_b32 v68, 16, v166
    v_and_b32 v69, 0xffff0000, v166
    v_lshlrev_b32 v70, 16, v167
    v_and_b32 v71, 0xffff0000, v167
    v_fmac_f32_dpp v20, v57, v64 row_newbcast:0 row_mask:0xf bank_mask:0xf
    v_fmac_f32_dpp v21, v57, v65 row_newbcast:0 row_mask:0xf bank_mask:0xf
    v_fmac_f32_dpp v22, v57, v66 row_newbcast:0 row_mask:0xf bank_mask:0xf
    v_fmac_f32_dpp v23, v57, v67 row_newbcast:0 row_mask:0xf bank_mask:0xf
    v_fmac_f32_dpp v24, v57, v68 row_newbcast:0 row_mask:0xf bank_mask:0xf
    v_fmac_f32_dpp v25, v57, v69 row_newbcast:0 row_mask:0xf bank_mask:0xf
    v_fmac_f32_dpp v26, v57, v70 row_newbcast:0 row_mask:0xf bank_mask:0xf
    v_fmac_f32_dpp v27, v57, v71 row_newbcast:0 row_mask:0xf bank_mask:0xf
    v_fmac_f32_dpp v28, v57, v64 row_newbcast:1 row_mask:0xf bank_mask:0xf
    v_fmac_f32_dpp v29, v57, v65 row_newbcast:1 row_mask:0xf bank_mask:0xf
    v_fmac_f32_dpp v30, v57, v66 row_newbcast:1 row_mask:0xf bank_mask:0xf
    v_fmac_f32_dpp v31, v57, v67 row_newbcast:1 row_mask:0xf bank_mask:0xf
    v_fmac_f32_dpp v32, v57, v68 row_newbcast:1 row_mask:0xf bank_mask:0xf
    v_fmac_f32_dpp v33, v57, v69 row_newbcast:1 row_mask:0xf bank_mask:0xf
    v_fmac_f32_dpp v34, v57, v70 row_newbcast:1 row_mask:0xf bank_mask:0xf
    v_fmac_f32_dpp v35, v57, v71 row_newbcast:1 row_mask:0xf bank_mask:0xf
    v_fmac_f32_dpp v36, v57, v64 row_newbcast:2 row_mask:0xf bank_mask:0xf
    v_fmac_f32_dpp v37, v57, v65 row_newbcast:2 row_mask:0xf bank_mask:0xf
    v_fmac_f32_dpp v38, v57, v66 row_newbcast:2 row_mask:0xf bank_mask:0xf
    v_fmac_f32_dpp v39, v57, v67 row_newbcast:2 row_mask:0xf bank_mask:0xf
    v_fmac_f32_dpp v40, v57, v68 row_newbcast:2 row_mask:0xf bank_mask:0xf
    v_fmac_f32_dpp v41, v57, v69 row_newbcast:2 row_mask:0xf bank_mask:0xf
    v_fmac_f32_dpp v42, v57, v70 row_newbcast:2 row_mask:0xf bank_mask:0xf
    v_fmac_f32_dpp v43, v57, v71 row_newbcast:2 row_mask:0xf bank_mask:0xf
    v_fmac_f32_dpp v44, v57, v64 row_newbcast:3 row_mask:0xf bank_mask:0xf
    v_fmac_f32_dpp v45, v57, v65 row_newbcast:3 row_mask:0xf bank_mask:0xf
    v_fmac_f32_dpp v46, v57, v66 row_newbcast:3 row_mask:0xf bank_mask:0xf
    v_fmac_f32_dpp v47, v57, v67 row_newbcast:3 row_mask:0xf bank_mask:0xf
    v_fmac_f32_dpp v48, v57, v68 row_newbcast:3 row_mask:0xf bank_mask:0xf
    v_fmac_f32_dpp v49, v57, v69 row_newbcast:3 row_mask:0xf bank_mask:0xf
    v_fmac_f32_dpp v50, v57, v70 row_newbcast:3 row_mask:0xf bank_mask:0xf
    v_fmac_f32_dpp v51, v57, v71 row_newbcast:3 row_mask:0xf bank_mask:0xf
    v_lshlrev_b32 v64, 16, v168
    v_and_b32 v65, 0xffff0000, v168
    v_lshlrev_b32 v66, 16, v169
    v_and_b32 v67, 0xffff0000, v169
    v_lshlrev_b32 v68, 16, v170
    v_and_b32 v69, 0xffff0000, v170
    v_lshlrev_b32 v70, 16, v171
    v_and_b32 v71, 0xffff0000, v171
    v_fmac_f32_dpp v20, v58, v64 row_newbcast:0 row_mask:0xf bank_mask:0xf
    v_fmac_f32_dpp v21, v58, v65 row_newbcast:0 row_mask:0xf bank_mask:0xf
    v_fmac_f32_dpp v22, v58, v66 row_newbcast:0 row_mask:0xf bank_mask:0xf
    v_fmac_f32_dpp v23, v58, v67 row_newbcast:0 row_mask:0xf bank_mask:0xf
    v_fmac_f32_dpp v24, v58, v68 row_newbcast:0 row_mask:0xf bank_mask:0xf
    v_fmac_f32_dpp v25, v58, v69 row_newbcast:0 row_mask:0xf bank_mask:0xf
    v_fmac_f32_dpp v26, v58, v70 row_newbcast:0 row_mask:0xf bank_mask:0xf
    v_fmac_f32_dpp v27, v58, v71 row_newbcast:0 row_mask:0xf bank_mask:0xf
    v_fmac_f32_dpp v28, v58, v64 row_newbcast:1 row_mask:0xf bank_mask:0xf
    v_fmac_f32_dpp v29, v58, v65 row_newbcast:1 row_mask:0xf bank_mask:0xf
    v_fmac_f32_dpp v30, v58, v66 row_newbcast:1 row_mask:0xf bank_mask:0xf
    v_fmac_f32_dpp v31, v58, v67 row_newbcast:1 row_mask:0xf bank_mask:0xf
    v_fmac_f32_dpp v32, v58, v68 row_newbcast:1 row_mask:0xf bank_mask:0xf
    v_fmac_f32_dpp v33, v58, v69 row_newbcast:1 row_mask:0xf bank_mask:0xf
    v_fmac_f32_dpp v34, v58, v70 row_newbcast:1 row_mask:0xf bank_mask:0xf
    v_fmac_f32_dpp v35, v58, v71 row_newbcast:1 row_mask:0xf bank_mask:0xf
    v_fmac_f32_dpp v36, v58, v64 row_newbcast:2 row_mask:0xf bank_mask:0xf
    v_fmac_f32_dpp v37, v58, v65 row_newbcast:2 row_mask:0xf bank_mask:0xf
    v_fmac_f32_dpp v38, v58, v66 row_newbcast:2 row_mask:0xf bank_mask:0xf
    v_fmac_f32_dpp v39, v58, v67 row_newbcast:2 row_mask:0xf bank_mask:0xf
    v_fmac_f32_dpp v40, v58, v68 row_newbcast:2 row_mask:0xf bank_mask:0xf
    v_fmac_f32_dpp v41, v58, v69 row_newbcast:2 row_mask:0xf bank_mask:0xf
    v_fmac_f32_dpp v42, v58, v70 row_newbcast:2 row_mask:0xf bank_mask:0xf
    v_fmac_f32_dpp v43, v58, v71 row_newbcast:2 row_mask:0xf bank_mask:0xf
    v_fmac_f32_dpp v44, v58, v64 row_newbcast:3 row_mask:0xf bank_mask:0xf
    v_fmac_f32_dpp v45, v58, v65 row_newbcast:3 row_mask:0xf bank_mask:0xf
    v_fmac_f32_dpp v46, v58, v66 row_newbcast:3 row_mask:0xf bank_mask:0xf
    v_fmac_f32_dpp v47, v58, v67 row_newbcast:3 row_mask:0xf bank_mask:0xf
    v_fmac_f32_dpp v48, v58, v68 row_newbcast:3 row_mask:0xf bank_mask:0xf
    v_fmac_f32_dpp v49, v58, v69 row_newbcast:3 row_mask:0xf bank_mask:0xf
    v_fmac_f32_dpp v50, v58, v70 row_newbcast:3 row_mask:0xf bank_mask:0xf
    v_fmac_f32_dpp v51, v58, v71 row_newbcast:3 row_mask:0xf bank_mask:0xf
    v_lshlrev_b32 v64, 16, v172
    v_and_b32 v65, 0xffff0000, v172
    v_lshlrev_b32 v66, 16, v173
    v_and_b32 v67, 0xffff0000, v173
    v_lshlrev_b32 v68, 16, v174
    v_and_b32 v69, 0xffff0000, v174
    v_lshlrev_b32 v70, 16, v175
    v_and_b32 v71, 0xffff0000, v175
    v_fmac_f32_dpp v20, v59, v64 row_newbcast:0 row_mask:0xf bank_mask:0xf
    v_fmac_f32_dpp v21, v59, v65 row_newbcast:0 row_mask:0xf bank_mask:0xf
    v_fmac_f32_dpp v22, v59, v66 row_newbcast:0 row_mask:0xf bank_mask:0xf
    v_fmac_f32_dpp v23, v59, v67 row_newbcast:0 row_mask:0xf bank_mask:0xf
    v_fmac_f32_dpp v24, v59, v68 row_newbcast:0 row_mask:0xf bank_mask:0xf
    v_fmac_f32_dpp v25, v59, v69 row_newbcast:0 row_mask:0xf bank_mask:0xf
    v_fmac_f32_dpp v26, v59, v70 row_newbcast:0 row_mask:0xf bank_mask:0xf
    v_fmac_f32_dpp v27, v59, v71 row_newbcast:0 row_mask:0xf bank_mask:0xf
    v_fmac_f32_dpp v28, v59, v64 row_newbcast:1 row_mask:0xf bank_mask:0xf
    v_fmac_f32_dpp v29, v59, v65 row_newbcast:1 row_mask:0xf bank_mask:0xf
    v_fmac_f32_dpp v30, v59, v66 row_newbcast:1 row_mask:0xf bank_mask:0xf
    v_fmac_f32_dpp v31, v59, v67 row_newbcast:1 row_mask:0xf bank_mask:0xf
    v_fmac_f32_dpp v32, v59, v68 row_newbcast:1 row_mask:0xf bank_mask:0xf
    v_fmac_f32_dpp v33, v59, v69 row_newbcast:1 row_mask:0xf bank_mask:0xf
    v_fmac_f32_dpp v34, v59, v70 row_newbcast:1 row_mask:0xf bank_mask:0xf
    v_fmac_f32_dpp v35, v59, v71 row_newbcast:1 row_mask:0xf bank_mask:0xf
    v_fmac_f32_dpp v36, v59, v64 row_newbcast:2 row_mask:0xf bank_mask:0xf
    v_fmac_f32_dpp v37, v59, v65 row_newbcast:2 row_mask:0xf bank_mask:0xf
    v_fmac_f32_dpp v38, v59, v66 row_newbcast:2 row_mask:0xf bank_mask:0xf
    v_fmac_f32_dpp v39, v59, v67 row_newbcast:2 row_mask:0xf bank_mask:0xf
    v_fmac_f32_dpp v40, v59, v68 row_newbcast:2 row_mask:0xf bank_mask:0xf
    v_fmac_f32_dpp v41, v59, v69 row_newbcast:2 row_mask:0xf bank_mask:0xf
    v_fmac_f32_dpp v42, v59, v70 row_newbcast:2 row_mask:0xf bank_mask:0xf
    v_fmac_f32_dpp v43, v59, v71 row_newbcast:2 row_mask:0xf bank_mask:0xf
    v_fmac_f32_dpp v44, v59, v64 row_newbcast:3 row_mask:0xf bank_mask:0xf
    v_fmac_f32_dpp v45, v59, v65 row_newbcast:3 row_mask:0xf bank_mask:0xf
    v_fmac_f32_dpp v46, v59, v66 row_newbcast:3 row_mask:0xf bank_mask:0xf
    v_fmac_f32_dpp v47, v59, v67 row_newbcast:3 row_mask:0xf bank_mask:0xf
    v_fmac_f32_dpp v48, v59, v68 row_newbcast:3 row_mask:0xf bank_mask:0xf
    v_fmac_f32_dpp v49, v59, v69 row_newbcast:3 row_mask:0xf bank_mask:0xf
    v_fmac_f32_dpp v50, v59, v70 row_newbcast:3 row_mask:0xf bank_mask:0xf
    v_fmac_f32_dpp v51, v59, v71 row_newbcast:3 row_mask:0xf bank_mask:0xf
    s_add_u32 s19, s17, 20480
    buffer_load_dwordx4 v[160:163], v2, s[8:11], s19 offen offset:0 nt
    buffer_load_dwordx4 v[164:167], v2, s[8:11], s19 offen offset:256 nt
    buffer_load_dwordx4 v[168:171], v2, s[8:11], s19 offen offset:512 nt
    buffer_load_dwordx4 v[172:175], v2, s[8:11], s19 offen offset:768 nt
    s_waitcnt vmcnt(28)
    v_mfma_f32_16x16x32_bf16 v[52:55], v[112:115], v[4:7], 0
    v_mfma_f32_16x16x32_bf16 v[52:55], v[116:119], v[8:11], v[52:55]
    v_mfma_f32_16x16x32_bf16 v[52:55], v[120:123], v[12:15], v[52:55]
    v_mfma_f32_16x16x32_bf16 v[52:55], v[124:127], v[16:19], v[52:55]
    s_add_u32 s18, s17, 24576
    buffer_load_dwordx4 v[112:115], v1, s[4:7], s18 offen offset:0 nt
    buffer_load_dwordx4 v[116:119], v1, s[4:7], s18 offen offset:64 nt
    buffer_load_dwordx4 v[120:123], v1, s[4:7], s18 offen offset:128 nt
    buffer_load_dwordx4 v[124:127], v1, s[4:7], s18 offen offset:192 nt
    s_nop 3
    s_nop 1
    v_max3_f32 v62, v52, v53, v54
    v_max3_f32 v62, v62, v55, v60
    v_cmp_gt_f32 vcc, v62, v60
    s_nop 1
    s_cbranch_vccz k2_attn_kernel_nr2
    v_sub_f32 v63, v60, v62
    v_mul_f32 v63, s21, v63
    v_exp_f32 v63, v63
    v_mov_b32 v60, v62
    v_mul_f32 v61, v61, v63
    s_nop 0
    v_mul_f32_dpp v20, v63, v20 row_newbcast:0 row_mask:0xf bank_mask:0xf
    v_mul_f32_dpp v21, v63, v21 row_newbcast:0 row_mask:0xf bank_mask:0xf
    v_mul_f32_dpp v22, v63, v22 row_newbcast:0 row_mask:0xf bank_mask:0xf
    v_mul_f32_dpp v23, v63, v23 row_newbcast:0 row_mask:0xf bank_mask:0xf
    v_mul_f32_dpp v24, v63, v24 row_newbcast:0 row_mask:0xf bank_mask:0xf
    v_mul_f32_dpp v25, v63, v25 row_newbcast:0 row_mask:0xf bank_mask:0xf
    v_mul_f32_dpp v26, v63, v26 row_newbcast:0 row_mask:0xf bank_mask:0xf
    v_mul_f32_dpp v27, v63, v27 row_newbcast:0 row_mask:0xf bank_mask:0xf
    v_mul_f32_dpp v28, v63, v28 row_newbcast:1 row_mask:0xf bank_mask:0xf
    v_mul_f32_dpp v29, v63, v29 row_newbcast:1 row_mask:0xf bank_mask:0xf
    v_mul_f32_dpp v30, v63, v30 row_newbcast:1 row_mask:0xf bank_mask:0xf
    v_mul_f32_dpp v31, v63, v31 row_newbcast:1 row_mask:0xf bank_mask:0xf
    v_mul_f32_dpp v32, v63, v32 row_newbcast:1 row_mask:0xf bank_mask:0xf
    v_mul_f32_dpp v33, v63, v33 row_newbcast:1 row_mask:0xf bank_mask:0xf
    v_mul_f32_dpp v34, v63, v34 row_newbcast:1 row_mask:0xf bank_mask:0xf
    v_mul_f32_dpp v35, v63, v35 row_newbcast:1 row_mask:0xf bank_mask:0xf
    v_mul_f32_dpp v36, v63, v36 row_newbcast:2 row_mask:0xf bank_mask:0xf
    v_mul_f32_dpp v37, v63, v37 row_newbcast:2 row_mask:0xf bank_mask:0xf
    v_mul_f32_dpp v38, v63, v38 row_newbcast:2 row_mask:0xf bank_mask:0xf
    v_mul_f32_dpp v39, v63, v39 row_newbcast:2 row_mask:0xf bank_mask:0xf
    v_mul_f32_dpp v40, v63, v40 row_newbcast:2 row_mask:0xf bank_mask:0xf
    v_mul_f32_dpp v41, v63, v41 row_newbcast:2 row_mask:0xf bank_mask:0xf
    v_mul_f32_dpp v42, v63, v42 row_newbcast:2 row_mask:0xf bank_mask:0xf
    v_mul_f32_dpp v43, v63, v43 row_newbcast:2 row_mask:0xf bank_mask:0xf
    v_mul_f32_dpp v44, v63, v44 row_newbcast:3 row_mask:0xf bank_mask:0xf
    v_mul_f32_dpp v45, v63, v45 row_newbcast:3 row_mask:0xf bank_mask:0xf
    v_mul_f32_dpp v46, v63, v46 row_newbcast:3 row_mask:0xf bank_mask:0xf
    v_mul_f32_dpp v47, v63, v47 row_newbcast:3 row_mask:0xf bank_mask:0xf
    v_mul_f32_dpp v48, v63, v48 row_newbcast:3 row_mask:0xf bank_mask:0xf
    v_mul_f32_dpp v49, v63, v49 row_newbcast:3 row_mask:0xf bank_mask:0xf
    v_mul_f32_dpp v50, v63, v50 row_newbcast:3 row_mask:0xf bank_mask:0xf
    v_mul_f32_dpp v51, v63, v51 row_newbcast:3 row_mask:0xf bank_mask:0xf
k2_attn_kernel_nr2:
    v_mul_f32 v72, s21, v60
    v_fma_f32 v56, v52, s21, -v72
    v_fma_f32 v57, v53, s21, -v72
    v_fma_f32 v58, v54, s21, -v72
    v_fma_f32 v59, v55, s21, -v72
    v_exp_f32 v56, v56
    v_exp_f32 v57, v57
    v_exp_f32 v58, v58
    v_exp_f32 v59, v59
    s_waitcnt vmcnt(28)
    v_add_f32 v62, v56, v57
    v_add_f32 v63, v58, v59
    v_add_f32 v61, v61, v62
    v_add_f32 v61, v61, v63
    v_lshlrev_b32 v64, 16, v176
    v_and_b32 v65, 0xffff0000, v176
    v_lshlrev_b32 v66, 16, v177
    v_and_b32 v67, 0xffff0000, v177
    v_lshlrev_b32 v68, 16, v178
    v_and_b32 v69, 0xffff0000, v178
    v_lshlrev_b32 v70, 16, v179
    v_and_b32 v71, 0xffff0000, v179
    v_fmac_f32_dpp v20, v56, v64 row_newbcast:0 row_mask:0xf bank_mask:0xf
    v_fmac_f32_dpp v21, v56, v65 row_newbcast:0 row_mask:0xf bank_mask:0xf
    v_fmac_f32_dpp v22, v56, v66 row_newbcast:0 row_mask:0xf bank_mask:0xf
    v_fmac_f32_dpp v23, v56, v67 row_newbcast:0 row_mask:0xf bank_mask:0xf
    v_fmac_f32_dpp v24, v56, v68 row_newbcast:0 row_mask:0xf bank_mask:0xf
    v_fmac_f32_dpp v25, v56, v69 row_newbcast:0 row_mask:0xf bank_mask:0xf
    v_fmac_f32_dpp v26, v56, v70 row_newbcast:0 row_mask:0xf bank_mask:0xf
    v_fmac_f32_dpp v27, v56, v71 row_newbcast:0 row_mask:0xf bank_mask:0xf
    v_fmac_f32_dpp v28, v56, v64 row_newbcast:1 row_mask:0xf bank_mask:0xf
    v_fmac_f32_dpp v29, v56, v65 row_newbcast:1 row_mask:0xf bank_mask:0xf
    v_fmac_f32_dpp v30, v56, v66 row_newbcast:1 row_mask:0xf bank_mask:0xf
    v_fmac_f32_dpp v31, v56, v67 row_newbcast:1 row_mask:0xf bank_mask:0xf
    v_fmac_f32_dpp v32, v56, v68 row_newbcast:1 row_mask:0xf bank_mask:0xf
    v_fmac_f32_dpp v33, v56, v69 row_newbcast:1 row_mask:0xf bank_mask:0xf
    v_fmac_f32_dpp v34, v56, v70 row_newbcast:1 row_mask:0xf bank_mask:0xf
    v_fmac_f32_dpp v35, v56, v71 row_newbcast:1 row_mask:0xf bank_mask:0xf
    v_fmac_f32_dpp v36, v56, v64 row_newbcast:2 row_mask:0xf bank_mask:0xf
    v_fmac_f32_dpp v37, v56, v65 row_newbcast:2 row_mask:0xf bank_mask:0xf
    v_fmac_f32_dpp v38, v56, v66 row_newbcast:2 row_mask:0xf bank_mask:0xf
    v_fmac_f32_dpp v39, v56, v67 row_newbcast:2 row_mask:0xf bank_mask:0xf
    v_fmac_f32_dpp v40, v56, v68 row_newbcast:2 row_mask:0xf bank_mask:0xf
    v_fmac_f32_dpp v41, v56, v69 row_newbcast:2 row_mask:0xf bank_mask:0xf
    v_fmac_f32_dpp v42, v56, v70 row_newbcast:2 row_mask:0xf bank_mask:0xf
    v_fmac_f32_dpp v43, v56, v71 row_newbcast:2 row_mask:0xf bank_mask:0xf
    v_fmac_f32_dpp v44, v56, v64 row_newbcast:3 row_mask:0xf bank_mask:0xf
    v_fmac_f32_dpp v45, v56, v65 row_newbcast:3 row_mask:0xf bank_mask:0xf
    v_fmac_f32_dpp v46, v56, v66 row_newbcast:3 row_mask:0xf bank_mask:0xf
    v_fmac_f32_dpp v47, v56, v67 row_newbcast:3 row_mask:0xf bank_mask:0xf
    v_fmac_f32_dpp v48, v56, v68 row_newbcast:3 row_mask:0xf bank_mask:0xf
    v_fmac_f32_dpp v49, v56, v69 row_newbcast:3 row_mask:0xf bank_mask:0xf
    v_fmac_f32_dpp v50, v56, v70 row_newbcast:3 row_mask:0xf bank_mask:0xf
    v_fmac_f32_dpp v51, v56, v71 row_newbcast:3 row_mask:0xf bank_mask:0xf
    v_lshlrev_b32 v64, 16, v180
    v_and_b32 v65, 0xffff0000, v180
    v_lshlrev_b32 v66, 16, v181
    v_and_b32 v67, 0xffff0000, v181
    v_lshlrev_b32 v68, 16, v182
    v_and_b32 v69, 0xffff0000, v182
    v_lshlrev_b32 v70, 16, v183
    v_and_b32 v71, 0xffff0000, v183
    v_fmac_f32_dpp v20, v57, v64 row_newbcast:0 row_mask:0xf bank_mask:0xf
    v_fmac_f32_dpp v21, v57, v65 row_newbcast:0 row_mask:0xf bank_mask:0xf
    v_fmac_f32_dpp v22, v57, v66 row_newbcast:0 row_mask:0xf bank_mask:0xf
    v_fmac_f32_dpp v23, v57, v67 row_newbcast:0 row_mask:0xf bank_mask:0xf
    v_fmac_f32_dpp v24, v57, v68 row_newbcast:0 row_mask:0xf bank_mask:0xf
    v_fmac_f32_dpp v25, v57, v69 row_newbcast:0 row_mask:0xf bank_mask:0xf
    v_fmac_f32_dpp v26, v57, v70 row_newbcast:0 row_mask:0xf bank_mask:0xf
    v_fmac_f32_dpp v27, v57, v71 row_newbcast:0 row_mask:0xf bank_mask:0xf
    v_fmac_f32_dpp v28, v57, v64 row_newbcast:1 row_mask:0xf bank_mask:0xf
    v_fmac_f32_dpp v29, v57, v65 row_newbcast:1 row_mask:0xf bank_mask:0xf
    v_fmac_f32_dpp v30, v57, v66 row_newbcast:1 row_mask:0xf bank_mask:0xf
    v_fmac_f32_dpp v31, v57, v67 row_newbcast:1 row_mask:0xf bank_mask:0xf
    v_fmac_f32_dpp v32, v57, v68 row_newbcast:1 row_mask:0xf bank_mask:0xf
    v_fmac_f32_dpp v33, v57, v69 row_newbcast:1 row_mask:0xf bank_mask:0xf
    v_fmac_f32_dpp v34, v57, v70 row_newbcast:1 row_mask:0xf bank_mask:0xf
    v_fmac_f32_dpp v35, v57, v71 row_newbcast:1 row_mask:0xf bank_mask:0xf
    v_fmac_f32_dpp v36, v57, v64 row_newbcast:2 row_mask:0xf bank_mask:0xf
    v_fmac_f32_dpp v37, v57, v65 row_newbcast:2 row_mask:0xf bank_mask:0xf
    v_fmac_f32_dpp v38, v57, v66 row_newbcast:2 row_mask:0xf bank_mask:0xf
    v_fmac_f32_dpp v39, v57, v67 row_newbcast:2 row_mask:0xf bank_mask:0xf
    v_fmac_f32_dpp v40, v57, v68 row_newbcast:2 row_mask:0xf bank_mask:0xf
    v_fmac_f32_dpp v41, v57, v69 row_newbcast:2 row_mask:0xf bank_mask:0xf
    v_fmac_f32_dpp v42, v57, v70 row_newbcast:2 row_mask:0xf bank_mask:0xf
    v_fmac_f32_dpp v43, v57, v71 row_newbcast:2 row_mask:0xf bank_mask:0xf
    v_fmac_f32_dpp v44, v57, v64 row_newbcast:3 row_mask:0xf bank_mask:0xf
    v_fmac_f32_dpp v45, v57, v65 row_newbcast:3 row_mask:0xf bank_mask:0xf
    v_fmac_f32_dpp v46, v57, v66 row_newbcast:3 row_mask:0xf bank_mask:0xf
    v_fmac_f32_dpp v47, v57, v67 row_newbcast:3 row_mask:0xf bank_mask:0xf
    v_fmac_f32_dpp v48, v57, v68 row_newbcast:3 row_mask:0xf bank_mask:0xf
    v_fmac_f32_dpp v49, v57, v69 row_newbcast:3 row_mask:0xf bank_mask:0xf
    v_fmac_f32_dpp v50, v57, v70 row_newbcast:3 row_mask:0xf bank_mask:0xf
    v_fmac_f32_dpp v51, v57, v71 row_newbcast:3 row_mask:0xf bank_mask:0xf
    v_lshlrev_b32 v64, 16, v184
    v_and_b32 v65, 0xffff0000, v184
    v_lshlrev_b32 v66, 16, v185
    v_and_b32 v67, 0xffff0000, v185
    v_lshlrev_b32 v68, 16, v186
    v_and_b32 v69, 0xffff0000, v186
    v_lshlrev_b32 v70, 16, v187
    v_and_b32 v71, 0xffff0000, v187
    v_fmac_f32_dpp v20, v58, v64 row_newbcast:0 row_mask:0xf bank_mask:0xf
    v_fmac_f32_dpp v21, v58, v65 row_newbcast:0 row_mask:0xf bank_mask:0xf
    v_fmac_f32_dpp v22, v58, v66 row_newbcast:0 row_mask:0xf bank_mask:0xf
    v_fmac_f32_dpp v23, v58, v67 row_newbcast:0 row_mask:0xf bank_mask:0xf
    v_fmac_f32_dpp v24, v58, v68 row_newbcast:0 row_mask:0xf bank_mask:0xf
    v_fmac_f32_dpp v25, v58, v69 row_newbcast:0 row_mask:0xf bank_mask:0xf
    v_fmac_f32_dpp v26, v58, v70 row_newbcast:0 row_mask:0xf bank_mask:0xf
    v_fmac_f32_dpp v27, v58, v71 row_newbcast:0 row_mask:0xf bank_mask:0xf
    v_fmac_f32_dpp v28, v58, v64 row_newbcast:1 row_mask:0xf bank_mask:0xf
    v_fmac_f32_dpp v29, v58, v65 row_newbcast:1 row_mask:0xf bank_mask:0xf
    v_fmac_f32_dpp v30, v58, v66 row_newbcast:1 row_mask:0xf bank_mask:0xf
    v_fmac_f32_dpp v31, v58, v67 row_newbcast:1 row_mask:0xf bank_mask:0xf
    v_fmac_f32_dpp v32, v58, v68 row_newbcast:1 row_mask:0xf bank_mask:0xf
    v_fmac_f32_dpp v33, v58, v69 row_newbcast:1 row_mask:0xf bank_mask:0xf
    v_fmac_f32_dpp v34, v58, v70 row_newbcast:1 row_mask:0xf bank_mask:0xf
    v_fmac_f32_dpp v35, v58, v71 row_newbcast:1 row_mask:0xf bank_mask:0xf
    v_fmac_f32_dpp v36, v58, v64 row_newbcast:2 row_mask:0xf bank_mask:0xf
    v_fmac_f32_dpp v37, v58, v65 row_newbcast:2 row_mask:0xf bank_mask:0xf
    v_fmac_f32_dpp v38, v58, v66 row_newbcast:2 row_mask:0xf bank_mask:0xf
    v_fmac_f32_dpp v39, v58, v67 row_newbcast:2 row_mask:0xf bank_mask:0xf
    v_fmac_f32_dpp v40, v58, v68 row_newbcast:2 row_mask:0xf bank_mask:0xf
    v_fmac_f32_dpp v41, v58, v69 row_newbcast:2 row_mask:0xf bank_mask:0xf
    v_fmac_f32_dpp v42, v58, v70 row_newbcast:2 row_mask:0xf bank_mask:0xf
    v_fmac_f32_dpp v43, v58, v71 row_newbcast:2 row_mask:0xf bank_mask:0xf
    v_fmac_f32_dpp v44, v58, v64 row_newbcast:3 row_mask:0xf bank_mask:0xf
    v_fmac_f32_dpp v45, v58, v65 row_newbcast:3 row_mask:0xf bank_mask:0xf
    v_fmac_f32_dpp v46, v58, v66 row_newbcast:3 row_mask:0xf bank_mask:0xf
    v_fmac_f32_dpp v47, v58, v67 row_newbcast:3 row_mask:0xf bank_mask:0xf
    v_fmac_f32_dpp v48, v58, v68 row_newbcast:3 row_mask:0xf bank_mask:0xf
    v_fmac_f32_dpp v49, v58, v69 row_newbcast:3 row_mask:0xf bank_mask:0xf
    v_fmac_f32_dpp v50, v58, v70 row_newbcast:3 row_mask:0xf bank_mask:0xf
    v_fmac_f32_dpp v51, v58, v71 row_newbcast:3 row_mask:0xf bank_mask:0xf
    v_lshlrev_b32 v64, 16, v188
    v_and_b32 v65, 0xffff0000, v188
    v_lshlrev_b32 v66, 16, v189
    v_and_b32 v67, 0xffff0000, v189
    v_lshlrev_b32 v68, 16, v190
    v_and_b32 v69, 0xffff0000, v190
    v_lshlrev_b32 v70, 16, v191
    v_and_b32 v71, 0xffff0000, v191
    v_fmac_f32_dpp v20, v59, v64 row_newbcast:0 row_mask:0xf bank_mask:0xf
    v_fmac_f32_dpp v21, v59, v65 row_newbcast:0 row_mask:0xf bank_mask:0xf
    v_fmac_f32_dpp v22, v59, v66 row_newbcast:0 row_mask:0xf bank_mask:0xf
    v_fmac_f32_dpp v23, v59, v67 row_newbcast:0 row_mask:0xf bank_mask:0xf
    v_fmac_f32_dpp v24, v59, v68 row_newbcast:0 row_mask:0xf bank_mask:0xf
    v_fmac_f32_dpp v25, v59, v69 row_newbcast:0 row_mask:0xf bank_mask:0xf
    v_fmac_f32_dpp v26, v59, v70 row_newbcast:0 row_mask:0xf bank_mask:0xf
    v_fmac_f32_dpp v27, v59, v71 row_newbcast:0 row_mask:0xf bank_mask:0xf
    v_fmac_f32_dpp v28, v59, v64 row_newbcast:1 row_mask:0xf bank_mask:0xf
    v_fmac_f32_dpp v29, v59, v65 row_newbcast:1 row_mask:0xf bank_mask:0xf
    v_fmac_f32_dpp v30, v59, v66 row_newbcast:1 row_mask:0xf bank_mask:0xf
    v_fmac_f32_dpp v31, v59, v67 row_newbcast:1 row_mask:0xf bank_mask:0xf
    v_fmac_f32_dpp v32, v59, v68 row_newbcast:1 row_mask:0xf bank_mask:0xf
    v_fmac_f32_dpp v33, v59, v69 row_newbcast:1 row_mask:0xf bank_mask:0xf
    v_fmac_f32_dpp v34, v59, v70 row_newbcast:1 row_mask:0xf bank_mask:0xf
    v_fmac_f32_dpp v35, v59, v71 row_newbcast:1 row_mask:0xf bank_mask:0xf
    v_fmac_f32_dpp v36, v59, v64 row_newbcast:2 row_mask:0xf bank_mask:0xf
    v_fmac_f32_dpp v37, v59, v65 row_newbcast:2 row_mask:0xf bank_mask:0xf
    v_fmac_f32_dpp v38, v59, v66 row_newbcast:2 row_mask:0xf bank_mask:0xf
    v_fmac_f32_dpp v39, v59, v67 row_newbcast:2 row_mask:0xf bank_mask:0xf
    v_fmac_f32_dpp v40, v59, v68 row_newbcast:2 row_mask:0xf bank_mask:0xf
    v_fmac_f32_dpp v41, v59, v69 row_newbcast:2 row_mask:0xf bank_mask:0xf
    v_fmac_f32_dpp v42, v59, v70 row_newbcast:2 row_mask:0xf bank_mask:0xf
    v_fmac_f32_dpp v43, v59, v71 row_newbcast:2 row_mask:0xf bank_mask:0xf
    v_fmac_f32_dpp v44, v59, v64 row_newbcast:3 row_mask:0xf bank_mask:0xf
    v_fmac_f32_dpp v45, v59, v65 row_newbcast:3 row_mask:0xf bank_mask:0xf
    v_fmac_f32_dpp v46, v59, v66 row_newbcast:3 row_mask:0xf bank_mask:0xf
    v_fmac_f32_dpp v47, v59, v67 row_newbcast:3 row_mask:0xf bank_mask:0xf
    v_fmac_f32_dpp v48, v59, v68 row_newbcast:3 row_mask:0xf bank_mask:0xf
    v_fmac_f32_dpp v49, v59, v69 row_newbcast:3 row_mask:0xf bank_mask:0xf
    v_fmac_f32_dpp v50, v59, v70 row_newbcast:3 row_mask:0xf bank_mask:0xf
    v_fmac_f32_dpp v51, v59, v71 row_newbcast:3 row_mask:0xf bank_mask:0xf
    s_add_u32 s19, s17, 24576
    buffer_load_dwordx4 v[176:179], v2, s[8:11], s19 offen offset:0 nt
    buffer_load_dwordx4 v[180:183], v2, s[8:11], s19 offen offset:256 nt
    buffer_load_dwordx4 v[184:187], v2, s[8:11], s19 offen offset:512 nt
    buffer_load_dwordx4 v[188:191], v2, s[8:11], s19 offen offset:768 nt
    s_waitcnt vmcnt(28)
    v_mfma_f32_16x16x32_bf16 v[52:55], v[128:131], v[4:7], 0
    v_mfma_f32_16x16x32_bf16 v[52:55], v[132:135], v[8:11], v[52:55]
    v_mfma_f32_16x16x32_bf16 v[52:55], v[136:139], v[12:15], v[52:55]
    v_mfma_f32_16x16x32_bf16 v[52:55], v[140:143], v[16:19], v[52:55]
    s_add_u32 s18, s17, 28672
    buffer_load_dwordx4 v[128:131], v1, s[4:7], s18 offen offset:0 nt
    buffer_load_dwordx4 v[132:135], v1, s[4:7], s18 offen offset:64 nt
    buffer_load_dwordx4 v[136:139], v1, s[4:7], s18 offen offset:128 nt
    buffer_load_dwordx4 v[140:143], v1, s[4:7], s18 offen offset:192 nt
    s_nop 3
    s_nop 1
    v_max3_f32 v62, v52, v53, v54
    v_max3_f32 v62, v62, v55, v60
    v_cmp_gt_f32 vcc, v62, v60
    s_nop 1
    s_cbranch_vccz k2_attn_kernel_nr3
    v_sub_f32 v63, v60, v62
    v_mul_f32 v63, s21, v63
    v_exp_f32 v63, v63
    v_mov_b32 v60, v62
    v_mul_f32 v61, v61, v63
    s_nop 0
    v_mul_f32_dpp v20, v63, v20 row_newbcast:0 row_mask:0xf bank_mask:0xf
    v_mul_f32_dpp v21, v63, v21 row_newbcast:0 row_mask:0xf bank_mask:0xf
    v_mul_f32_dpp v22, v63, v22 row_newbcast:0 row_mask:0xf bank_mask:0xf
    v_mul_f32_dpp v23, v63, v23 row_newbcast:0 row_mask:0xf bank_mask:0xf
    v_mul_f32_dpp v24, v63, v24 row_newbcast:0 row_mask:0xf bank_mask:0xf
    v_mul_f32_dpp v25, v63, v25 row_newbcast:0 row_mask:0xf bank_mask:0xf
    v_mul_f32_dpp v26, v63, v26 row_newbcast:0 row_mask:0xf bank_mask:0xf
    v_mul_f32_dpp v27, v63, v27 row_newbcast:0 row_mask:0xf bank_mask:0xf
    v_mul_f32_dpp v28, v63, v28 row_newbcast:1 row_mask:0xf bank_mask:0xf
    v_mul_f32_dpp v29, v63, v29 row_newbcast:1 row_mask:0xf bank_mask:0xf
    v_mul_f32_dpp v30, v63, v30 row_newbcast:1 row_mask:0xf bank_mask:0xf
    v_mul_f32_dpp v31, v63, v31 row_newbcast:1 row_mask:0xf bank_mask:0xf
    v_mul_f32_dpp v32, v63, v32 row_newbcast:1 row_mask:0xf bank_mask:0xf
    v_mul_f32_dpp v33, v63, v33 row_newbcast:1 row_mask:0xf bank_mask:0xf
    v_mul_f32_dpp v34, v63, v34 row_newbcast:1 row_mask:0xf bank_mask:0xf
    v_mul_f32_dpp v35, v63, v35 row_newbcast:1 row_mask:0xf bank_mask:0xf
    v_mul_f32_dpp v36, v63, v36 row_newbcast:2 row_mask:0xf bank_mask:0xf
    v_mul_f32_dpp v37, v63, v37 row_newbcast:2 row_mask:0xf bank_mask:0xf
    v_mul_f32_dpp v38, v63, v38 row_newbcast:2 row_mask:0xf bank_mask:0xf
    v_mul_f32_dpp v39, v63, v39 row_newbcast:2 row_mask:0xf bank_mask:0xf
    v_mul_f32_dpp v40, v63, v40 row_newbcast:2 row_mask:0xf bank_mask:0xf
    v_mul_f32_dpp v41, v63, v41 row_newbcast:2 row_mask:0xf bank_mask:0xf
    v_mul_f32_dpp v42, v63, v42 row_newbcast:2 row_mask:0xf bank_mask:0xf
    v_mul_f32_dpp v43, v63, v43 row_newbcast:2 row_mask:0xf bank_mask:0xf
    v_mul_f32_dpp v44, v63, v44 row_newbcast:3 row_mask:0xf bank_mask:0xf
    v_mul_f32_dpp v45, v63, v45 row_newbcast:3 row_mask:0xf bank_mask:0xf
    v_mul_f32_dpp v46, v63, v46 row_newbcast:3 row_mask:0xf bank_mask:0xf
    v_mul_f32_dpp v47, v63, v47 row_newbcast:3 row_mask:0xf bank_mask:0xf
    v_mul_f32_dpp v48, v63, v48 row_newbcast:3 row_mask:0xf bank_mask:0xf
    v_mul_f32_dpp v49, v63, v49 row_newbcast:3 row_mask:0xf bank_mask:0xf
    v_mul_f32_dpp v50, v63, v50 row_newbcast:3 row_mask:0xf bank_mask:0xf
    v_mul_f32_dpp v51, v63, v51 row_newbcast:3 row_mask:0xf bank_mask:0xf
k2_attn_kernel_nr3:
    v_mul_f32 v72, s21, v60
    v_fma_f32 v56, v52, s21, -v72
    v_fma_f32 v57, v53, s21, -v72
    v_fma_f32 v58, v54, s21, -v72
    v_fma_f32 v59, v55, s21, -v72
    v_exp_f32 v56, v56
    v_exp_f32 v57, v57
    v_exp_f32 v58, v58
    v_exp_f32 v59, v59
    s_waitcnt vmcnt(28)
    v_add_f32 v62, v56, v57
    v_add_f32 v63, v58, v59
    v_add_f32 v61, v61, v62
    v_add_f32 v61, v61, v63
    v_lshlrev_b32 v64, 16, v192
    v_and_b32 v65, 0xffff0000, v192
    v_lshlrev_b32 v66, 16, v193
    v_and_b32 v67, 0xffff0000, v193
    v_lshlrev_b32 v68, 16, v194
    v_and_b32 v69, 0xffff0000, v194
    v_lshlrev_b32 v70, 16, v195
    v_and_b32 v71, 0xffff0000, v195
    v_fmac_f32_dpp v20, v56, v64 row_newbcast:0 row_mask:0xf bank_mask:0xf
    v_fmac_f32_dpp v21, v56, v65 row_newbcast:0 row_mask:0xf bank_mask:0xf
    v_fmac_f32_dpp v22, v56, v66 row_newbcast:0 row_mask:0xf bank_mask:0xf
    v_fmac_f32_dpp v23, v56, v67 row_newbcast:0 row_mask:0xf bank_mask:0xf
    v_fmac_f32_dpp v24, v56, v68 row_newbcast:0 row_mask:0xf bank_mask:0xf
    v_fmac_f32_dpp v25, v56, v69 row_newbcast:0 row_mask:0xf bank_mask:0xf
    v_fmac_f32_dpp v26, v56, v70 row_newbcast:0 row_mask:0xf bank_mask:0xf
    v_fmac_f32_dpp v27, v56, v71 row_newbcast:0 row_mask:0xf bank_mask:0xf
    v_fmac_f32_dpp v28, v56, v64 row_newbcast:1 row_mask:0xf bank_mask:0xf
    v_fmac_f32_dpp v29, v56, v65 row_newbcast:1 row_mask:0xf bank_mask:0xf
    v_fmac_f32_dpp v30, v56, v66 row_newbcast:1 row_mask:0xf bank_mask:0xf
    v_fmac_f32_dpp v31, v56, v67 row_newbcast:1 row_mask:0xf bank_mask:0xf
    v_fmac_f32_dpp v32, v56, v68 row_newbcast:1 row_mask:0xf bank_mask:0xf
    v_fmac_f32_dpp v33, v56, v69 row_newbcast:1 row_mask:0xf bank_mask:0xf
    v_fmac_f32_dpp v34, v56, v70 row_newbcast:1 row_mask:0xf bank_mask:0xf
    v_fmac_f32_dpp v35, v56, v71 row_newbcast:1 row_mask:0xf bank_mask:0xf
    v_fmac_f32_dpp v36, v56, v64 row_newbcast:2 row_mask:0xf bank_mask:0xf
    v_fmac_f32_dpp v37, v56, v65 row_newbcast:2 row_mask:0xf bank_mask:0xf
    v_fmac_f32_dpp v38, v56, v66 row_newbcast:2 row_mask:0xf bank_mask:0xf
    v_fmac_f32_dpp v39, v56, v67 row_newbcast:2 row_mask:0xf bank_mask:0xf
    v_fmac_f32_dpp v40, v56, v68 row_newbcast:2 row_mask:0xf bank_mask:0xf
    v_fmac_f32_dpp v41, v56, v69 row_newbcast:2 row_mask:0xf bank_mask:0xf
    v_fmac_f32_dpp v42, v56, v70 row_newbcast:2 row_mask:0xf bank_mask:0xf
    v_fmac_f32_dpp v43, v56, v71 row_newbcast:2 row_mask:0xf bank_mask:0xf
    v_fmac_f32_dpp v44, v56, v64 row_newbcast:3 row_mask:0xf bank_mask:0xf
    v_fmac_f32_dpp v45, v56, v65 row_newbcast:3 row_mask:0xf bank_mask:0xf
    v_fmac_f32_dpp v46, v56, v66 row_newbcast:3 row_mask:0xf bank_mask:0xf
    v_fmac_f32_dpp v47, v56, v67 row_newbcast:3 row_mask:0xf bank_mask:0xf
    v_fmac_f32_dpp v48, v56, v68 row_newbcast:3 row_mask:0xf bank_mask:0xf
    v_fmac_f32_dpp v49, v56, v69 row_newbcast:3 row_mask:0xf bank_mask:0xf
    v_fmac_f32_dpp v50, v56, v70 row_newbcast:3 row_mask:0xf bank_mask:0xf
    v_fmac_f32_dpp v51, v56, v71 row_newbcast:3 row_mask:0xf bank_mask:0xf
    v_lshlrev_b32 v64, 16, v196
    v_and_b32 v65, 0xffff0000, v196
    v_lshlrev_b32 v66, 16, v197
    v_and_b32 v67, 0xffff0000, v197
    v_lshlrev_b32 v68, 16, v198
    v_and_b32 v69, 0xffff0000, v198
    v_lshlrev_b32 v70, 16, v199
    v_and_b32 v71, 0xffff0000, v199
    v_fmac_f32_dpp v20, v57, v64 row_newbcast:0 row_mask:0xf bank_mask:0xf
    v_fmac_f32_dpp v21, v57, v65 row_newbcast:0 row_mask:0xf bank_mask:0xf
    v_fmac_f32_dpp v22, v57, v66 row_newbcast:0 row_mask:0xf bank_mask:0xf
    v_fmac_f32_dpp v23, v57, v67 row_newbcast:0 row_mask:0xf bank_mask:0xf
    v_fmac_f32_dpp v24, v57, v68 row_newbcast:0 row_mask:0xf bank_mask:0xf
    v_fmac_f32_dpp v25, v57, v69 row_newbcast:0 row_mask:0xf bank_mask:0xf
    v_fmac_f32_dpp v26, v57, v70 row_newbcast:0 row_mask:0xf bank_mask:0xf
    v_fmac_f32_dpp v27, v57, v71 row_newbcast:0 row_mask:0xf bank_mask:0xf
    v_fmac_f32_dpp v28, v57, v64 row_newbcast:1 row_mask:0xf bank_mask:0xf
    v_fmac_f32_dpp v29, v57, v65 row_newbcast:1 row_mask:0xf bank_mask:0xf
    v_fmac_f32_dpp v30, v57, v66 row_newbcast:1 row_mask:0xf bank_mask:0xf
    v_fmac_f32_dpp v31, v57, v67 row_newbcast:1 row_mask:0xf bank_mask:0xf
    v_fmac_f32_dpp v32, v57, v68 row_newbcast:1 row_mask:0xf bank_mask:0xf
    v_fmac_f32_dpp v33, v57, v69 row_newbcast:1 row_mask:0xf bank_mask:0xf
    v_fmac_f32_dpp v34, v57, v70 row_newbcast:1 row_mask:0xf bank_mask:0xf
    v_fmac_f32_dpp v35, v57, v71 row_newbcast:1 row_mask:0xf bank_mask:0xf
    v_fmac_f32_dpp v36, v57, v64 row_newbcast:2 row_mask:0xf bank_mask:0xf
    v_fmac_f32_dpp v37, v57, v65 row_newbcast:2 row_mask:0xf bank_mask:0xf
    v_fmac_f32_dpp v38, v57, v66 row_newbcast:2 row_mask:0xf bank_mask:0xf
    v_fmac_f32_dpp v39, v57, v67 row_newbcast:2 row_mask:0xf bank_mask:0xf
    v_fmac_f32_dpp v40, v57, v68 row_newbcast:2 row_mask:0xf bank_mask:0xf
    v_fmac_f32_dpp v41, v57, v69 row_newbcast:2 row_mask:0xf bank_mask:0xf
    v_fmac_f32_dpp v42, v57, v70 row_newbcast:2 row_mask:0xf bank_mask:0xf
    v_fmac_f32_dpp v43, v57, v71 row_newbcast:2 row_mask:0xf bank_mask:0xf
    v_fmac_f32_dpp v44, v57, v64 row_newbcast:3 row_mask:0xf bank_mask:0xf
    v_fmac_f32_dpp v45, v57, v65 row_newbcast:3 row_mask:0xf bank_mask:0xf
    v_fmac_f32_dpp v46, v57, v66 row_newbcast:3 row_mask:0xf bank_mask:0xf
    v_fmac_f32_dpp v47, v57, v67 row_newbcast:3 row_mask:0xf bank_mask:0xf
    v_fmac_f32_dpp v48, v57, v68 row_newbcast:3 row_mask:0xf bank_mask:0xf
    v_fmac_f32_dpp v49, v57, v69 row_newbcast:3 row_mask:0xf bank_mask:0xf
    v_fmac_f32_dpp v50, v57, v70 row_newbcast:3 row_mask:0xf bank_mask:0xf
    v_fmac_f32_dpp v51, v57, v71 row_newbcast:3 row_mask:0xf bank_mask:0xf
    v_lshlrev_b32 v64, 16, v200
    v_and_b32 v65, 0xffff0000, v200
    v_lshlrev_b32 v66, 16, v201
    v_and_b32 v67, 0xffff0000, v201
    v_lshlrev_b32 v68, 16, v202
    v_and_b32 v69, 0xffff0000, v202
    v_lshlrev_b32 v70, 16, v203
    v_and_b32 v71, 0xffff0000, v203
    v_fmac_f32_dpp v20, v58, v64 row_newbcast:0 row_mask:0xf bank_mask:0xf
    v_fmac_f32_dpp v21, v58, v65 row_newbcast:0 row_mask:0xf bank_mask:0xf
    v_fmac_f32_dpp v22, v58, v66 row_newbcast:0 row_mask:0xf bank_mask:0xf
    v_fmac_f32_dpp v23, v58, v67 row_newbcast:0 row_mask:0xf bank_mask:0xf
    v_fmac_f32_dpp v24, v58, v68 row_newbcast:0 row_mask:0xf bank_mask:0xf
    v_fmac_f32_dpp v25, v58, v69 row_newbcast:0 row_mask:0xf bank_mask:0xf
    v_fmac_f32_dpp v26, v58, v70 row_newbcast:0 row_mask:0xf bank_mask:0xf
    v_fmac_f32_dpp v27, v58, v71 row_newbcast:0 row_mask:0xf bank_mask:0xf
    v_fmac_f32_dpp v28, v58, v64 row_newbcast:1 row_mask:0xf bank_mask:0xf
    v_fmac_f32_dpp v29, v58, v65 row_newbcast:1 row_mask:0xf bank_mask:0xf
    v_fmac_f32_dpp v30, v58, v66 row_newbcast:1 row_mask:0xf bank_mask:0xf
    v_fmac_f32_dpp v31, v58, v67 row_newbcast:1 row_mask:0xf bank_mask:0xf
    v_fmac_f32_dpp v32, v58, v68 row_newbcast:1 row_mask:0xf bank_mask:0xf
    v_fmac_f32_dpp v33, v58, v69 row_newbcast:1 row_mask:0xf bank_mask:0xf
    v_fmac_f32_dpp v34, v58, v70 row_newbcast:1 row_mask:0xf bank_mask:0xf
    v_fmac_f32_dpp v35, v58, v71 row_newbcast:1 row_mask:0xf bank_mask:0xf
    v_fmac_f32_dpp v36, v58, v64 row_newbcast:2 row_mask:0xf bank_mask:0xf
    v_fmac_f32_dpp v37, v58, v65 row_newbcast:2 row_mask:0xf bank_mask:0xf
    v_fmac_f32_dpp v38, v58, v66 row_newbcast:2 row_mask:0xf bank_mask:0xf
    v_fmac_f32_dpp v39, v58, v67 row_newbcast:2 row_mask:0xf bank_mask:0xf
    v_fmac_f32_dpp v40, v58, v68 row_newbcast:2 row_mask:0xf bank_mask:0xf
    v_fmac_f32_dpp v41, v58, v69 row_newbcast:2 row_mask:0xf bank_mask:0xf
    v_fmac_f32_dpp v42, v58, v70 row_newbcast:2 row_mask:0xf bank_mask:0xf
    v_fmac_f32_dpp v43, v58, v71 row_newbcast:2 row_mask:0xf bank_mask:0xf
    v_fmac_f32_dpp v44, v58, v64 row_newbcast:3 row_mask:0xf bank_mask:0xf
    v_fmac_f32_dpp v45, v58, v65 row_newbcast:3 row_mask:0xf bank_mask:0xf
    v_fmac_f32_dpp v46, v58, v66 row_newbcast:3 row_mask:0xf bank_mask:0xf
    v_fmac_f32_dpp v47, v58, v67 row_newbcast:3 row_mask:0xf bank_mask:0xf
    v_fmac_f32_dpp v48, v58, v68 row_newbcast:3 row_mask:0xf bank_mask:0xf
    v_fmac_f32_dpp v49, v58, v69 row_newbcast:3 row_mask:0xf bank_mask:0xf
    v_fmac_f32_dpp v50, v58, v70 row_newbcast:3 row_mask:0xf bank_mask:0xf
    v_fmac_f32_dpp v51, v58, v71 row_newbcast:3 row_mask:0xf bank_mask:0xf
    v_lshlrev_b32 v64, 16, v204
    v_and_b32 v65, 0xffff0000, v204
    v_lshlrev_b32 v66, 16, v205
    v_and_b32 v67, 0xffff0000, v205
    v_lshlrev_b32 v68, 16, v206
    v_and_b32 v69, 0xffff0000, v206
    v_lshlrev_b32 v70, 16, v207
    v_and_b32 v71, 0xffff0000, v207
    v_fmac_f32_dpp v20, v59, v64 row_newbcast:0 row_mask:0xf bank_mask:0xf
    v_fmac_f32_dpp v21, v59, v65 row_newbcast:0 row_mask:0xf bank_mask:0xf
    v_fmac_f32_dpp v22, v59, v66 row_newbcast:0 row_mask:0xf bank_mask:0xf
    v_fmac_f32_dpp v23, v59, v67 row_newbcast:0 row_mask:0xf bank_mask:0xf
    v_fmac_f32_dpp v24, v59, v68 row_newbcast:0 row_mask:0xf bank_mask:0xf
    v_fmac_f32_dpp v25, v59, v69 row_newbcast:0 row_mask:0xf bank_mask:0xf
    v_fmac_f32_dpp v26, v59, v70 row_newbcast:0 row_mask:0xf bank_mask:0xf
    v_fmac_f32_dpp v27, v59, v71 row_newbcast:0 row_mask:0xf bank_mask:0xf
    v_fmac_f32_dpp v28, v59, v64 row_newbcast:1 row_mask:0xf bank_mask:0xf
    v_fmac_f32_dpp v29, v59, v65 row_newbcast:1 row_mask:0xf bank_mask:0xf
    v_fmac_f32_dpp v30, v59, v66 row_newbcast:1 row_mask:0xf bank_mask:0xf
    v_fmac_f32_dpp v31, v59, v67 row_newbcast:1 row_mask:0xf bank_mask:0xf
    v_fmac_f32_dpp v32, v59, v68 row_newbcast:1 row_mask:0xf bank_mask:0xf
    v_fmac_f32_dpp v33, v59, v69 row_newbcast:1 row_mask:0xf bank_mask:0xf
    v_fmac_f32_dpp v34, v59, v70 row_newbcast:1 row_mask:0xf bank_mask:0xf
    v_fmac_f32_dpp v35, v59, v71 row_newbcast:1 row_mask:0xf bank_mask:0xf
    v_fmac_f32_dpp v36, v59, v64 row_newbcast:2 row_mask:0xf bank_mask:0xf
    v_fmac_f32_dpp v37, v59, v65 row_newbcast:2 row_mask:0xf bank_mask:0xf
    v_fmac_f32_dpp v38, v59, v66 row_newbcast:2 row_mask:0xf bank_mask:0xf
    v_fmac_f32_dpp v39, v59, v67 row_newbcast:2 row_mask:0xf bank_mask:0xf
    v_fmac_f32_dpp v40, v59, v68 row_newbcast:2 row_mask:0xf bank_mask:0xf
    v_fmac_f32_dpp v41, v59, v69 row_newbcast:2 row_mask:0xf bank_mask:0xf
    v_fmac_f32_dpp v42, v59, v70 row_newbcast:2 row_mask:0xf bank_mask:0xf
    v_fmac_f32_dpp v43, v59, v71 row_newbcast:2 row_mask:0xf bank_mask:0xf
    v_fmac_f32_dpp v44, v59, v64 row_newbcast:3 row_mask:0xf bank_mask:0xf
    v_fmac_f32_dpp v45, v59, v65 row_newbcast:3 row_mask:0xf bank_mask:0xf
    v_fmac_f32_dpp v46, v59, v66 row_newbcast:3 row_mask:0xf bank_mask:0xf
    v_fmac_f32_dpp v47, v59, v67 row_newbcast:3 row_mask:0xf bank_mask:0xf
    v_fmac_f32_dpp v48, v59, v68 row_newbcast:3 row_mask:0xf bank_mask:0xf
    v_fmac_f32_dpp v49, v59, v69 row_newbcast:3 row_mask:0xf bank_mask:0xf
    v_fmac_f32_dpp v50, v59, v70 row_newbcast:3 row_mask:0xf bank_mask:0xf
    v_fmac_f32_dpp v51, v59, v71 row_newbcast:3 row_mask:0xf bank_mask:0xf
    s_add_u32 s19, s17, 28672
    buffer_load_dwordx4 v[192:195], v2, s[8:11], s19 offen offset:0 nt
    buffer_load_dwordx4 v[196:199], v2, s[8:11], s19 offen offset:256 nt
    buffer_load_dwordx4 v[200:203], v2, s[8:11], s19 offen offset:512 nt
    buffer_load_dwordx4 v[204:207], v2, s[8:11], s19 offen offset:768 nt
    s_waitcnt vmcnt(28)
    v_mfma_f32_16x16x32_bf16 v[52:55], v[80:83], v[4:7], 0
    v_mfma_f32_16x16x32_bf16 v[52:55], v[84:87], v[8:11], v[52:55]
    v_mfma_f32_16x16x32_bf16 v[52:55], v[88:91], v[12:15], v[52:55]
    v_mfma_f32_16x16x32_bf16 v[52:55], v[92:95], v[16:19], v[52:55]
    s_add_u32 s18, s17, 32768
    buffer_load_dwordx4 v[80:83], v1, s[4:7], s18 offen offset:0 nt
    buffer_load_dwordx4 v[84:87], v1, s[4:7], s18 offen offset:64 nt
    buffer_load_dwordx4 v[88:91], v1, s[4:7], s18 offen offset:128 nt
    buffer_load_dwordx4 v[92:95], v1, s[4:7], s18 offen offset:192 nt
    s_nop 3
    s_nop 1
    v_max3_f32 v62, v52, v53, v54
    v_max3_f32 v62, v62, v55, v60
    v_cmp_gt_f32 vcc, v62, v60
    s_nop 1
    s_cbranch_vccz k2_attn_kernel_nr4
    v_sub_f32 v63, v60, v62
    v_mul_f32 v63, s21, v63
    v_exp_f32 v63, v63
    v_mov_b32 v60, v62
    v_mul_f32 v61, v61, v63
    s_nop 0
    v_mul_f32_dpp v20, v63, v20 row_newbcast:0 row_mask:0xf bank_mask:0xf
    v_mul_f32_dpp v21, v63, v21 row_newbcast:0 row_mask:0xf bank_mask:0xf
    v_mul_f32_dpp v22, v63, v22 row_newbcast:0 row_mask:0xf bank_mask:0xf
    v_mul_f32_dpp v23, v63, v23 row_newbcast:0 row_mask:0xf bank_mask:0xf
    v_mul_f32_dpp v24, v63, v24 row_newbcast:0 row_mask:0xf bank_mask:0xf
    v_mul_f32_dpp v25, v63, v25 row_newbcast:0 row_mask:0xf bank_mask:0xf
    v_mul_f32_dpp v26, v63, v26 row_newbcast:0 row_mask:0xf bank_mask:0xf
    v_mul_f32_dpp v27, v63, v27 row_newbcast:0 row_mask:0xf bank_mask:0xf
    v_mul_f32_dpp v28, v63, v28 row_newbcast:1 row_mask:0xf bank_mask:0xf
    v_mul_f32_dpp v29, v63, v29 row_newbcast:1 row_mask:0xf bank_mask:0xf
    v_mul_f32_dpp v30, v63, v30 row_newbcast:1 row_mask:0xf bank_mask:0xf
    v_mul_f32_dpp v31, v63, v31 row_newbcast:1 row_mask:0xf bank_mask:0xf
    v_mul_f32_dpp v32, v63, v32 row_newbcast:1 row_mask:0xf bank_mask:0xf
    v_mul_f32_dpp v33, v63, v33 row_newbcast:1 row_mask:0xf bank_mask:0xf
    v_mul_f32_dpp v34, v63, v34 row_newbcast:1 row_mask:0xf bank_mask:0xf
    v_mul_f32_dpp v35, v63, v35 row_newbcast:1 row_mask:0xf bank_mask:0xf
    v_mul_f32_dpp v36, v63, v36 row_newbcast:2 row_mask:0xf bank_mask:0xf
    v_mul_f32_dpp v37, v63, v37 row_newbcast:2 row_mask:0xf bank_mask:0xf
    v_mul_f32_dpp v38, v63, v38 row_newbcast:2 row_mask:0xf bank_mask:0xf
    v_mul_f32_dpp v39, v63, v39 row_newbcast:2 row_mask:0xf bank_mask:0xf
    v_mul_f32_dpp v40, v63, v40 row_newbcast:2 row_mask:0xf bank_mask:0xf
    v_mul_f32_dpp v41, v63, v41 row_newbcast:2 row_mask:0xf bank_mask:0xf
    v_mul_f32_dpp v42, v63, v42 row_newbcast:2 row_mask:0xf bank_mask:0xf
    v_mul_f32_dpp v43, v63, v43 row_newbcast:2 row_mask:0xf bank_mask:0xf
    v_mul_f32_dpp v44, v63, v44 row_newbcast:3 row_mask:0xf bank_mask:0xf
    v_mul_f32_dpp v45, v63, v45 row_newbcast:3 row_mask:0xf bank_mask:0xf
    v_mul_f32_dpp v46, v63, v46 row_newbcast:3 row_mask:0xf bank_mask:0xf
    v_mul_f32_dpp v47, v63, v47 row_newbcast:3 row_mask:0xf bank_mask:0xf
    v_mul_f32_dpp v48, v63, v48 row_newbcast:3 row_mask:0xf bank_mask:0xf
    v_mul_f32_dpp v49, v63, v49 row_newbcast:3 row_mask:0xf bank_mask:0xf
    v_mul_f32_dpp v50, v63, v50 row_newbcast:3 row_mask:0xf bank_mask:0xf
    v_mul_f32_dpp v51, v63, v51 row_newbcast:3 row_mask:0xf bank_mask:0xf
k2_attn_kernel_nr4:
    v_mul_f32 v72, s21, v60
    v_fma_f32 v56, v52, s21, -v72
    v_fma_f32 v57, v53, s21, -v72
    v_fma_f32 v58, v54, s21, -v72
    v_fma_f32 v59, v55, s21, -v72
    v_exp_f32 v56, v56
    v_exp_f32 v57, v57
    v_exp_f32 v58, v58
    v_exp_f32 v59, v59
    s_waitcnt vmcnt(28)
    v_add_f32 v62, v56, v57
    v_add_f32 v63, v58, v59
    v_add_f32 v61, v61, v62
    v_add_f32 v61, v61, v63
    v_lshlrev_b32 v64, 16, v144
    v_and_b32 v65, 0xffff0000, v144
    v_lshlrev_b32 v66, 16, v145
    v_and_b32 v67, 0xffff0000, v145
    v_lshlrev_b32 v68, 16, v146
    v_and_b32 v69, 0xffff0000, v146
    v_lshlrev_b32 v70, 16, v147
    v_and_b32 v71, 0xffff0000, v147
    v_fmac_f32_dpp v20, v56, v64 row_newbcast:0 row_mask:0xf bank_mask:0xf
    v_fmac_f32_dpp v21, v56, v65 row_newbcast:0 row_mask:0xf bank_mask:0xf
    v_fmac_f32_dpp v22, v56, v66 row_newbcast:0 row_mask:0xf bank_mask:0xf
    v_fmac_f32_dpp v23, v56, v67 row_newbcast:0 row_mask:0xf bank_mask:0xf
    v_fmac_f32_dpp v24, v56, v68 row_newbcast:0 row_mask:0xf bank_mask:0xf
    v_fmac_f32_dpp v25, v56, v69 row_newbcast:0 row_mask:0xf bank_mask:0xf
    v_fmac_f32_dpp v26, v56, v70 row_newbcast:0 row_mask:0xf bank_mask:0xf
    v_fmac_f32_dpp v27, v56, v71 row_newbcast:0 row_mask:0xf bank_mask:0xf
    v_fmac_f32_dpp v28, v56, v64 row_newbcast:1 row_mask:0xf bank_mask:0xf
    v_fmac_f32_dpp v29, v56, v65 row_newbcast:1 row_mask:0xf bank_mask:0xf
    v_fmac_f32_dpp v30, v56, v66 row_newbcast:1 row_mask:0xf bank_mask:0xf
    v_fmac_f32_dpp v31, v56, v67 row_newbcast:1 row_mask:0xf bank_mask:0xf
    v_fmac_f32_dpp v32, v56, v68 row_newbcast:1 row_mask:0xf bank_mask:0xf
    v_fmac_f32_dpp v33, v56, v69 row_newbcast:1 row_mask:0xf bank_mask:0xf
    v_fmac_f32_dpp v34, v56, v70 row_newbcast:1 row_mask:0xf bank_mask:0xf
    v_fmac_f32_dpp v35, v56, v71 row_newbcast:1 row_mask:0xf bank_mask:0xf
    v_fmac_f32_dpp v36, v56, v64 row_newbcast:2 row_mask:0xf bank_mask:0xf
    v_fmac_f32_dpp v37, v56, v65 row_newbcast:2 row_mask:0xf bank_mask:0xf
    v_fmac_f32_dpp v38, v56, v66 row_newbcast:2 row_mask:0xf bank_mask:0xf
    v_fmac_f32_dpp v39, v56, v67 row_newbcast:2 row_mask:0xf bank_mask:0xf
    v_fmac_f32_dpp v40, v56, v68 row_newbcast:2 row_mask:0xf bank_mask:0xf
    v_fmac_f32_dpp v41, v56, v69 row_newbcast:2 row_mask:0xf bank_mask:0xf
    v_fmac_f32_dpp v42, v56, v70 row_newbcast:2 row_mask:0xf bank_mask:0xf
    v_fmac_f32_dpp v43, v56, v71 row_newbcast:2 row_mask:0xf bank_mask:0xf
    v_fmac_f32_dpp v44, v56, v64 row_newbcast:3 row_mask:0xf bank_mask:0xf
    v_fmac_f32_dpp v45, v56, v65 row_newbcast:3 row_mask:0xf bank_mask:0xf
    v_fmac_f32_dpp v46, v56, v66 row_newbcast:3 row_mask:0xf bank_mask:0xf
    v_fmac_f32_dpp v47, v56, v67 row_newbcast:3 row_mask:0xf bank_mask:0xf
    v_fmac_f32_dpp v48, v56, v68 row_newbcast:3 row_mask:0xf bank_mask:0xf
    v_fmac_f32_dpp v49, v56, v69 row_newbcast:3 row_mask:0xf bank_mask:0xf
    v_fmac_f32_dpp v50, v56, v70 row_newbcast:3 row_mask:0xf bank_mask:0xf
    v_fmac_f32_dpp v51, v56, v71 row_newbcast:3 row_mask:0xf bank_mask:0xf
    v_lshlrev_b32 v64, 16, v148
    v_and_b32 v65, 0xffff0000, v148
    v_lshlrev_b32 v66, 16, v149
    v_and_b32 v67, 0xffff0000, v149
    v_lshlrev_b32 v68, 16, v150
    v_and_b32 v69, 0xffff0000, v150
    v_lshlrev_b32 v70, 16, v151
    v_and_b32 v71, 0xffff0000, v151
    v_fmac_f32_dpp v20, v57, v64 row_newbcast:0 row_mask:0xf bank_mask:0xf
    v_fmac_f32_dpp v21, v57, v65 row_newbcast:0 row_mask:0xf bank_mask:0xf
    v_fmac_f32_dpp v22, v57, v66 row_newbcast:0 row_mask:0xf bank_mask:0xf
    v_fmac_f32_dpp v23, v57, v67 row_newbcast:0 row_mask:0xf bank_mask:0xf
    v_fmac_f32_dpp v24, v57, v68 row_newbcast:0 row_mask:0xf bank_mask:0xf
    v_fmac_f32_dpp v25, v57, v69 row_newbcast:0 row_mask:0xf bank_mask:0xf
    v_fmac_f32_dpp v26, v57, v70 row_newbcast:0 row_mask:0xf bank_mask:0xf
    v_fmac_f32_dpp v27, v57, v71 row_newbcast:0 row_mask:0xf bank_mask:0xf
    v_fmac_f32_dpp v28, v57, v64 row_newbcast:1 row_mask:0xf bank_mask:0xf
    v_fmac_f32_dpp v29, v57, v65 row_newbcast:1 row_mask:0xf bank_mask:0xf
    v_fmac_f32_dpp v30, v57, v66 row_newbcast:1 row_mask:0xf bank_mask:0xf
    v_fmac_f32_dpp v31, v57, v67 row_newbcast:1 row_mask:0xf bank_mask:0xf
    v_fmac_f32_dpp v32, v57, v68 row_newbcast:1 row_mask:0xf bank_mask:0xf
    v_fmac_f32_dpp v33, v57, v69 row_newbcast:1 row_mask:0xf bank_mask:0xf
    v_fmac_f32_dpp v34, v57, v70 row_newbcast:1 row_mask:0xf bank_mask:0xf
    v_fmac_f32_dpp v35, v57, v71 row_newbcast:1 row_mask:0xf bank_mask:0xf
    v_fmac_f32_dpp v36, v57, v64 row_newbcast:2 row_mask:0xf bank_mask:0xf
    v_fmac_f32_dpp v37, v57, v65 row_newbcast:2 row_mask:0xf bank_mask:0xf
    v_fmac_f32_dpp v38, v57, v66 row_newbcast:2 row_mask:0xf bank_mask:0xf
    v_fmac_f32_dpp v39, v57, v67 row_newbcast:2 row_mask:0xf bank_mask:0xf
    v_fmac_f32_dpp v40, v57, v68 row_newbcast:2 row_mask:0xf bank_mask:0xf
    v_fmac_f32_dpp v41, v57, v69 row_newbcast:2 row_mask:0xf bank_mask:0xf
    v_fmac_f32_dpp v42, v57, v70 row_newbcast:2 row_mask:0xf bank_mask:0xf
    v_fmac_f32_dpp v43, v57, v71 row_newbcast:2 row_mask:0xf bank_mask:0xf
    v_fmac_f32_dpp v44, v57, v64 row_newbcast:3 row_mask:0xf bank_mask:0xf
    v_fmac_f32_dpp v45, v57, v65 row_newbcast:3 row_mask:0xf bank_mask:0xf
    v_fmac_f32_dpp v46, v57, v66 row_newbcast:3 row_mask:0xf bank_mask:0xf
    v_fmac_f32_dpp v47, v57, v67 row_newbcast:3 row_mask:0xf bank_mask:0xf
    v_fmac_f32_dpp v48, v57, v68 row_newbcast:3 row_mask:0xf bank_mask:0xf
    v_fmac_f32_dpp v49, v57, v69 row_newbcast:3 row_mask:0xf bank_mask:0xf
    v_fmac_f32_dpp v50, v57, v70 row_newbcast:3 row_mask:0xf bank_mask:0xf
    v_fmac_f32_dpp v51, v57, v71 row_newbcast:3 row_mask:0xf bank_mask:0xf
    v_lshlrev_b32 v64, 16, v152
    v_and_b32 v65, 0xffff0000, v152
    v_lshlrev_b32 v66, 16, v153
    v_and_b32 v67, 0xffff0000, v153
    v_lshlrev_b32 v68, 16, v154
    v_and_b32 v69, 0xffff0000, v154
    v_lshlrev_b32 v70, 16, v155
    v_and_b32 v71, 0xffff0000, v155
    v_fmac_f32_dpp v20, v58, v64 row_newbcast:0 row_mask:0xf bank_mask:0xf
    v_fmac_f32_dpp v21, v58, v65 row_newbcast:0 row_mask:0xf bank_mask:0xf
    v_fmac_f32_dpp v22, v58, v66 row_newbcast:0 row_mask:0xf bank_mask:0xf
    v_fmac_f32_dpp v23, v58, v67 row_newbcast:0 row_mask:0xf bank_mask:0xf
    v_fmac_f32_dpp v24, v58, v68 row_newbcast:0 row_mask:0xf bank_mask:0xf
    v_fmac_f32_dpp v25, v58, v69 row_newbcast:0 row_mask:0xf bank_mask:0xf
    v_fmac_f32_dpp v26, v58, v70 row_newbcast:0 row_mask:0xf bank_mask:0xf
    v_fmac_f32_dpp v27, v58, v71 row_newbcast:0 row_mask:0xf bank_mask:0xf
    v_fmac_f32_dpp v28, v58, v64 row_newbcast:1 row_mask:0xf bank_mask:0xf
    v_fmac_f32_dpp v29, v58, v65 row_newbcast:1 row_mask:0xf bank_mask:0xf
    v_fmac_f32_dpp v30, v58, v66 row_newbcast:1 row_mask:0xf bank_mask:0xf
    v_fmac_f32_dpp v31, v58, v67 row_newbcast:1 row_mask:0xf bank_mask:0xf
    v_fmac_f32_dpp v32, v58, v68 row_newbcast:1 row_mask:0xf bank_mask:0xf
    v_fmac_f32_dpp v33, v58, v69 row_newbcast:1 row_mask:0xf bank_mask:0xf
    v_fmac_f32_dpp v34, v58, v70 row_newbcast:1 row_mask:0xf bank_mask:0xf
    v_fmac_f32_dpp v35, v58, v71 row_newbcast:1 row_mask:0xf bank_mask:0xf
    v_fmac_f32_dpp v36, v58, v64 row_newbcast:2 row_mask:0xf bank_mask:0xf
    v_fmac_f32_dpp v37, v58, v65 row_newbcast:2 row_mask:0xf bank_mask:0xf
    v_fmac_f32_dpp v38, v58, v66 row_newbcast:2 row_mask:0xf bank_mask:0xf
    v_fmac_f32_dpp v39, v58, v67 row_newbcast:2 row_mask:0xf bank_mask:0xf
    v_fmac_f32_dpp v40, v58, v68 row_newbcast:2 row_mask:0xf bank_mask:0xf
    v_fmac_f32_dpp v41, v58, v69 row_newbcast:2 row_mask:0xf bank_mask:0xf
    v_fmac_f32_dpp v42, v58, v70 row_newbcast:2 row_mask:0xf bank_mask:0xf
    v_fmac_f32_dpp v43, v58, v71 row_newbcast:2 row_mask:0xf bank_mask:0xf
    v_fmac_f32_dpp v44, v58, v64 row_newbcast:3 row_mask:0xf bank_mask:0xf
    v_fmac_f32_dpp v45, v58, v65 row_newbcast:3 row_mask:0xf bank_mask:0xf
    v_fmac_f32_dpp v46, v58, v66 row_newbcast:3 row_mask:0xf bank_mask:0xf
    v_fmac_f32_dpp v47, v58, v67 row_newbcast:3 row_mask:0xf bank_mask:0xf
    v_fmac_f32_dpp v48, v58, v68 row_newbcast:3 row_mask:0xf bank_mask:0xf
    v_fmac_f32_dpp v49, v58, v69 row_newbcast:3 row_mask:0xf bank_mask:0xf
    v_fmac_f32_dpp v50, v58, v70 row_newbcast:3 row_mask:0xf bank_mask:0xf
    v_fmac_f32_dpp v51, v58, v71 row_newbcast:3 row_mask:0xf bank_mask:0xf
    v_lshlrev_b32 v64, 16, v156
    v_and_b32 v65, 0xffff0000, v156
    v_lshlrev_b32 v66, 16, v157
    v_and_b32 v67, 0xffff0000, v157
    v_lshlrev_b32 v68, 16, v158
    v_and_b32 v69, 0xffff0000, v158
    v_lshlrev_b32 v70, 16, v159
    v_and_b32 v71, 0xffff0000, v159
    v_fmac_f32_dpp v20, v59, v64 row_newbcast:0 row_mask:0xf bank_mask:0xf
    v_fmac_f32_dpp v21, v59, v65 row_newbcast:0 row_mask:0xf bank_mask:0xf
    v_fmac_f32_dpp v22, v59, v66 row_newbcast:0 row_mask:0xf bank_mask:0xf
    v_fmac_f32_dpp v23, v59, v67 row_newbcast:0 row_mask:0xf bank_mask:0xf
    v_fmac_f32_dpp v24, v59, v68 row_newbcast:0 row_mask:0xf bank_mask:0xf
    v_fmac_f32_dpp v25, v59, v69 row_newbcast:0 row_mask:0xf bank_mask:0xf
    v_fmac_f32_dpp v26, v59, v70 row_newbcast:0 row_mask:0xf bank_mask:0xf
    v_fmac_f32_dpp v27, v59, v71 row_newbcast:0 row_mask:0xf bank_mask:0xf
    v_fmac_f32_dpp v28, v59, v64 row_newbcast:1 row_mask:0xf bank_mask:0xf
    v_fmac_f32_dpp v29, v59, v65 row_newbcast:1 row_mask:0xf bank_mask:0xf
    v_fmac_f32_dpp v30, v59, v66 row_newbcast:1 row_mask:0xf bank_mask:0xf
    v_fmac_f32_dpp v31, v59, v67 row_newbcast:1 row_mask:0xf bank_mask:0xf
    v_fmac_f32_dpp v32, v59, v68 row_newbcast:1 row_mask:0xf bank_mask:0xf
    v_fmac_f32_dpp v33, v59, v69 row_newbcast:1 row_mask:0xf bank_mask:0xf
    v_fmac_f32_dpp v34, v59, v70 row_newbcast:1 row_mask:0xf bank_mask:0xf
    v_fmac_f32_dpp v35, v59, v71 row_newbcast:1 row_mask:0xf bank_mask:0xf
    v_fmac_f32_dpp v36, v59, v64 row_newbcast:2 row_mask:0xf bank_mask:0xf
    v_fmac_f32_dpp v37, v59, v65 row_newbcast:2 row_mask:0xf bank_mask:0xf
    v_fmac_f32_dpp v38, v59, v66 row_newbcast:2 row_mask:0xf bank_mask:0xf
    v_fmac_f32_dpp v39, v59, v67 row_newbcast:2 row_mask:0xf bank_mask:0xf
    v_fmac_f32_dpp v40, v59, v68 row_newbcast:2 row_mask:0xf bank_mask:0xf
    v_fmac_f32_dpp v41, v59, v69 row_newbcast:2 row_mask:0xf bank_mask:0xf
    v_fmac_f32_dpp v42, v59, v70 row_newbcast:2 row_mask:0xf bank_mask:0xf
    v_fmac_f32_dpp v43, v59, v71 row_newbcast:2 row_mask:0xf bank_mask:0xf
    v_fmac_f32_dpp v44, v59, v64 row_newbcast:3 row_mask:0xf bank_mask:0xf
    v_fmac_f32_dpp v45, v59, v65 row_newbcast:3 row_mask:0xf bank_mask:0xf
    v_fmac_f32_dpp v46, v59, v66 row_newbcast:3 row_mask:0xf bank_mask:0xf
    v_fmac_f32_dpp v47, v59, v67 row_newbcast:3 row_mask:0xf bank_mask:0xf
    v_fmac_f32_dpp v48, v59, v68 row_newbcast:3 row_mask:0xf bank_mask:0xf
    v_fmac_f32_dpp v49, v59, v69 row_newbcast:3 row_mask:0xf bank_mask:0xf
    v_fmac_f32_dpp v50, v59, v70 row_newbcast:3 row_mask:0xf bank_mask:0xf
    v_fmac_f32_dpp v51, v59, v71 row_newbcast:3 row_mask:0xf bank_mask:0xf
    s_add_u32 s19, s17, 32768
    buffer_load_dwordx4 v[144:147], v2, s[8:11], s19 offen offset:0 nt
    buffer_load_dwordx4 v[148:151], v2, s[8:11], s19 offen offset:256 nt
    buffer_load_dwordx4 v[152:155], v2, s[8:11], s19 offen offset:512 nt
    buffer_load_dwordx4 v[156:159], v2, s[8:11], s19 offen offset:768 nt
    s_waitcnt vmcnt(28)
    v_mfma_f32_16x16x32_bf16 v[52:55], v[96:99], v[4:7], 0
    v_mfma_f32_16x16x32_bf16 v[52:55], v[100:103], v[8:11], v[52:55]
    v_mfma_f32_16x16x32_bf16 v[52:55], v[104:107], v[12:15], v[52:55]
    v_mfma_f32_16x16x32_bf16 v[52:55], v[108:111], v[16:19], v[52:55]
    s_add_u32 s18, s17, 36864
    buffer_load_dwordx4 v[96:99], v1, s[4:7], s18 offen offset:0 nt
    buffer_load_dwordx4 v[100:103], v1, s[4:7], s18 offen offset:64 nt
    buffer_load_dwordx4 v[104:107], v1, s[4:7], s18 offen offset:128 nt
    buffer_load_dwordx4 v[108:111], v1, s[4:7], s18 offen offset:192 nt
    s_nop 3
    s_nop 1
    v_max3_f32 v62, v52, v53, v54
    v_max3_f32 v62, v62, v55, v60
    v_cmp_gt_f32 vcc, v62, v60
    s_nop 1
    s_cbranch_vccz k2_attn_kernel_nr5
    v_sub_f32 v63, v60, v62
    v_mul_f32 v63, s21, v63
    v_exp_f32 v63, v63
    v_mov_b32 v60, v62
    v_mul_f32 v61, v61, v63
    s_nop 0
    v_mul_f32_dpp v20, v63, v20 row_newbcast:0 row_mask:0xf bank_mask:0xf
    v_mul_f32_dpp v21, v63, v21 row_newbcast:0 row_mask:0xf bank_mask:0xf
    v_mul_f32_dpp v22, v63, v22 row_newbcast:0 row_mask:0xf bank_mask:0xf
    v_mul_f32_dpp v23, v63, v23 row_newbcast:0 row_mask:0xf bank_mask:0xf
    v_mul_f32_dpp v24, v63, v24 row_newbcast:0 row_mask:0xf bank_mask:0xf
    v_mul_f32_dpp v25, v63, v25 row_newbcast:0 row_mask:0xf bank_mask:0xf
    v_mul_f32_dpp v26, v63, v26 row_newbcast:0 row_mask:0xf bank_mask:0xf
    v_mul_f32_dpp v27, v63, v27 row_newbcast:0 row_mask:0xf bank_mask:0xf
    v_mul_f32_dpp v28, v63, v28 row_newbcast:1 row_mask:0xf bank_mask:0xf
    v_mul_f32_dpp v29, v63, v29 row_newbcast:1 row_mask:0xf bank_mask:0xf
    v_mul_f32_dpp v30, v63, v30 row_newbcast:1 row_mask:0xf bank_mask:0xf
    v_mul_f32_dpp v31, v63, v31 row_newbcast:1 row_mask:0xf bank_mask:0xf
    v_mul_f32_dpp v32, v63, v32 row_newbcast:1 row_mask:0xf bank_mask:0xf
    v_mul_f32_dpp v33, v63, v33 row_newbcast:1 row_mask:0xf bank_mask:0xf
    v_mul_f32_dpp v34, v63, v34 row_newbcast:1 row_mask:0xf bank_mask:0xf
    v_mul_f32_dpp v35, v63, v35 row_newbcast:1 row_mask:0xf bank_mask:0xf
    v_mul_f32_dpp v36, v63, v36 row_newbcast:2 row_mask:0xf bank_mask:0xf
    v_mul_f32_dpp v37, v63, v37 row_newbcast:2 row_mask:0xf bank_mask:0xf
    v_mul_f32_dpp v38, v63, v38 row_newbcast:2 row_mask:0xf bank_mask:0xf
    v_mul_f32_dpp v39, v63, v39 row_newbcast:2 row_mask:0xf bank_mask:0xf
    v_mul_f32_dpp v40, v63, v40 row_newbcast:2 row_mask:0xf bank_mask:0xf
    v_mul_f32_dpp v41, v63, v41 row_newbcast:2 row_mask:0xf bank_mask:0xf
    v_mul_f32_dpp v42, v63, v42 row_newbcast:2 row_mask:0xf bank_mask:0xf
    v_mul_f32_dpp v43, v63, v43 row_newbcast:2 row_mask:0xf bank_mask:0xf
    v_mul_f32_dpp v44, v63, v44 row_newbcast:3 row_mask:0xf bank_mask:0xf
    v_mul_f32_dpp v45, v63, v45 row_newbcast:3 row_mask:0xf bank_mask:0xf
    v_mul_f32_dpp v46, v63, v46 row_newbcast:3 row_mask:0xf bank_mask:0xf
    v_mul_f32_dpp v47, v63, v47 row_newbcast:3 row_mask:0xf bank_mask:0xf
    v_mul_f32_dpp v48, v63, v48 row_newbcast:3 row_mask:0xf bank_mask:0xf
    v_mul_f32_dpp v49, v63, v49 row_newbcast:3 row_mask:0xf bank_mask:0xf
    v_mul_f32_dpp v50, v63, v50 row_newbcast:3 row_mask:0xf bank_mask:0xf
    v_mul_f32_dpp v51, v63, v51 row_newbcast:3 row_mask:0xf bank_mask:0xf
k2_attn_kernel_nr5:
    v_mul_f32 v72, s21, v60
    v_fma_f32 v56, v52, s21, -v72
    v_fma_f32 v57, v53, s21, -v72
    v_fma_f32 v58, v54, s21, -v72
    v_fma_f32 v59, v55, s21, -v72
    v_exp_f32 v56, v56
    v_exp_f32 v57, v57
    v_exp_f32 v58, v58
    v_exp_f32 v59, v59
    s_waitcnt vmcnt(28)
    v_add_f32 v62, v56, v57
    v_add_f32 v63, v58, v59
    v_add_f32 v61, v61, v62
    v_add_f32 v61, v61, v63
    v_lshlrev_b32 v64, 16, v160
    v_and_b32 v65, 0xffff0000, v160
    v_lshlrev_b32 v66, 16, v161
    v_and_b32 v67, 0xffff0000, v161
    v_lshlrev_b32 v68, 16, v162
    v_and_b32 v69, 0xffff0000, v162
    v_lshlrev_b32 v70, 16, v163
    v_and_b32 v71, 0xffff0000, v163
    v_fmac_f32_dpp v20, v56, v64 row_newbcast:0 row_mask:0xf bank_mask:0xf
    v_fmac_f32_dpp v21, v56, v65 row_newbcast:0 row_mask:0xf bank_mask:0xf
    v_fmac_f32_dpp v22, v56, v66 row_newbcast:0 row_mask:0xf bank_mask:0xf
    v_fmac_f32_dpp v23, v56, v67 row_newbcast:0 row_mask:0xf bank_mask:0xf
    v_fmac_f32_dpp v24, v56, v68 row_newbcast:0 row_mask:0xf bank_mask:0xf
    v_fmac_f32_dpp v25, v56, v69 row_newbcast:0 row_mask:0xf bank_mask:0xf
    v_fmac_f32_dpp v26, v56, v70 row_newbcast:0 row_mask:0xf bank_mask:0xf
    v_fmac_f32_dpp v27, v56, v71 row_newbcast:0 row_mask:0xf bank_mask:0xf
    v_fmac_f32_dpp v28, v56, v64 row_newbcast:1 row_mask:0xf bank_mask:0xf
    v_fmac_f32_dpp v29, v56, v65 row_newbcast:1 row_mask:0xf bank_mask:0xf
    v_fmac_f32_dpp v30, v56, v66 row_newbcast:1 row_mask:0xf bank_mask:0xf
    v_fmac_f32_dpp v31, v56, v67 row_newbcast:1 row_mask:0xf bank_mask:0xf
    v_fmac_f32_dpp v32, v56, v68 row_newbcast:1 row_mask:0xf bank_mask:0xf
    v_fmac_f32_dpp v33, v56, v69 row_newbcast:1 row_mask:0xf bank_mask:0xf
    v_fmac_f32_dpp v34, v56, v70 row_newbcast:1 row_mask:0xf bank_mask:0xf
    v_fmac_f32_dpp v35, v56, v71 row_newbcast:1 row_mask:0xf bank_mask:0xf
    v_fmac_f32_dpp v36, v56, v64 row_newbcast:2 row_mask:0xf bank_mask:0xf
    v_fmac_f32_dpp v37, v56, v65 row_newbcast:2 row_mask:0xf bank_mask:0xf
    v_fmac_f32_dpp v38, v56, v66 row_newbcast:2 row_mask:0xf bank_mask:0xf
    v_fmac_f32_dpp v39, v56, v67 row_newbcast:2 row_mask:0xf bank_mask:0xf
    v_fmac_f32_dpp v40, v56, v68 row_newbcast:2 row_mask:0xf bank_mask:0xf
    v_fmac_f32_dpp v41, v56, v69 row_newbcast:2 row_mask:0xf bank_mask:0xf
    v_fmac_f32_dpp v42, v56, v70 row_newbcast:2 row_mask:0xf bank_mask:0xf
    v_fmac_f32_dpp v43, v56, v71 row_newbcast:2 row_mask:0xf bank_mask:0xf
    v_fmac_f32_dpp v44, v56, v64 row_newbcast:3 row_mask:0xf bank_mask:0xf
    v_fmac_f32_dpp v45, v56, v65 row_newbcast:3 row_mask:0xf bank_mask:0xf
    v_fmac_f32_dpp v46, v56, v66 row_newbcast:3 row_mask:0xf bank_mask:0xf
    v_fmac_f32_dpp v47, v56, v67 row_newbcast:3 row_mask:0xf bank_mask:0xf
    v_fmac_f32_dpp v48, v56, v68 row_newbcast:3 row_mask:0xf bank_mask:0xf
    v_fmac_f32_dpp v49, v56, v69 row_newbcast:3 row_mask:0xf bank_mask:0xf
    v_fmac_f32_dpp v50, v56, v70 row_newbcast:3 row_mask:0xf bank_mask:0xf
    v_fmac_f32_dpp v51, v56, v71 row_newbcast:3 row_mask:0xf bank_mask:0xf
    v_lshlrev_b32 v64, 16, v164
    v_and_b32 v65, 0xffff0000, v164
    v_lshlrev_b32 v66, 16, v165
    v_and_b32 v67, 0xffff0000, v165
    v_lshlrev_b32 v68, 16, v166
    v_and_b32 v69, 0xffff0000, v166
    v_lshlrev_b32 v70, 16, v167
    v_and_b32 v71, 0xffff0000, v167
    v_fmac_f32_dpp v20, v57, v64 row_newbcast:0 row_mask:0xf bank_mask:0xf
    v_fmac_f32_dpp v21, v57, v65 row_newbcast:0 row_mask:0xf bank_mask:0xf
    v_fmac_f32_dpp v22, v57, v66 row_newbcast:0 row_mask:0xf bank_mask:0xf
    v_fmac_f32_dpp v23, v57, v67 row_newbcast:0 row_mask:0xf bank_mask:0xf
    v_fmac_f32_dpp v24, v57, v68 row_newbcast:0 row_mask:0xf bank_mask:0xf
    v_fmac_f32_dpp v25, v57, v69 row_newbcast:0 row_mask:0xf bank_mask:0xf
    v_fmac_f32_dpp v26, v57, v70 row_newbcast:0 row_mask:0xf bank_mask:0xf
    v_fmac_f32_dpp v27, v57, v71 row_newbcast:0 row_mask:0xf bank_mask:0xf
    v_fmac_f32_dpp v28, v57, v64 row_newbcast:1 row_mask:0xf bank_mask:0xf
    v_fmac_f32_dpp v29, v57, v65 row_newbcast:1 row_mask:0xf bank_mask:0xf
    v_fmac_f32_dpp v30, v57, v66 row_newbcast:1 row_mask:0xf bank_mask:0xf
    v_fmac_f32_dpp v31, v57, v67 row_newbcast:1 row_mask:0xf bank_mask:0xf
    v_fmac_f32_dpp v32, v57, v68 row_newbcast:1 row_mask:0xf bank_mask:0xf
    v_fmac_f32_dpp v33, v57, v69 row_newbcast:1 row_mask:0xf bank_mask:0xf
    v_fmac_f32_dpp v34, v57, v70 row_newbcast:1 row_mask:0xf bank_mask:0xf
    v_fmac_f32_dpp v35, v57, v71 row_newbcast:1 row_mask:0xf bank_mask:0xf
    v_fmac_f32_dpp v36, v57, v64 row_newbcast:2 row_mask:0xf bank_mask:0xf
    v_fmac_f32_dpp v37, v57, v65 row_newbcast:2 row_mask:0xf bank_mask:0xf
    v_fmac_f32_dpp v38, v57, v66 row_newbcast:2 row_mask:0xf bank_mask:0xf
    v_fmac_f32_dpp v39, v57, v67 row_newbcast:2 row_mask:0xf bank_mask:0xf
    v_fmac_f32_dpp v40, v57, v68 row_newbcast:2 row_mask:0xf bank_mask:0xf
    v_fmac_f32_dpp v41, v57, v69 row_newbcast:2 row_mask:0xf bank_mask:0xf
    v_fmac_f32_dpp v42, v57, v70 row_newbcast:2 row_mask:0xf bank_mask:0xf
    v_fmac_f32_dpp v43, v57, v71 row_newbcast:2 row_mask:0xf bank_mask:0xf
    v_fmac_f32_dpp v44, v57, v64 row_newbcast:3 row_mask:0xf bank_mask:0xf
    v_fmac_f32_dpp v45, v57, v65 row_newbcast:3 row_mask:0xf bank_mask:0xf
    v_fmac_f32_dpp v46, v57, v66 row_newbcast:3 row_mask:0xf bank_mask:0xf
    v_fmac_f32_dpp v47, v57, v67 row_newbcast:3 row_mask:0xf bank_mask:0xf
    v_fmac_f32_dpp v48, v57, v68 row_newbcast:3 row_mask:0xf bank_mask:0xf
    v_fmac_f32_dpp v49, v57, v69 row_newbcast:3 row_mask:0xf bank_mask:0xf
    v_fmac_f32_dpp v50, v57, v70 row_newbcast:3 row_mask:0xf bank_mask:0xf
    v_fmac_f32_dpp v51, v57, v71 row_newbcast:3 row_mask:0xf bank_mask:0xf
    v_lshlrev_b32 v64, 16, v168
    v_and_b32 v65, 0xffff0000, v168
    v_lshlrev_b32 v66, 16, v169
    v_and_b32 v67, 0xffff0000, v169
    v_lshlrev_b32 v68, 16, v170
    v_and_b32 v69, 0xffff0000, v170
    v_lshlrev_b32 v70, 16, v171
    v_and_b32 v71, 0xffff0000, v171
    v_fmac_f32_dpp v20, v58, v64 row_newbcast:0 row_mask:0xf bank_mask:0xf
    v_fmac_f32_dpp v21, v58, v65 row_newbcast:0 row_mask:0xf bank_mask:0xf
    v_fmac_f32_dpp v22, v58, v66 row_newbcast:0 row_mask:0xf bank_mask:0xf
    v_fmac_f32_dpp v23, v58, v67 row_newbcast:0 row_mask:0xf bank_mask:0xf
    v_fmac_f32_dpp v24, v58, v68 row_newbcast:0 row_mask:0xf bank_mask:0xf
    v_fmac_f32_dpp v25, v58, v69 row_newbcast:0 row_mask:0xf bank_mask:0xf
    v_fmac_f32_dpp v26, v58, v70 row_newbcast:0 row_mask:0xf bank_mask:0xf
    v_fmac_f32_dpp v27, v58, v71 row_newbcast:0 row_mask:0xf bank_mask:0xf
    v_fmac_f32_dpp v28, v58, v64 row_newbcast:1 row_mask:0xf bank_mask:0xf
    v_fmac_f32_dpp v29, v58, v65 row_newbcast:1 row_mask:0xf bank_mask:0xf
    v_fmac_f32_dpp v30, v58, v66 row_newbcast:1 row_mask:0xf bank_mask:0xf
    v_fmac_f32_dpp v31, v58, v67 row_newbcast:1 row_mask:0xf bank_mask:0xf
    v_fmac_f32_dpp v32, v58, v68 row_newbcast:1 row_mask:0xf bank_mask:0xf
    v_fmac_f32_dpp v33, v58, v69 row_newbcast:1 row_mask:0xf bank_mask:0xf
    v_fmac_f32_dpp v34, v58, v70 row_newbcast:1 row_mask:0xf bank_mask:0xf
    v_fmac_f32_dpp v35, v58, v71 row_newbcast:1 row_mask:0xf bank_mask:0xf
    v_fmac_f32_dpp v36, v58, v64 row_newbcast:2 row_mask:0xf bank_mask:0xf
    v_fmac_f32_dpp v37, v58, v65 row_newbcast:2 row_mask:0xf bank_mask:0xf
    v_fmac_f32_dpp v38, v58, v66 row_newbcast:2 row_mask:0xf bank_mask:0xf
    v_fmac_f32_dpp v39, v58, v67 row_newbcast:2 row_mask:0xf bank_mask:0xf
    v_fmac_f32_dpp v40, v58, v68 row_newbcast:2 row_mask:0xf bank_mask:0xf
    v_fmac_f32_dpp v41, v58, v69 row_newbcast:2 row_mask:0xf bank_mask:0xf
    v_fmac_f32_dpp v42, v58, v70 row_newbcast:2 row_mask:0xf bank_mask:0xf
    v_fmac_f32_dpp v43, v58, v71 row_newbcast:2 row_mask:0xf bank_mask:0xf
    v_fmac_f32_dpp v44, v58, v64 row_newbcast:3 row_mask:0xf bank_mask:0xf
    v_fmac_f32_dpp v45, v58, v65 row_newbcast:3 row_mask:0xf bank_mask:0xf
    v_fmac_f32_dpp v46, v58, v66 row_newbcast:3 row_mask:0xf bank_mask:0xf
    v_fmac_f32_dpp v47, v58, v67 row_newbcast:3 row_mask:0xf bank_mask:0xf
    v_fmac_f32_dpp v48, v58, v68 row_newbcast:3 row_mask:0xf bank_mask:0xf
    v_fmac_f32_dpp v49, v58, v69 row_newbcast:3 row_mask:0xf bank_mask:0xf
    v_fmac_f32_dpp v50, v58, v70 row_newbcast:3 row_mask:0xf bank_mask:0xf
    v_fmac_f32_dpp v51, v58, v71 row_newbcast:3 row_mask:0xf bank_mask:0xf
    v_lshlrev_b32 v64, 16, v172
    v_and_b32 v65, 0xffff0000, v172
    v_lshlrev_b32 v66, 16, v173
    v_and_b32 v67, 0xffff0000, v173
    v_lshlrev_b32 v68, 16, v174
    v_and_b32 v69, 0xffff0000, v174
    v_lshlrev_b32 v70, 16, v175
    v_and_b32 v71, 0xffff0000, v175
    v_fmac_f32_dpp v20, v59, v64 row_newbcast:0 row_mask:0xf bank_mask:0xf
    v_fmac_f32_dpp v21, v59, v65 row_newbcast:0 row_mask:0xf bank_mask:0xf
    v_fmac_f32_dpp v22, v59, v66 row_newbcast:0 row_mask:0xf bank_mask:0xf
    v_fmac_f32_dpp v23, v59, v67 row_newbcast:0 row_mask:0xf bank_mask:0xf
    v_fmac_f32_dpp v24, v59, v68 row_newbcast:0 row_mask:0xf bank_mask:0xf
    v_fmac_f32_dpp v25, v59, v69 row_newbcast:0 row_mask:0xf bank_mask:0xf
    v_fmac_f32_dpp v26, v59, v70 row_newbcast:0 row_mask:0xf bank_mask:0xf
    v_fmac_f32_dpp v27, v59, v71 row_newbcast:0 row_mask:0xf bank_mask:0xf
    v_fmac_f32_dpp v28, v59, v64 row_newbcast:1 row_mask:0xf bank_mask:0xf
    v_fmac_f32_dpp v29, v59, v65 row_newbcast:1 row_mask:0xf bank_mask:0xf
    v_fmac_f32_dpp v30, v59, v66 row_newbcast:1 row_mask:0xf bank_mask:0xf
    v_fmac_f32_dpp v31, v59, v67 row_newbcast:1 row_mask:0xf bank_mask:0xf
    v_fmac_f32_dpp v32, v59, v68 row_newbcast:1 row_mask:0xf bank_mask:0xf
    v_fmac_f32_dpp v33, v59, v69 row_newbcast:1 row_mask:0xf bank_mask:0xf
    v_fmac_f32_dpp v34, v59, v70 row_newbcast:1 row_mask:0xf bank_mask:0xf
    v_fmac_f32_dpp v35, v59, v71 row_newbcast:1 row_mask:0xf bank_mask:0xf
    v_fmac_f32_dpp v36, v59, v64 row_newbcast:2 row_mask:0xf bank_mask:0xf
    v_fmac_f32_dpp v37, v59, v65 row_newbcast:2 row_mask:0xf bank_mask:0xf
    v_fmac_f32_dpp v38, v59, v66 row_newbcast:2 row_mask:0xf bank_mask:0xf
    v_fmac_f32_dpp v39, v59, v67 row_newbcast:2 row_mask:0xf bank_mask:0xf
    v_fmac_f32_dpp v40, v59, v68 row_newbcast:2 row_mask:0xf bank_mask:0xf
    v_fmac_f32_dpp v41, v59, v69 row_newbcast:2 row_mask:0xf bank_mask:0xf
    v_fmac_f32_dpp v42, v59, v70 row_newbcast:2 row_mask:0xf bank_mask:0xf
    v_fmac_f32_dpp v43, v59, v71 row_newbcast:2 row_mask:0xf bank_mask:0xf
    v_fmac_f32_dpp v44, v59, v64 row_newbcast:3 row_mask:0xf bank_mask:0xf
    v_fmac_f32_dpp v45, v59, v65 row_newbcast:3 row_mask:0xf bank_mask:0xf
    v_fmac_f32_dpp v46, v59, v66 row_newbcast:3 row_mask:0xf bank_mask:0xf
    v_fmac_f32_dpp v47, v59, v67 row_newbcast:3 row_mask:0xf bank_mask:0xf
    v_fmac_f32_dpp v48, v59, v68 row_newbcast:3 row_mask:0xf bank_mask:0xf
    v_fmac_f32_dpp v49, v59, v69 row_newbcast:3 row_mask:0xf bank_mask:0xf
    v_fmac_f32_dpp v50, v59, v70 row_newbcast:3 row_mask:0xf bank_mask:0xf
    v_fmac_f32_dpp v51, v59, v71 row_newbcast:3 row_mask:0xf bank_mask:0xf
    s_add_u32 s19, s17, 36864
    buffer_load_dwordx4 v[160:163], v2, s[8:11], s19 offen offset:0 nt
    buffer_load_dwordx4 v[164:167], v2, s[8:11], s19 offen offset:256 nt
    buffer_load_dwordx4 v[168:171], v2, s[8:11], s19 offen offset:512 nt
    buffer_load_dwordx4 v[172:175], v2, s[8:11], s19 offen offset:768 nt
    s_waitcnt vmcnt(28)
    v_mfma_f32_16x16x32_bf16 v[52:55], v[112:115], v[4:7], 0
    v_mfma_f32_16x16x32_bf16 v[52:55], v[116:119], v[8:11], v[52:55]
    v_mfma_f32_16x16x32_bf16 v[52:55], v[120:123], v[12:15], v[52:55]
    v_mfma_f32_16x16x32_bf16 v[52:55], v[124:127], v[16:19], v[52:55]
    s_add_u32 s18, s17, 40960
    buffer_load_dwordx4 v[112:115], v1, s[4:7], s18 offen offset:0 nt
    buffer_load_dwordx4 v[116:119], v1, s[4:7], s18 offen offset:64 nt
    buffer_load_dwordx4 v[120:123], v1, s[4:7], s18 offen offset:128 nt
    buffer_load_dwordx4 v[124:127], v1, s[4:7], s18 offen offset:192 nt
    s_nop 3
    s_nop 1
    v_max3_f32 v62, v52, v53, v54
    v_max3_f32 v62, v62, v55, v60
    v_cmp_gt_f32 vcc, v62, v60
    s_nop 1
    s_cbranch_vccz k2_attn_kernel_nr6
    v_sub_f32 v63, v60, v62
    v_mul_f32 v63, s21, v63
    v_exp_f32 v63, v63
    v_mov_b32 v60, v62
    v_mul_f32 v61, v61, v63
    s_nop 0
    v_mul_f32_dpp v20, v63, v20 row_newbcast:0 row_mask:0xf bank_mask:0xf
    v_mul_f32_dpp v21, v63, v21 row_newbcast:0 row_mask:0xf bank_mask:0xf
    v_mul_f32_dpp v22, v63, v22 row_newbcast:0 row_mask:0xf bank_mask:0xf
    v_mul_f32_dpp v23, v63, v23 row_newbcast:0 row_mask:0xf bank_mask:0xf
    v_mul_f32_dpp v24, v63, v24 row_newbcast:0 row_mask:0xf bank_mask:0xf
    v_mul_f32_dpp v25, v63, v25 row_newbcast:0 row_mask:0xf bank_mask:0xf
    v_mul_f32_dpp v26, v63, v26 row_newbcast:0 row_mask:0xf bank_mask:0xf
    v_mul_f32_dpp v27, v63, v27 row_newbcast:0 row_mask:0xf bank_mask:0xf
    v_mul_f32_dpp v28, v63, v28 row_newbcast:1 row_mask:0xf bank_mask:0xf
    v_mul_f32_dpp v29, v63, v29 row_newbcast:1 row_mask:0xf bank_mask:0xf
    v_mul_f32_dpp v30, v63, v30 row_newbcast:1 row_mask:0xf bank_mask:0xf
    v_mul_f32_dpp v31, v63, v31 row_newbcast:1 row_mask:0xf bank_mask:0xf
    v_mul_f32_dpp v32, v63, v32 row_newbcast:1 row_mask:0xf bank_mask:0xf
    v_mul_f32_dpp v33, v63, v33 row_newbcast:1 row_mask:0xf bank_mask:0xf
    v_mul_f32_dpp v34, v63, v34 row_newbcast:1 row_mask:0xf bank_mask:0xf
    v_mul_f32_dpp v35, v63, v35 row_newbcast:1 row_mask:0xf bank_mask:0xf
    v_mul_f32_dpp v36, v63, v36 row_newbcast:2 row_mask:0xf bank_mask:0xf
    v_mul_f32_dpp v37, v63, v37 row_newbcast:2 row_mask:0xf bank_mask:0xf
    v_mul_f32_dpp v38, v63, v38 row_newbcast:2 row_mask:0xf bank_mask:0xf
    v_mul_f32_dpp v39, v63, v39 row_newbcast:2 row_mask:0xf bank_mask:0xf
    v_mul_f32_dpp v40, v63, v40 row_newbcast:2 row_mask:0xf bank_mask:0xf
    v_mul_f32_dpp v41, v63, v41 row_newbcast:2 row_mask:0xf bank_mask:0xf
    v_mul_f32_dpp v42, v63, v42 row_newbcast:2 row_mask:0xf bank_mask:0xf
    v_mul_f32_dpp v43, v63, v43 row_newbcast:2 row_mask:0xf bank_mask:0xf
    v_mul_f32_dpp v44, v63, v44 row_newbcast:3 row_mask:0xf bank_mask:0xf
    v_mul_f32_dpp v45, v63, v45 row_newbcast:3 row_mask:0xf bank_mask:0xf
    v_mul_f32_dpp v46, v63, v46 row_newbcast:3 row_mask:0xf bank_mask:0xf
    v_mul_f32_dpp v47, v63, v47 row_newbcast:3 row_mask:0xf bank_mask:0xf
    v_mul_f32_dpp v48, v63, v48 row_newbcast:3 row_mask:0xf bank_mask:0xf
    v_mul_f32_dpp v49, v63, v49 row_newbcast:3 row_mask:0xf bank_mask:0xf
    v_mul_f32_dpp v50, v63, v50 row_newbcast:3 row_mask:0xf bank_mask:0xf
    v_mul_f32_dpp v51, v63, v51 row_newbcast:3 row_mask:0xf bank_mask:0xf
k2_attn_kernel_nr6:
    v_mul_f32 v72, s21, v60
    v_fma_f32 v56, v52, s21, -v72
    v_fma_f32 v57, v53, s21, -v72
    v_fma_f32 v58, v54, s21, -v72
    v_fma_f32 v59, v55, s21, -v72
    v_exp_f32 v56, v56
    v_exp_f32 v57, v57
    v_exp_f32 v58, v58
    v_exp_f32 v59, v59
    s_waitcnt vmcnt(28)
    v_add_f32 v62, v56, v57
    v_add_f32 v63, v58, v59
    v_add_f32 v61, v61, v62
    v_add_f32 v61, v61, v63
    v_lshlrev_b32 v64, 16, v176
    v_and_b32 v65, 0xffff0000, v176
    v_lshlrev_b32 v66, 16, v177
    v_and_b32 v67, 0xffff0000, v177
    v_lshlrev_b32 v68, 16, v178
    v_and_b32 v69, 0xffff0000, v178
    v_lshlrev_b32 v70, 16, v179
    v_and_b32 v71, 0xffff0000, v179
    v_fmac_f32_dpp v20, v56, v64 row_newbcast:0 row_mask:0xf bank_mask:0xf
    v_fmac_f32_dpp v21, v56, v65 row_newbcast:0 row_mask:0xf bank_mask:0xf
    v_fmac_f32_dpp v22, v56, v66 row_newbcast:0 row_mask:0xf bank_mask:0xf
    v_fmac_f32_dpp v23, v56, v67 row_newbcast:0 row_mask:0xf bank_mask:0xf
    v_fmac_f32_dpp v24, v56, v68 row_newbcast:0 row_mask:0xf bank_mask:0xf
    v_fmac_f32_dpp v25, v56, v69 row_newbcast:0 row_mask:0xf bank_mask:0xf
    v_fmac_f32_dpp v26, v56, v70 row_newbcast:0 row_mask:0xf bank_mask:0xf
    v_fmac_f32_dpp v27, v56, v71 row_newbcast:0 row_mask:0xf bank_mask:0xf
    v_fmac_f32_dpp v28, v56, v64 row_newbcast:1 row_mask:0xf bank_mask:0xf
    v_fmac_f32_dpp v29, v56, v65 row_newbcast:1 row_mask:0xf bank_mask:0xf
    v_fmac_f32_dpp v30, v56, v66 row_newbcast:1 row_mask:0xf bank_mask:0xf
    v_fmac_f32_dpp v31, v56, v67 row_newbcast:1 row_mask:0xf bank_mask:0xf
    v_fmac_f32_dpp v32, v56, v68 row_newbcast:1 row_mask:0xf bank_mask:0xf
    v_fmac_f32_dpp v33, v56, v69 row_newbcast:1 row_mask:0xf bank_mask:0xf
    v_fmac_f32_dpp v34, v56, v70 row_newbcast:1 row_mask:0xf bank_mask:0xf
    v_fmac_f32_dpp v35, v56, v71 row_newbcast:1 row_mask:0xf bank_mask:0xf
    v_fmac_f32_dpp v36, v56, v64 row_newbcast:2 row_mask:0xf bank_mask:0xf
    v_fmac_f32_dpp v37, v56, v65 row_newbcast:2 row_mask:0xf bank_mask:0xf
    v_fmac_f32_dpp v38, v56, v66 row_newbcast:2 row_mask:0xf bank_mask:0xf
    v_fmac_f32_dpp v39, v56, v67 row_newbcast:2 row_mask:0xf bank_mask:0xf
    v_fmac_f32_dpp v40, v56, v68 row_newbcast:2 row_mask:0xf bank_mask:0xf
    v_fmac_f32_dpp v41, v56, v69 row_newbcast:2 row_mask:0xf bank_mask:0xf
    v_fmac_f32_dpp v42, v56, v70 row_newbcast:2 row_mask:0xf bank_mask:0xf
    v_fmac_f32_dpp v43, v56, v71 row_newbcast:2 row_mask:0xf bank_mask:0xf
    v_fmac_f32_dpp v44, v56, v64 row_newbcast:3 row_mask:0xf bank_mask:0xf
    v_fmac_f32_dpp v45, v56, v65 row_newbcast:3 row_mask:0xf bank_mask:0xf
    v_fmac_f32_dpp v46, v56, v66 row_newbcast:3 row_mask:0xf bank_mask:0xf
    v_fmac_f32_dpp v47, v56, v67 row_newbcast:3 row_mask:0xf bank_mask:0xf
    v_fmac_f32_dpp v48, v56, v68 row_newbcast:3 row_mask:0xf bank_mask:0xf
    v_fmac_f32_dpp v49, v56, v69 row_newbcast:3 row_mask:0xf bank_mask:0xf
    v_fmac_f32_dpp v50, v56, v70 row_newbcast:3 row_mask:0xf bank_mask:0xf
    v_fmac_f32_dpp v51, v56, v71 row_newbcast:3 row_mask:0xf bank_mask:0xf
    v_lshlrev_b32 v64, 16, v180
    v_and_b32 v65, 0xffff0000, v180
    v_lshlrev_b32 v66, 16, v181
    v_and_b32 v67, 0xffff0000, v181
    v_lshlrev_b32 v68, 16, v182
    v_and_b32 v69, 0xffff0000, v182
    v_lshlrev_b32 v70, 16, v183
    v_and_b32 v71, 0xffff0000, v183
    v_fmac_f32_dpp v20, v57, v64 row_newbcast:0 row_mask:0xf bank_mask:0xf
    v_fmac_f32_dpp v21, v57, v65 row_newbcast:0 row_mask:0xf bank_mask:0xf
    v_fmac_f32_dpp v22, v57, v66 row_newbcast:0 row_mask:0xf bank_mask:0xf
    v_fmac_f32_dpp v23, v57, v67 row_newbcast:0 row_mask:0xf bank_mask:0xf
    v_fmac_f32_dpp v24, v57, v68 row_newbcast:0 row_mask:0xf bank_mask:0xf
    v_fmac_f32_dpp v25, v57, v69 row_newbcast:0 row_mask:0xf bank_mask:0xf
    v_fmac_f32_dpp v26, v57, v70 row_newbcast:0 row_mask:0xf bank_mask:0xf
    v_fmac_f32_dpp v27, v57, v71 row_newbcast:0 row_mask:0xf bank_mask:0xf
    v_fmac_f32_dpp v28, v57, v64 row_newbcast:1 row_mask:0xf bank_mask:0xf
    v_fmac_f32_dpp v29, v57, v65 row_newbcast:1 row_mask:0xf bank_mask:0xf
    v_fmac_f32_dpp v30, v57, v66 row_newbcast:1 row_mask:0xf bank_mask:0xf
    v_fmac_f32_dpp v31, v57, v67 row_newbcast:1 row_mask:0xf bank_mask:0xf
    v_fmac_f32_dpp v32, v57, v68 row_newbcast:1 row_mask:0xf bank_mask:0xf
    v_fmac_f32_dpp v33, v57, v69 row_newbcast:1 row_mask:0xf bank_mask:0xf
    v_fmac_f32_dpp v34, v57, v70 row_newbcast:1 row_mask:0xf bank_mask:0xf
    v_fmac_f32_dpp v35, v57, v71 row_newbcast:1 row_mask:0xf bank_mask:0xf
    v_fmac_f32_dpp v36, v57, v64 row_newbcast:2 row_mask:0xf bank_mask:0xf
    v_fmac_f32_dpp v37, v57, v65 row_newbcast:2 row_mask:0xf bank_mask:0xf
    v_fmac_f32_dpp v38, v57, v66 row_newbcast:2 row_mask:0xf bank_mask:0xf
    v_fmac_f32_dpp v39, v57, v67 row_newbcast:2 row_mask:0xf bank_mask:0xf
    v_fmac_f32_dpp v40, v57, v68 row_newbcast:2 row_mask:0xf bank_mask:0xf
    v_fmac_f32_dpp v41, v57, v69 row_newbcast:2 row_mask:0xf bank_mask:0xf
    v_fmac_f32_dpp v42, v57, v70 row_newbcast:2 row_mask:0xf bank_mask:0xf
    v_fmac_f32_dpp v43, v57, v71 row_newbcast:2 row_mask:0xf bank_mask:0xf
    v_fmac_f32_dpp v44, v57, v64 row_newbcast:3 row_mask:0xf bank_mask:0xf
    v_fmac_f32_dpp v45, v57, v65 row_newbcast:3 row_mask:0xf bank_mask:0xf
    v_fmac_f32_dpp v46, v57, v66 row_newbcast:3 row_mask:0xf bank_mask:0xf
    v_fmac_f32_dpp v47, v57, v67 row_newbcast:3 row_mask:0xf bank_mask:0xf
    v_fmac_f32_dpp v48, v57, v68 row_newbcast:3 row_mask:0xf bank_mask:0xf
    v_fmac_f32_dpp v49, v57, v69 row_newbcast:3 row_mask:0xf bank_mask:0xf
    v_fmac_f32_dpp v50, v57, v70 row_newbcast:3 row_mask:0xf bank_mask:0xf
    v_fmac_f32_dpp v51, v57, v71 row_newbcast:3 row_mask:0xf bank_mask:0xf
    v_lshlrev_b32 v64, 16, v184
    v_and_b32 v65, 0xffff0000, v184
    v_lshlrev_b32 v66, 16, v185
    v_and_b32 v67, 0xffff0000, v185
    v_lshlrev_b32 v68, 16, v186
    v_and_b32 v69, 0xffff0000, v186
    v_lshlrev_b32 v70, 16, v187
    v_and_b32 v71, 0xffff0000, v187
    v_fmac_f32_dpp v20, v58, v64 row_newbcast:0 row_mask:0xf bank_mask:0xf
    v_fmac_f32_dpp v21, v58, v65 row_newbcast:0 row_mask:0xf bank_mask:0xf
    v_fmac_f32_dpp v22, v58, v66 row_newbcast:0 row_mask:0xf bank_mask:0xf
    v_fmac_f32_dpp v23, v58, v67 row_newbcast:0 row_mask:0xf bank_mask:0xf
    v_fmac_f32_dpp v24, v58, v68 row_newbcast:0 row_mask:0xf bank_mask:0xf
    v_fmac_f32_dpp v25, v58, v69 row_newbcast:0 row_mask:0xf bank_mask:0xf
    v_fmac_f32_dpp v26, v58, v70 row_newbcast:0 row_mask:0xf bank_mask:0xf
    v_fmac_f32_dpp v27, v58, v71 row_newbcast:0 row_mask:0xf bank_mask:0xf
    v_fmac_f32_dpp v28, v58, v64 row_newbcast:1 row_mask:0xf bank_mask:0xf
    v_fmac_f32_dpp v29, v58, v65 row_newbcast:1 row_mask:0xf bank_mask:0xf
    v_fmac_f32_dpp v30, v58, v66 row_newbcast:1 row_mask:0xf bank_mask:0xf
    v_fmac_f32_dpp v31, v58, v67 row_newbcast:1 row_mask:0xf bank_mask:0xf
    v_fmac_f32_dpp v32, v58, v68 row_newbcast:1 row_mask:0xf bank_mask:0xf
    v_fmac_f32_dpp v33, v58, v69 row_newbcast:1 row_mask:0xf bank_mask:0xf
    v_fmac_f32_dpp v34, v58, v70 row_newbcast:1 row_mask:0xf bank_mask:0xf
    v_fmac_f32_dpp v35, v58, v71 row_newbcast:1 row_mask:0xf bank_mask:0xf
    v_fmac_f32_dpp v36, v58, v64 row_newbcast:2 row_mask:0xf bank_mask:0xf
    v_fmac_f32_dpp v37, v58, v65 row_newbcast:2 row_mask:0xf bank_mask:0xf
    v_fmac_f32_dpp v38, v58, v66 row_newbcast:2 row_mask:0xf bank_mask:0xf
    v_fmac_f32_dpp v39, v58, v67 row_newbcast:2 row_mask:0xf bank_mask:0xf
    v_fmac_f32_dpp v40, v58, v68 row_newbcast:2 row_mask:0xf bank_mask:0xf
    v_fmac_f32_dpp v41, v58, v69 row_newbcast:2 row_mask:0xf bank_mask:0xf
    v_fmac_f32_dpp v42, v58, v70 row_newbcast:2 row_mask:0xf bank_mask:0xf
    v_fmac_f32_dpp v43, v58, v71 row_newbcast:2 row_mask:0xf bank_mask:0xf
    v_fmac_f32_dpp v44, v58, v64 row_newbcast:3 row_mask:0xf bank_mask:0xf
    v_fmac_f32_dpp v45, v58, v65 row_newbcast:3 row_mask:0xf bank_mask:0xf
    v_fmac_f32_dpp v46, v58, v66 row_newbcast:3 row_mask:0xf bank_mask:0xf
    v_fmac_f32_dpp v47, v58, v67 row_newbcast:3 row_mask:0xf bank_mask:0xf
    v_fmac_f32_dpp v48, v58, v68 row_newbcast:3 row_mask:0xf bank_mask:0xf
    v_fmac_f32_dpp v49, v58, v69 row_newbcast:3 row_mask:0xf bank_mask:0xf
    v_fmac_f32_dpp v50, v58, v70 row_newbcast:3 row_mask:0xf bank_mask:0xf
    v_fmac_f32_dpp v51, v58, v71 row_newbcast:3 row_mask:0xf bank_mask:0xf
    v_lshlrev_b32 v64, 16, v188
    v_and_b32 v65, 0xffff0000, v188
    v_lshlrev_b32 v66, 16, v189
    v_and_b32 v67, 0xffff0000, v189
    v_lshlrev_b32 v68, 16, v190
    v_and_b32 v69, 0xffff0000, v190
    v_lshlrev_b32 v70, 16, v191
    v_and_b32 v71, 0xffff0000, v191
    v_fmac_f32_dpp v20, v59, v64 row_newbcast:0 row_mask:0xf bank_mask:0xf
    v_fmac_f32_dpp v21, v59, v65 row_newbcast:0 row_mask:0xf bank_mask:0xf
    v_fmac_f32_dpp v22, v59, v66 row_newbcast:0 row_mask:0xf bank_mask:0xf
    v_fmac_f32_dpp v23, v59, v67 row_newbcast:0 row_mask:0xf bank_mask:0xf
    v_fmac_f32_dpp v24, v59, v68 row_newbcast:0 row_mask:0xf bank_mask:0xf
    v_fmac_f32_dpp v25, v59, v69 row_newbcast:0 row_mask:0xf bank_mask:0xf
    v_fmac_f32_dpp v26, v59, v70 row_newbcast:0 row_mask:0xf bank_mask:0xf
    v_fmac_f32_dpp v27, v59, v71 row_newbcast:0 row_mask:0xf bank_mask:0xf
    v_fmac_f32_dpp v28, v59, v64 row_newbcast:1 row_mask:0xf bank_mask:0xf
    v_fmac_f32_dpp v29, v59, v65 row_newbcast:1 row_mask:0xf bank_mask:0xf
    v_fmac_f32_dpp v30, v59, v66 row_newbcast:1 row_mask:0xf bank_mask:0xf
    v_fmac_f32_dpp v31, v59, v67 row_newbcast:1 row_mask:0xf bank_mask:0xf
    v_fmac_f32_dpp v32, v59, v68 row_newbcast:1 row_mask:0xf bank_mask:0xf
    v_fmac_f32_dpp v33, v59, v69 row_newbcast:1 row_mask:0xf bank_mask:0xf
    v_fmac_f32_dpp v34, v59, v70 row_newbcast:1 row_mask:0xf bank_mask:0xf
    v_fmac_f32_dpp v35, v59, v71 row_newbcast:1 row_mask:0xf bank_mask:0xf
    v_fmac_f32_dpp v36, v59, v64 row_newbcast:2 row_mask:0xf bank_mask:0xf
    v_fmac_f32_dpp v37, v59, v65 row_newbcast:2 row_mask:0xf bank_mask:0xf
    v_fmac_f32_dpp v38, v59, v66 row_newbcast:2 row_mask:0xf bank_mask:0xf
    v_fmac_f32_dpp v39, v59, v67 row_newbcast:2 row_mask:0xf bank_mask:0xf
    v_fmac_f32_dpp v40, v59, v68 row_newbcast:2 row_mask:0xf bank_mask:0xf
    v_fmac_f32_dpp v41, v59, v69 row_newbcast:2 row_mask:0xf bank_mask:0xf
    v_fmac_f32_dpp v42, v59, v70 row_newbcast:2 row_mask:0xf bank_mask:0xf
    v_fmac_f32_dpp v43, v59, v71 row_newbcast:2 row_mask:0xf bank_mask:0xf
    v_fmac_f32_dpp v44, v59, v64 row_newbcast:3 row_mask:0xf bank_mask:0xf
    v_fmac_f32_dpp v45, v59, v65 row_newbcast:3 row_mask:0xf bank_mask:0xf
    v_fmac_f32_dpp v46, v59, v66 row_newbcast:3 row_mask:0xf bank_mask:0xf
    v_fmac_f32_dpp v47, v59, v67 row_newbcast:3 row_mask:0xf bank_mask:0xf
    v_fmac_f32_dpp v48, v59, v68 row_newbcast:3 row_mask:0xf bank_mask:0xf
    v_fmac_f32_dpp v49, v59, v69 row_newbcast:3 row_mask:0xf bank_mask:0xf
    v_fmac_f32_dpp v50, v59, v70 row_newbcast:3 row_mask:0xf bank_mask:0xf
    v_fmac_f32_dpp v51, v59, v71 row_newbcast:3 row_mask:0xf bank_mask:0xf
    s_add_u32 s19, s17, 40960
    buffer_load_dwordx4 v[176:179], v2, s[8:11], s19 offen offset:0 nt
    buffer_load_dwordx4 v[180:183], v2, s[8:11], s19 offen offset:256 nt
    buffer_load_dwordx4 v[184:187], v2, s[8:11], s19 offen offset:512 nt
    buffer_load_dwordx4 v[188:191], v2, s[8:11], s19 offen offset:768 nt
    s_waitcnt vmcnt(28)
    v_mfma_f32_16x16x32_bf16 v[52:55], v[128:131], v[4:7], 0
    v_mfma_f32_16x16x32_bf16 v[52:55], v[132:135], v[8:11], v[52:55]
    v_mfma_f32_16x16x32_bf16 v[52:55], v[136:139], v[12:15], v[52:55]
    v_mfma_f32_16x16x32_bf16 v[52:55], v[140:143], v[16:19], v[52:55]
    s_add_u32 s18, s17, 45056
    buffer_load_dwordx4 v[128:131], v1, s[4:7], s18 offen offset:0 nt
    buffer_load_dwordx4 v[132:135], v1, s[4:7], s18 offen offset:64 nt
    buffer_load_dwordx4 v[136:139], v1, s[4:7], s18 offen offset:128 nt
    buffer_load_dwordx4 v[140:143], v1, s[4:7], s18 offen offset:192 nt
    s_nop 3
    s_nop 1
    v_max3_f32 v62, v52, v53, v54
    v_max3_f32 v62, v62, v55, v60
    v_cmp_gt_f32 vcc, v62, v60
    s_nop 1
    s_cbranch_vccz k2_attn_kernel_nr7
    v_sub_f32 v63, v60, v62
    v_mul_f32 v63, s21, v63
    v_exp_f32 v63, v63
    v_mov_b32 v60, v62
    v_mul_f32 v61, v61, v63
    s_nop 0
    v_mul_f32_dpp v20, v63, v20 row_newbcast:0 row_mask:0xf bank_mask:0xf
    v_mul_f32_dpp v21, v63, v21 row_newbcast:0 row_mask:0xf bank_mask:0xf
    v_mul_f32_dpp v22, v63, v22 row_newbcast:0 row_mask:0xf bank_mask:0xf
    v_mul_f32_dpp v23, v63, v23 row_newbcast:0 row_mask:0xf bank_mask:0xf
    v_mul_f32_dpp v24, v63, v24 row_newbcast:0 row_mask:0xf bank_mask:0xf
    v_mul_f32_dpp v25, v63, v25 row_newbcast:0 row_mask:0xf bank_mask:0xf
    v_mul_f32_dpp v26, v63, v26 row_newbcast:0 row_mask:0xf bank_mask:0xf
    v_mul_f32_dpp v27, v63, v27 row_newbcast:0 row_mask:0xf bank_mask:0xf
    v_mul_f32_dpp v28, v63, v28 row_newbcast:1 row_mask:0xf bank_mask:0xf
    v_mul_f32_dpp v29, v63, v29 row_newbcast:1 row_mask:0xf bank_mask:0xf
    v_mul_f32_dpp v30, v63, v30 row_newbcast:1 row_mask:0xf bank_mask:0xf
    v_mul_f32_dpp v31, v63, v31 row_newbcast:1 row_mask:0xf bank_mask:0xf
    v_mul_f32_dpp v32, v63, v32 row_newbcast:1 row_mask:0xf bank_mask:0xf
    v_mul_f32_dpp v33, v63, v33 row_newbcast:1 row_mask:0xf bank_mask:0xf
    v_mul_f32_dpp v34, v63, v34 row_newbcast:1 row_mask:0xf bank_mask:0xf
    v_mul_f32_dpp v35, v63, v35 row_newbcast:1 row_mask:0xf bank_mask:0xf
    v_mul_f32_dpp v36, v63, v36 row_newbcast:2 row_mask:0xf bank_mask:0xf
    v_mul_f32_dpp v37, v63, v37 row_newbcast:2 row_mask:0xf bank_mask:0xf
    v_mul_f32_dpp v38, v63, v38 row_newbcast:2 row_mask:0xf bank_mask:0xf
    v_mul_f32_dpp v39, v63, v39 row_newbcast:2 row_mask:0xf bank_mask:0xf
    v_mul_f32_dpp v40, v63, v40 row_newbcast:2 row_mask:0xf bank_mask:0xf
    v_mul_f32_dpp v41, v63, v41 row_newbcast:2 row_mask:0xf bank_mask:0xf
    v_mul_f32_dpp v42, v63, v42 row_newbcast:2 row_mask:0xf bank_mask:0xf
    v_mul_f32_dpp v43, v63, v43 row_newbcast:2 row_mask:0xf bank_mask:0xf
    v_mul_f32_dpp v44, v63, v44 row_newbcast:3 row_mask:0xf bank_mask:0xf
    v_mul_f32_dpp v45, v63, v45 row_newbcast:3 row_mask:0xf bank_mask:0xf
    v_mul_f32_dpp v46, v63, v46 row_newbcast:3 row_mask:0xf bank_mask:0xf
    v_mul_f32_dpp v47, v63, v47 row_newbcast:3 row_mask:0xf bank_mask:0xf
    v_mul_f32_dpp v48, v63, v48 row_newbcast:3 row_mask:0xf bank_mask:0xf
    v_mul_f32_dpp v49, v63, v49 row_newbcast:3 row_mask:0xf bank_mask:0xf
    v_mul_f32_dpp v50, v63, v50 row_newbcast:3 row_mask:0xf bank_mask:0xf
    v_mul_f32_dpp v51, v63, v51 row_newbcast:3 row_mask:0xf bank_mask:0xf
k2_attn_kernel_nr7:
    v_mul_f32 v72, s21, v60
    v_fma_f32 v56, v52, s21, -v72
    v_fma_f32 v57, v53, s21, -v72
    v_fma_f32 v58, v54, s21, -v72
    v_fma_f32 v59, v55, s21, -v72
    v_exp_f32 v56, v56
    v_exp_f32 v57, v57
    v_exp_f32 v58, v58
    v_exp_f32 v59, v59
    s_waitcnt vmcnt(28)
    v_add_f32 v62, v56, v57
    v_add_f32 v63, v58, v59
    v_add_f32 v61, v61, v62
    v_add_f32 v61, v61, v63
    v_lshlrev_b32 v64, 16, v192
    v_and_b32 v65, 0xffff0000, v192
    v_lshlrev_b32 v66, 16, v193
    v_and_b32 v67, 0xffff0000, v193
    v_lshlrev_b32 v68, 16, v194
    v_and_b32 v69, 0xffff0000, v194
    v_lshlrev_b32 v70, 16, v195
    v_and_b32 v71, 0xffff0000, v195
    v_fmac_f32_dpp v20, v56, v64 row_newbcast:0 row_mask:0xf bank_mask:0xf
    v_fmac_f32_dpp v21, v56, v65 row_newbcast:0 row_mask:0xf bank_mask:0xf
    v_fmac_f32_dpp v22, v56, v66 row_newbcast:0 row_mask:0xf bank_mask:0xf
    v_fmac_f32_dpp v23, v56, v67 row_newbcast:0 row_mask:0xf bank_mask:0xf
    v_fmac_f32_dpp v24, v56, v68 row_newbcast:0 row_mask:0xf bank_mask:0xf
    v_fmac_f32_dpp v25, v56, v69 row_newbcast:0 row_mask:0xf bank_mask:0xf
    v_fmac_f32_dpp v26, v56, v70 row_newbcast:0 row_mask:0xf bank_mask:0xf
    v_fmac_f32_dpp v27, v56, v71 row_newbcast:0 row_mask:0xf bank_mask:0xf
    v_fmac_f32_dpp v28, v56, v64 row_newbcast:1 row_mask:0xf bank_mask:0xf
    v_fmac_f32_dpp v29, v56, v65 row_newbcast:1 row_mask:0xf bank_mask:0xf
    v_fmac_f32_dpp v30, v56, v66 row_newbcast:1 row_mask:0xf bank_mask:0xf
    v_fmac_f32_dpp v31, v56, v67 row_newbcast:1 row_mask:0xf bank_mask:0xf
    v_fmac_f32_dpp v32, v56, v68 row_newbcast:1 row_mask:0xf bank_mask:0xf
    v_fmac_f32_dpp v33, v56, v69 row_newbcast:1 row_mask:0xf bank_mask:0xf
    v_fmac_f32_dpp v34, v56, v70 row_newbcast:1 row_mask:0xf bank_mask:0xf
    v_fmac_f32_dpp v35, v56, v71 row_newbcast:1 row_mask:0xf bank_mask:0xf
    v_fmac_f32_dpp v36, v56, v64 row_newbcast:2 row_mask:0xf bank_mask:0xf
    v_fmac_f32_dpp v37, v56, v65 row_newbcast:2 row_mask:0xf bank_mask:0xf
    v_fmac_f32_dpp v38, v56, v66 row_newbcast:2 row_mask:0xf bank_mask:0xf
    v_fmac_f32_dpp v39, v56, v67 row_newbcast:2 row_mask:0xf bank_mask:0xf
    v_fmac_f32_dpp v40, v56, v68 row_newbcast:2 row_mask:0xf bank_mask:0xf
    v_fmac_f32_dpp v41, v56, v69 row_newbcast:2 row_mask:0xf bank_mask:0xf
    v_fmac_f32_dpp v42, v56, v70 row_newbcast:2 row_mask:0xf bank_mask:0xf
    v_fmac_f32_dpp v43, v56, v71 row_newbcast:2 row_mask:0xf bank_mask:0xf
    v_fmac_f32_dpp v44, v56, v64 row_newbcast:3 row_mask:0xf bank_mask:0xf
    v_fmac_f32_dpp v45, v56, v65 row_newbcast:3 row_mask:0xf bank_mask:0xf
    v_fmac_f32_dpp v46, v56, v66 row_newbcast:3 row_mask:0xf bank_mask:0xf
    v_fmac_f32_dpp v47, v56, v67 row_newbcast:3 row_mask:0xf bank_mask:0xf
    v_fmac_f32_dpp v48, v56, v68 row_newbcast:3 row_mask:0xf bank_mask:0xf
    v_fmac_f32_dpp v49, v56, v69 row_newbcast:3 row_mask:0xf bank_mask:0xf
    v_fmac_f32_dpp v50, v56, v70 row_newbcast:3 row_mask:0xf bank_mask:0xf
    v_fmac_f32_dpp v51, v56, v71 row_newbcast:3 row_mask:0xf bank_mask:0xf
    v_lshlrev_b32 v64, 16, v196
    v_and_b32 v65, 0xffff0000, v196
    v_lshlrev_b32 v66, 16, v197
    v_and_b32 v67, 0xffff0000, v197
    v_lshlrev_b32 v68, 16, v198
    v_and_b32 v69, 0xffff0000, v198
    v_lshlrev_b32 v70, 16, v199
    v_and_b32 v71, 0xffff0000, v199
    v_fmac_f32_dpp v20, v57, v64 row_newbcast:0 row_mask:0xf bank_mask:0xf
    v_fmac_f32_dpp v21, v57, v65 row_newbcast:0 row_mask:0xf bank_mask:0xf
    v_fmac_f32_dpp v22, v57, v66 row_newbcast:0 row_mask:0xf bank_mask:0xf
    v_fmac_f32_dpp v23, v57, v67 row_newbcast:0 row_mask:0xf bank_mask:0xf
    v_fmac_f32_dpp v24, v57, v68 row_newbcast:0 row_mask:0xf bank_mask:0xf
    v_fmac_f32_dpp v25, v57, v69 row_newbcast:0 row_mask:0xf bank_mask:0xf
    v_fmac_f32_dpp v26, v57, v70 row_newbcast:0 row_mask:0xf bank_mask:0xf
    v_fmac_f32_dpp v27, v57, v71 row_newbcast:0 row_mask:0xf bank_mask:0xf
    v_fmac_f32_dpp v28, v57, v64 row_newbcast:1 row_mask:0xf bank_mask:0xf
    v_fmac_f32_dpp v29, v57, v65 row_newbcast:1 row_mask:0xf bank_mask:0xf
    v_fmac_f32_dpp v30, v57, v66 row_newbcast:1 row_mask:0xf bank_mask:0xf
    v_fmac_f32_dpp v31, v57, v67 row_newbcast:1 row_mask:0xf bank_mask:0xf
    v_fmac_f32_dpp v32, v57, v68 row_newbcast:1 row_mask:0xf bank_mask:0xf
    v_fmac_f32_dpp v33, v57, v69 row_newbcast:1 row_mask:0xf bank_mask:0xf
    v_fmac_f32_dpp v34, v57, v70 row_newbcast:1 row_mask:0xf bank_mask:0xf
    v_fmac_f32_dpp v35, v57, v71 row_newbcast:1 row_mask:0xf bank_mask:0xf
    v_fmac_f32_dpp v36, v57, v64 row_newbcast:2 row_mask:0xf bank_mask:0xf
    v_fmac_f32_dpp v37, v57, v65 row_newbcast:2 row_mask:0xf bank_mask:0xf
    v_fmac_f32_dpp v38, v57, v66 row_newbcast:2 row_mask:0xf bank_mask:0xf
    v_fmac_f32_dpp v39, v57, v67 row_newbcast:2 row_mask:0xf bank_mask:0xf
    v_fmac_f32_dpp v40, v57, v68 row_newbcast:2 row_mask:0xf bank_mask:0xf
    v_fmac_f32_dpp v41, v57, v69 row_newbcast:2 row_mask:0xf bank_mask:0xf
    v_fmac_f32_dpp v42, v57, v70 row_newbcast:2 row_mask:0xf bank_mask:0xf
    v_fmac_f32_dpp v43, v57, v71 row_newbcast:2 row_mask:0xf bank_mask:0xf
    v_fmac_f32_dpp v44, v57, v64 row_newbcast:3 row_mask:0xf bank_mask:0xf
    v_fmac_f32_dpp v45, v57, v65 row_newbcast:3 row_mask:0xf bank_mask:0xf
    v_fmac_f32_dpp v46, v57, v66 row_newbcast:3 row_mask:0xf bank_mask:0xf
    v_fmac_f32_dpp v47, v57, v67 row_newbcast:3 row_mask:0xf bank_mask:0xf
    v_fmac_f32_dpp v48, v57, v68 row_newbcast:3 row_mask:0xf bank_mask:0xf
    v_fmac_f32_dpp v49, v57, v69 row_newbcast:3 row_mask:0xf bank_mask:0xf
    v_fmac_f32_dpp v50, v57, v70 row_newbcast:3 row_mask:0xf bank_mask:0xf
    v_fmac_f32_dpp v51, v57, v71 row_newbcast:3 row_mask:0xf bank_mask:0xf
    v_lshlrev_b32 v64, 16, v200
    v_and_b32 v65, 0xffff0000, v200
    v_lshlrev_b32 v66, 16, v201
    v_and_b32 v67, 0xffff0000, v201
    v_lshlrev_b32 v68, 16, v202
    v_and_b32 v69, 0xffff0000, v202
    v_lshlrev_b32 v70, 16, v203
    v_and_b32 v71, 0xffff0000, v203
    v_fmac_f32_dpp v20, v58, v64 row_newbcast:0 row_mask:0xf bank_mask:0xf
    v_fmac_f32_dpp v21, v58, v65 row_newbcast:0 row_mask:0xf bank_mask:0xf
    v_fmac_f32_dpp v22, v58, v66 row_newbcast:0 row_mask:0xf bank_mask:0xf
    v_fmac_f32_dpp v23, v58, v67 row_newbcast:0 row_mask:0xf bank_mask:0xf
    v_fmac_f32_dpp v24, v58, v68 row_newbcast:0 row_mask:0xf bank_mask:0xf
    v_fmac_f32_dpp v25, v58, v69 row_newbcast:0 row_mask:0xf bank_mask:0xf
    v_fmac_f32_dpp v26, v58, v70 row_newbcast:0 row_mask:0xf bank_mask:0xf
    v_fmac_f32_dpp v27, v58, v71 row_newbcast:0 row_mask:0xf bank_mask:0xf
    v_fmac_f32_dpp v28, v58, v64 row_newbcast:1 row_mask:0xf bank_mask:0xf
    v_fmac_f32_dpp v29, v58, v65 row_newbcast:1 row_mask:0xf bank_mask:0xf
    v_fmac_f32_dpp v30, v58, v66 row_newbcast:1 row_mask:0xf bank_mask:0xf
    v_fmac_f32_dpp v31, v58, v67 row_newbcast:1 row_mask:0xf bank_mask:0xf
    v_fmac_f32_dpp v32, v58, v68 row_newbcast:1 row_mask:0xf bank_mask:0xf
    v_fmac_f32_dpp v33, v58, v69 row_newbcast:1 row_mask:0xf bank_mask:0xf
    v_fmac_f32_dpp v34, v58, v70 row_newbcast:1 row_mask:0xf bank_mask:0xf
    v_fmac_f32_dpp v35, v58, v71 row_newbcast:1 row_mask:0xf bank_mask:0xf
    v_fmac_f32_dpp v36, v58, v64 row_newbcast:2 row_mask:0xf bank_mask:0xf
    v_fmac_f32_dpp v37, v58, v65 row_newbcast:2 row_mask:0xf bank_mask:0xf
    v_fmac_f32_dpp v38, v58, v66 row_newbcast:2 row_mask:0xf bank_mask:0xf
    v_fmac_f32_dpp v39, v58, v67 row_newbcast:2 row_mask:0xf bank_mask:0xf
    v_fmac_f32_dpp v40, v58, v68 row_newbcast:2 row_mask:0xf bank_mask:0xf
    v_fmac_f32_dpp v41, v58, v69 row_newbcast:2 row_mask:0xf bank_mask:0xf
    v_fmac_f32_dpp v42, v58, v70 row_newbcast:2 row_mask:0xf bank_mask:0xf
    v_fmac_f32_dpp v43, v58, v71 row_newbcast:2 row_mask:0xf bank_mask:0xf
    v_fmac_f32_dpp v44, v58, v64 row_newbcast:3 row_mask:0xf bank_mask:0xf
    v_fmac_f32_dpp v45, v58, v65 row_newbcast:3 row_mask:0xf bank_mask:0xf
    v_fmac_f32_dpp v46, v58, v66 row_newbcast:3 row_mask:0xf bank_mask:0xf
    v_fmac_f32_dpp v47, v58, v67 row_newbcast:3 row_mask:0xf bank_mask:0xf
    v_fmac_f32_dpp v48, v58, v68 row_newbcast:3 row_mask:0xf bank_mask:0xf
    v_fmac_f32_dpp v49, v58, v69 row_newbcast:3 row_mask:0xf bank_mask:0xf
    v_fmac_f32_dpp v50, v58, v70 row_newbcast:3 row_mask:0xf bank_mask:0xf
    v_fmac_f32_dpp v51, v58, v71 row_newbcast:3 row_mask:0xf bank_mask:0xf
    v_lshlrev_b32 v64, 16, v204
    v_and_b32 v65, 0xffff0000, v204
    v_lshlrev_b32 v66, 16, v205
    v_and_b32 v67, 0xffff0000, v205
    v_lshlrev_b32 v68, 16, v206
    v_and_b32 v69, 0xffff0000, v206
    v_lshlrev_b32 v70, 16, v207
    v_and_b32 v71, 0xffff0000, v207
    v_fmac_f32_dpp v20, v59, v64 row_newbcast:0 row_mask:0xf bank_mask:0xf
    v_fmac_f32_dpp v21, v59, v65 row_newbcast:0 row_mask:0xf bank_mask:0xf
    v_fmac_f32_dpp v22, v59, v66 row_newbcast:0 row_mask:0xf bank_mask:0xf
    v_fmac_f32_dpp v23, v59, v67 row_newbcast:0 row_mask:0xf bank_mask:0xf
    v_fmac_f32_dpp v24, v59, v68 row_newbcast:0 row_mask:0xf bank_mask:0xf
    v_fmac_f32_dpp v25, v59, v69 row_newbcast:0 row_mask:0xf bank_mask:0xf
    v_fmac_f32_dpp v26, v59, v70 row_newbcast:0 row_mask:0xf bank_mask:0xf
    v_fmac_f32_dpp v27, v59, v71 row_newbcast:0 row_mask:0xf bank_mask:0xf
    v_fmac_f32_dpp v28, v59, v64 row_newbcast:1 row_mask:0xf bank_mask:0xf
    v_fmac_f32_dpp v29, v59, v65 row_newbcast:1 row_mask:0xf bank_mask:0xf
    v_fmac_f32_dpp v30, v59, v66 row_newbcast:1 row_mask:0xf bank_mask:0xf
    v_fmac_f32_dpp v31, v59, v67 row_newbcast:1 row_mask:0xf bank_mask:0xf
    v_fmac_f32_dpp v32, v59, v68 row_newbcast:1 row_mask:0xf bank_mask:0xf
    v_fmac_f32_dpp v33, v59, v69 row_newbcast:1 row_mask:0xf bank_mask:0xf
    v_fmac_f32_dpp v34, v59, v70 row_newbcast:1 row_mask:0xf bank_mask:0xf
    v_fmac_f32_dpp v35, v59, v71 row_newbcast:1 row_mask:0xf bank_mask:0xf
    v_fmac_f32_dpp v36, v59, v64 row_newbcast:2 row_mask:0xf bank_mask:0xf
    v_fmac_f32_dpp v37, v59, v65 row_newbcast:2 row_mask:0xf bank_mask:0xf
    v_fmac_f32_dpp v38, v59, v66 row_newbcast:2 row_mask:0xf bank_mask:0xf
    v_fmac_f32_dpp v39, v59, v67 row_newbcast:2 row_mask:0xf bank_mask:0xf
    v_fmac_f32_dpp v40, v59, v68 row_newbcast:2 row_mask:0xf bank_mask:0xf
    v_fmac_f32_dpp v41, v59, v69 row_newbcast:2 row_mask:0xf bank_mask:0xf
    v_fmac_f32_dpp v42, v59, v70 row_newbcast:2 row_mask:0xf bank_mask:0xf
    v_fmac_f32_dpp v43, v59, v71 row_newbcast:2 row_mask:0xf bank_mask:0xf
    v_fmac_f32_dpp v44, v59, v64 row_newbcast:3 row_mask:0xf bank_mask:0xf
    v_fmac_f32_dpp v45, v59, v65 row_newbcast:3 row_mask:0xf bank_mask:0xf
    v_fmac_f32_dpp v46, v59, v66 row_newbcast:3 row_mask:0xf bank_mask:0xf
    v_fmac_f32_dpp v47, v59, v67 row_newbcast:3 row_mask:0xf bank_mask:0xf
    v_fmac_f32_dpp v48, v59, v68 row_newbcast:3 row_mask:0xf bank_mask:0xf
    v_fmac_f32_dpp v49, v59, v69 row_newbcast:3 row_mask:0xf bank_mask:0xf
    v_fmac_f32_dpp v50, v59, v70 row_newbcast:3 row_mask:0xf bank_mask:0xf
    v_fmac_f32_dpp v51, v59, v71 row_newbcast:3 row_mask:0xf bank_mask:0xf
    s_add_u32 s19, s17, 45056
    buffer_load_dwordx4 v[192:195], v2, s[8:11], s19 offen offset:0 nt
    buffer_load_dwordx4 v[196:199], v2, s[8:11], s19 offen offset:256 nt
    buffer_load_dwordx4 v[200:203], v2, s[8:11], s19 offen offset:512 nt
    buffer_load_dwordx4 v[204:207], v2, s[8:11], s19 offen offset:768 nt
    s_waitcnt vmcnt(28)
    v_mfma_f32_16x16x32_bf16 v[52:55], v[80:83], v[4:7], 0
    v_mfma_f32_16x16x32_bf16 v[52:55], v[84:87], v[8:11], v[52:55]
    v_mfma_f32_16x16x32_bf16 v[52:55], v[88:91], v[12:15], v[52:55]
    v_mfma_f32_16x16x32_bf16 v[52:55], v[92:95], v[16:19], v[52:55]
    s_add_u32 s18, s17, 49152
    buffer_load_dwordx4 v[80:83], v1, s[4:7], s18 offen offset:0 nt
    buffer_load_dwordx4 v[84:87], v1, s[4:7], s18 offen offset:64 nt
    buffer_load_dwordx4 v[88:91], v1, s[4:7], s18 offen offset:128 nt
    buffer_load_dwordx4 v[92:95], v1, s[4:7], s18 offen offset:192 nt
    s_nop 3
    s_nop 1
    v_max3_f32 v62, v52, v53, v54
    v_max3_f32 v62, v62, v55, v60
    v_cmp_gt_f32 vcc, v62, v60
    s_nop 1
    s_cbranch_vccz k2_attn_kernel_nr8
    v_sub_f32 v63, v60, v62
    v_mul_f32 v63, s21, v63
    v_exp_f32 v63, v63
    v_mov_b32 v60, v62
    v_mul_f32 v61, v61, v63
    s_nop 0
    v_mul_f32_dpp v20, v63, v20 row_newbcast:0 row_mask:0xf bank_mask:0xf
    v_mul_f32_dpp v21, v63, v21 row_newbcast:0 row_mask:0xf bank_mask:0xf
    v_mul_f32_dpp v22, v63, v22 row_newbcast:0 row_mask:0xf bank_mask:0xf
    v_mul_f32_dpp v23, v63, v23 row_newbcast:0 row_mask:0xf bank_mask:0xf
    v_mul_f32_dpp v24, v63, v24 row_newbcast:0 row_mask:0xf bank_mask:0xf
    v_mul_f32_dpp v25, v63, v25 row_newbcast:0 row_mask:0xf bank_mask:0xf
    v_mul_f32_dpp v26, v63, v26 row_newbcast:0 row_mask:0xf bank_mask:0xf
    v_mul_f32_dpp v27, v63, v27 row_newbcast:0 row_mask:0xf bank_mask:0xf
    v_mul_f32_dpp v28, v63, v28 row_newbcast:1 row_mask:0xf bank_mask:0xf
    v_mul_f32_dpp v29, v63, v29 row_newbcast:1 row_mask:0xf bank_mask:0xf
    v_mul_f32_dpp v30, v63, v30 row_newbcast:1 row_mask:0xf bank_mask:0xf
    v_mul_f32_dpp v31, v63, v31 row_newbcast:1 row_mask:0xf bank_mask:0xf
    v_mul_f32_dpp v32, v63, v32 row_newbcast:1 row_mask:0xf bank_mask:0xf
    v_mul_f32_dpp v33, v63, v33 row_newbcast:1 row_mask:0xf bank_mask:0xf
    v_mul_f32_dpp v34, v63, v34 row_newbcast:1 row_mask:0xf bank_mask:0xf
    v_mul_f32_dpp v35, v63, v35 row_newbcast:1 row_mask:0xf bank_mask:0xf
    v_mul_f32_dpp v36, v63, v36 row_newbcast:2 row_mask:0xf bank_mask:0xf
    v_mul_f32_dpp v37, v63, v37 row_newbcast:2 row_mask:0xf bank_mask:0xf
    v_mul_f32_dpp v38, v63, v38 row_newbcast:2 row_mask:0xf bank_mask:0xf
    v_mul_f32_dpp v39, v63, v39 row_newbcast:2 row_mask:0xf bank_mask:0xf
    v_mul_f32_dpp v40, v63, v40 row_newbcast:2 row_mask:0xf bank_mask:0xf
    v_mul_f32_dpp v41, v63, v41 row_newbcast:2 row_mask:0xf bank_mask:0xf
    v_mul_f32_dpp v42, v63, v42 row_newbcast:2 row_mask:0xf bank_mask:0xf
    v_mul_f32_dpp v43, v63, v43 row_newbcast:2 row_mask:0xf bank_mask:0xf
    v_mul_f32_dpp v44, v63, v44 row_newbcast:3 row_mask:0xf bank_mask:0xf
    v_mul_f32_dpp v45, v63, v45 row_newbcast:3 row_mask:0xf bank_mask:0xf
    v_mul_f32_dpp v46, v63, v46 row_newbcast:3 row_mask:0xf bank_mask:0xf
    v_mul_f32_dpp v47, v63, v47 row_newbcast:3 row_mask:0xf bank_mask:0xf
    v_mul_f32_dpp v48, v63, v48 row_newbcast:3 row_mask:0xf bank_mask:0xf
    v_mul_f32_dpp v49, v63, v49 row_newbcast:3 row_mask:0xf bank_mask:0xf
    v_mul_f32_dpp v50, v63, v50 row_newbcast:3 row_mask:0xf bank_mask:0xf
    v_mul_f32_dpp v51, v63, v51 row_newbcast:3 row_mask:0xf bank_mask:0xf
k2_attn_kernel_nr8:
    v_mul_f32 v72, s21, v60
    v_fma_f32 v56, v52, s21, -v72
    v_fma_f32 v57, v53, s21, -v72
    v_fma_f32 v58, v54, s21, -v72
    v_fma_f32 v59, v55, s21, -v72
    v_exp_f32 v56, v56
    v_exp_f32 v57, v57
    v_exp_f32 v58, v58
    v_exp_f32 v59, v59
    s_waitcnt vmcnt(28)
    v_add_f32 v62, v56, v57
    v_add_f32 v63, v58, v59
    v_add_f32 v61, v61, v62
    v_add_f32 v61, v61, v63
    v_lshlrev_b32 v64, 16, v144
    v_and_b32 v65, 0xffff0000, v144
    v_lshlrev_b32 v66, 16, v145
    v_and_b32 v67, 0xffff0000, v145
    v_lshlrev_b32 v68, 16, v146
    v_and_b32 v69, 0xffff0000, v146
    v_lshlrev_b32 v70, 16, v147
    v_and_b32 v71, 0xffff0000, v147
    v_fmac_f32_dpp v20, v56, v64 row_newbcast:0 row_mask:0xf bank_mask:0xf
    v_fmac_f32_dpp v21, v56, v65 row_newbcast:0 row_mask:0xf bank_mask:0xf
    v_fmac_f32_dpp v22, v56, v66 row_newbcast:0 row_mask:0xf bank_mask:0xf
    v_fmac_f32_dpp v23, v56, v67 row_newbcast:0 row_mask:0xf bank_mask:0xf
    v_fmac_f32_dpp v24, v56, v68 row_newbcast:0 row_mask:0xf bank_mask:0xf
    v_fmac_f32_dpp v25, v56, v69 row_newbcast:0 row_mask:0xf bank_mask:0xf
    v_fmac_f32_dpp v26, v56, v70 row_newbcast:0 row_mask:0xf bank_mask:0xf
    v_fmac_f32_dpp v27, v56, v71 row_newbcast:0 row_mask:0xf bank_mask:0xf
    v_fmac_f32_dpp v28, v56, v64 row_newbcast:1 row_mask:0xf bank_mask:0xf
    v_fmac_f32_dpp v29, v56, v65 row_newbcast:1 row_mask:0xf bank_mask:0xf
    v_fmac_f32_dpp v30, v56, v66 row_newbcast:1 row_mask:0xf bank_mask:0xf
    v_fmac_f32_dpp v31, v56, v67 row_newbcast:1 row_mask:0xf bank_mask:0xf
    v_fmac_f32_dpp v32, v56, v68 row_newbcast:1 row_mask:0xf bank_mask:0xf
    v_fmac_f32_dpp v33, v56, v69 row_newbcast:1 row_mask:0xf bank_mask:0xf
    v_fmac_f32_dpp v34, v56, v70 row_newbcast:1 row_mask:0xf bank_mask:0xf
    v_fmac_f32_dpp v35, v56, v71 row_newbcast:1 row_mask:0xf bank_mask:0xf
    v_fmac_f32_dpp v36, v56, v64 row_newbcast:2 row_mask:0xf bank_mask:0xf
    v_fmac_f32_dpp v37, v56, v65 row_newbcast:2 row_mask:0xf bank_mask:0xf
    v_fmac_f32_dpp v38, v56, v66 row_newbcast:2 row_mask:0xf bank_mask:0xf
    v_fmac_f32_dpp v39, v56, v67 row_newbcast:2 row_mask:0xf bank_mask:0xf
    v_fmac_f32_dpp v40, v56, v68 row_newbcast:2 row_mask:0xf bank_mask:0xf
    v_fmac_f32_dpp v41, v56, v69 row_newbcast:2 row_mask:0xf bank_mask:0xf
    v_fmac_f32_dpp v42, v56, v70 row_newbcast:2 row_mask:0xf bank_mask:0xf
    v_fmac_f32_dpp v43, v56, v71 row_newbcast:2 row_mask:0xf bank_mask:0xf
    v_fmac_f32_dpp v44, v56, v64 row_newbcast:3 row_mask:0xf bank_mask:0xf
    v_fmac_f32_dpp v45, v56, v65 row_newbcast:3 row_mask:0xf bank_mask:0xf
    v_fmac_f32_dpp v46, v56, v66 row_newbcast:3 row_mask:0xf bank_mask:0xf
    v_fmac_f32_dpp v47, v56, v67 row_newbcast:3 row_mask:0xf bank_mask:0xf
    v_fmac_f32_dpp v48, v56, v68 row_newbcast:3 row_mask:0xf bank_mask:0xf
    v_fmac_f32_dpp v49, v56, v69 row_newbcast:3 row_mask:0xf bank_mask:0xf
    v_fmac_f32_dpp v50, v56, v70 row_newbcast:3 row_mask:0xf bank_mask:0xf
    v_fmac_f32_dpp v51, v56, v71 row_newbcast:3 row_mask:0xf bank_mask:0xf
    v_lshlrev_b32 v64, 16, v148
    v_and_b32 v65, 0xffff0000, v148
    v_lshlrev_b32 v66, 16, v149
    v_and_b32 v67, 0xffff0000, v149
    v_lshlrev_b32 v68, 16, v150
    v_and_b32 v69, 0xffff0000, v150
    v_lshlrev_b32 v70, 16, v151
    v_and_b32 v71, 0xffff0000, v151
    v_fmac_f32_dpp v20, v57, v64 row_newbcast:0 row_mask:0xf bank_mask:0xf
    v_fmac_f32_dpp v21, v57, v65 row_newbcast:0 row_mask:0xf bank_mask:0xf
    v_fmac_f32_dpp v22, v57, v66 row_newbcast:0 row_mask:0xf bank_mask:0xf
    v_fmac_f32_dpp v23, v57, v67 row_newbcast:0 row_mask:0xf bank_mask:0xf
    v_fmac_f32_dpp v24, v57, v68 row_newbcast:0 row_mask:0xf bank_mask:0xf
    v_fmac_f32_dpp v25, v57, v69 row_newbcast:0 row_mask:0xf bank_mask:0xf
    v_fmac_f32_dpp v26, v57, v70 row_newbcast:0 row_mask:0xf bank_mask:0xf
    v_fmac_f32_dpp v27, v57, v71 row_newbcast:0 row_mask:0xf bank_mask:0xf
    v_fmac_f32_dpp v28, v57, v64 row_newbcast:1 row_mask:0xf bank_mask:0xf
    v_fmac_f32_dpp v29, v57, v65 row_newbcast:1 row_mask:0xf bank_mask:0xf
    v_fmac_f32_dpp v30, v57, v66 row_newbcast:1 row_mask:0xf bank_mask:0xf
    v_fmac_f32_dpp v31, v57, v67 row_newbcast:1 row_mask:0xf bank_mask:0xf
    v_fmac_f32_dpp v32, v57, v68 row_newbcast:1 row_mask:0xf bank_mask:0xf
    v_fmac_f32_dpp v33, v57, v69 row_newbcast:1 row_mask:0xf bank_mask:0xf
    v_fmac_f32_dpp v34, v57, v70 row_newbcast:1 row_mask:0xf bank_mask:0xf
    v_fmac_f32_dpp v35, v57, v71 row_newbcast:1 row_mask:0xf bank_mask:0xf
    v_fmac_f32_dpp v36, v57, v64 row_newbcast:2 row_mask:0xf bank_mask:0xf
    v_fmac_f32_dpp v37, v57, v65 row_newbcast:2 row_mask:0xf bank_mask:0xf
    v_fmac_f32_dpp v38, v57, v66 row_newbcast:2 row_mask:0xf bank_mask:0xf
    v_fmac_f32_dpp v39, v57, v67 row_newbcast:2 row_mask:0xf bank_mask:0xf
    v_fmac_f32_dpp v40, v57, v68 row_newbcast:2 row_mask:0xf bank_mask:0xf
    v_fmac_f32_dpp v41, v57, v69 row_newbcast:2 row_mask:0xf bank_mask:0xf
    v_fmac_f32_dpp v42, v57, v70 row_newbcast:2 row_mask:0xf bank_mask:0xf
    v_fmac_f32_dpp v43, v57, v71 row_newbcast:2 row_mask:0xf bank_mask:0xf
    v_fmac_f32_dpp v44, v57, v64 row_newbcast:3 row_mask:0xf bank_mask:0xf
    v_fmac_f32_dpp v45, v57, v65 row_newbcast:3 row_mask:0xf bank_mask:0xf
    v_fmac_f32_dpp v46, v57, v66 row_newbcast:3 row_mask:0xf bank_mask:0xf
    v_fmac_f32_dpp v47, v57, v67 row_newbcast:3 row_mask:0xf bank_mask:0xf
    v_fmac_f32_dpp v48, v57, v68 row_newbcast:3 row_mask:0xf bank_mask:0xf
    v_fmac_f32_dpp v49, v57, v69 row_newbcast:3 row_mask:0xf bank_mask:0xf
    v_fmac_f32_dpp v50, v57, v70 row_newbcast:3 row_mask:0xf bank_mask:0xf
    v_fmac_f32_dpp v51, v57, v71 row_newbcast:3 row_mask:0xf bank_mask:0xf
    v_lshlrev_b32 v64, 16, v152
    v_and_b32 v65, 0xffff0000, v152
    v_lshlrev_b32 v66, 16, v153
    v_and_b32 v67, 0xffff0000, v153
    v_lshlrev_b32 v68, 16, v154
    v_and_b32 v69, 0xffff0000, v154
    v_lshlrev_b32 v70, 16, v155
    v_and_b32 v71, 0xffff0000, v155
    v_fmac_f32_dpp v20, v58, v64 row_newbcast:0 row_mask:0xf bank_mask:0xf
    v_fmac_f32_dpp v21, v58, v65 row_newbcast:0 row_mask:0xf bank_mask:0xf
    v_fmac_f32_dpp v22, v58, v66 row_newbcast:0 row_mask:0xf bank_mask:0xf
    v_fmac_f32_dpp v23, v58, v67 row_newbcast:0 row_mask:0xf bank_mask:0xf
    v_fmac_f32_dpp v24, v58, v68 row_newbcast:0 row_mask:0xf bank_mask:0xf
    v_fmac_f32_dpp v25, v58, v69 row_newbcast:0 row_mask:0xf bank_mask:0xf
    v_fmac_f32_dpp v26, v58, v70 row_newbcast:0 row_mask:0xf bank_mask:0xf
    v_fmac_f32_dpp v27, v58, v71 row_newbcast:0 row_mask:0xf bank_mask:0xf
    v_fmac_f32_dpp v28, v58, v64 row_newbcast:1 row_mask:0xf bank_mask:0xf
    v_fmac_f32_dpp v29, v58, v65 row_newbcast:1 row_mask:0xf bank_mask:0xf
    v_fmac_f32_dpp v30, v58, v66 row_newbcast:1 row_mask:0xf bank_mask:0xf
    v_fmac_f32_dpp v31, v58, v67 row_newbcast:1 row_mask:0xf bank_mask:0xf
    v_fmac_f32_dpp v32, v58, v68 row_newbcast:1 row_mask:0xf bank_mask:0xf
    v_fmac_f32_dpp v33, v58, v69 row_newbcast:1 row_mask:0xf bank_mask:0xf
    v_fmac_f32_dpp v34, v58, v70 row_newbcast:1 row_mask:0xf bank_mask:0xf
    v_fmac_f32_dpp v35, v58, v71 row_newbcast:1 row_mask:0xf bank_mask:0xf
    v_fmac_f32_dpp v36, v58, v64 row_newbcast:2 row_mask:0xf bank_mask:0xf
    v_fmac_f32_dpp v37, v58, v65 row_newbcast:2 row_mask:0xf bank_mask:0xf
    v_fmac_f32_dpp v38, v58, v66 row_newbcast:2 row_mask:0xf bank_mask:0xf
    v_fmac_f32_dpp v39, v58, v67 row_newbcast:2 row_mask:0xf bank_mask:0xf
    v_fmac_f32_dpp v40, v58, v68 row_newbcast:2 row_mask:0xf bank_mask:0xf
    v_fmac_f32_dpp v41, v58, v69 row_newbcast:2 row_mask:0xf bank_mask:0xf
    v_fmac_f32_dpp v42, v58, v70 row_newbcast:2 row_mask:0xf bank_mask:0xf
    v_fmac_f32_dpp v43, v58, v71 row_newbcast:2 row_mask:0xf bank_mask:0xf
    v_fmac_f32_dpp v44, v58, v64 row_newbcast:3 row_mask:0xf bank_mask:0xf
    v_fmac_f32_dpp v45, v58, v65 row_newbcast:3 row_mask:0xf bank_mask:0xf
    v_fmac_f32_dpp v46, v58, v66 row_newbcast:3 row_mask:0xf bank_mask:0xf
    v_fmac_f32_dpp v47, v58, v67 row_newbcast:3 row_mask:0xf bank_mask:0xf
    v_fmac_f32_dpp v48, v58, v68 row_newbcast:3 row_mask:0xf bank_mask:0xf
    v_fmac_f32_dpp v49, v58, v69 row_newbcast:3 row_mask:0xf bank_mask:0xf
    v_fmac_f32_dpp v50, v58, v70 row_newbcast:3 row_mask:0xf bank_mask:0xf
    v_fmac_f32_dpp v51, v58, v71 row_newbcast:3 row_mask:0xf bank_mask:0xf
    v_lshlrev_b32 v64, 16, v156
    v_and_b32 v65, 0xffff0000, v156
    v_lshlrev_b32 v66, 16, v157
    v_and_b32 v67, 0xffff0000, v157
    v_lshlrev_b32 v68, 16, v158
    v_and_b32 v69, 0xffff0000, v158
    v_lshlrev_b32 v70, 16, v159
    v_and_b32 v71, 0xffff0000, v159
    v_fmac_f32_dpp v20, v59, v64 row_newbcast:0 row_mask:0xf bank_mask:0xf
    v_fmac_f32_dpp v21, v59, v65 row_newbcast:0 row_mask:0xf bank_mask:0xf
    v_fmac_f32_dpp v22, v59, v66 row_newbcast:0 row_mask:0xf bank_mask:0xf
    v_fmac_f32_dpp v23, v59, v67 row_newbcast:0 row_mask:0xf bank_mask:0xf
    v_fmac_f32_dpp v24, v59, v68 row_newbcast:0 row_mask:0xf bank_mask:0xf
    v_fmac_f32_dpp v25, v59, v69 row_newbcast:0 row_mask:0xf bank_mask:0xf
    v_fmac_f32_dpp v26, v59, v70 row_newbcast:0 row_mask:0xf bank_mask:0xf
    v_fmac_f32_dpp v27, v59, v71 row_newbcast:0 row_mask:0xf bank_mask:0xf
    v_fmac_f32_dpp v28, v59, v64 row_newbcast:1 row_mask:0xf bank_mask:0xf
    v_fmac_f32_dpp v29, v59, v65 row_newbcast:1 row_mask:0xf bank_mask:0xf
    v_fmac_f32_dpp v30, v59, v66 row_newbcast:1 row_mask:0xf bank_mask:0xf
    v_fmac_f32_dpp v31, v59, v67 row_newbcast:1 row_mask:0xf bank_mask:0xf
    v_fmac_f32_dpp v32, v59, v68 row_newbcast:1 row_mask:0xf bank_mask:0xf
    v_fmac_f32_dpp v33, v59, v69 row_newbcast:1 row_mask:0xf bank_mask:0xf
    v_fmac_f32_dpp v34, v59, v70 row_newbcast:1 row_mask:0xf bank_mask:0xf
    v_fmac_f32_dpp v35, v59, v71 row_newbcast:1 row_mask:0xf bank_mask:0xf
    v_fmac_f32_dpp v36, v59, v64 row_newbcast:2 row_mask:0xf bank_mask:0xf
    v_fmac_f32_dpp v37, v59, v65 row_newbcast:2 row_mask:0xf bank_mask:0xf
    v_fmac_f32_dpp v38, v59, v66 row_newbcast:2 row_mask:0xf bank_mask:0xf
    v_fmac_f32_dpp v39, v59, v67 row_newbcast:2 row_mask:0xf bank_mask:0xf
    v_fmac_f32_dpp v40, v59, v68 row_newbcast:2 row_mask:0xf bank_mask:0xf
    v_fmac_f32_dpp v41, v59, v69 row_newbcast:2 row_mask:0xf bank_mask:0xf
    v_fmac_f32_dpp v42, v59, v70 row_newbcast:2 row_mask:0xf bank_mask:0xf
    v_fmac_f32_dpp v43, v59, v71 row_newbcast:2 row_mask:0xf bank_mask:0xf
    v_fmac_f32_dpp v44, v59, v64 row_newbcast:3 row_mask:0xf bank_mask:0xf
    v_fmac_f32_dpp v45, v59, v65 row_newbcast:3 row_mask:0xf bank_mask:0xf
    v_fmac_f32_dpp v46, v59, v66 row_newbcast:3 row_mask:0xf bank_mask:0xf
    v_fmac_f32_dpp v47, v59, v67 row_newbcast:3 row_mask:0xf bank_mask:0xf
    v_fmac_f32_dpp v48, v59, v68 row_newbcast:3 row_mask:0xf bank_mask:0xf
    v_fmac_f32_dpp v49, v59, v69 row_newbcast:3 row_mask:0xf bank_mask:0xf
    v_fmac_f32_dpp v50, v59, v70 row_newbcast:3 row_mask:0xf bank_mask:0xf
    v_fmac_f32_dpp v51, v59, v71 row_newbcast:3 row_mask:0xf bank_mask:0xf
    s_add_u32 s19, s17, 49152
    buffer_load_dwordx4 v[144:147], v2, s[8:11], s19 offen offset:0 nt
    buffer_load_dwordx4 v[148:151], v2, s[8:11], s19 offen offset:256 nt
    buffer_load_dwordx4 v[152:155], v2, s[8:11], s19 offen offset:512 nt
    buffer_load_dwordx4 v[156:159], v2, s[8:11], s19 offen offset:768 nt
    s_waitcnt vmcnt(28)
    v_mfma_f32_16x16x32_bf16 v[52:55], v[96:99], v[4:7], 0
    v_mfma_f32_16x16x32_bf16 v[52:55], v[100:103], v[8:11], v[52:55]
    v_mfma_f32_16x16x32_bf16 v[52:55], v[104:107], v[12:15], v[52:55]
    v_mfma_f32_16x16x32_bf16 v[52:55], v[108:111], v[16:19], v[52:55]
    s_add_u32 s18, s17, 53248
    buffer_load_dwordx4 v[96:99], v1, s[4:7], s18 offen offset:0 nt
    buffer_load_dwordx4 v[100:103], v1, s[4:7], s18 offen offset:64 nt
    buffer_load_dwordx4 v[104:107], v1, s[4:7], s18 offen offset:128 nt
    buffer_load_dwordx4 v[108:111], v1, s[4:7], s18 offen offset:192 nt
    s_nop 3
    s_nop 1
    v_max3_f32 v62, v52, v53, v54
    v_max3_f32 v62, v62, v55, v60
    v_cmp_gt_f32 vcc, v62, v60
    s_nop 1
    s_cbranch_vccz k2_attn_kernel_nr9
    v_sub_f32 v63, v60, v62
    v_mul_f32 v63, s21, v63
    v_exp_f32 v63, v63
    v_mov_b32 v60, v62
    v_mul_f32 v61, v61, v63
    s_nop 0
    v_mul_f32_dpp v20, v63, v20 row_newbcast:0 row_mask:0xf bank_mask:0xf
    v_mul_f32_dpp v21, v63, v21 row_newbcast:0 row_mask:0xf bank_mask:0xf
    v_mul_f32_dpp v22, v63, v22 row_newbcast:0 row_mask:0xf bank_mask:0xf
    v_mul_f32_dpp v23, v63, v23 row_newbcast:0 row_mask:0xf bank_mask:0xf
    v_mul_f32_dpp v24, v63, v24 row_newbcast:0 row_mask:0xf bank_mask:0xf
    v_mul_f32_dpp v25, v63, v25 row_newbcast:0 row_mask:0xf bank_mask:0xf
    v_mul_f32_dpp v26, v63, v26 row_newbcast:0 row_mask:0xf bank_mask:0xf
    v_mul_f32_dpp v27, v63, v27 row_newbcast:0 row_mask:0xf bank_mask:0xf
    v_mul_f32_dpp v28, v63, v28 row_newbcast:1 row_mask:0xf bank_mask:0xf
    v_mul_f32_dpp v29, v63, v29 row_newbcast:1 row_mask:0xf bank_mask:0xf
    v_mul_f32_dpp v30, v63, v30 row_newbcast:1 row_mask:0xf bank_mask:0xf
    v_mul_f32_dpp v31, v63, v31 row_newbcast:1 row_mask:0xf bank_mask:0xf
    v_mul_f32_dpp v32, v63, v32 row_newbcast:1 row_mask:0xf bank_mask:0xf
    v_mul_f32_dpp v33, v63, v33 row_newbcast:1 row_mask:0xf bank_mask:0xf
    v_mul_f32_dpp v34, v63, v34 row_newbcast:1 row_mask:0xf bank_mask:0xf
    v_mul_f32_dpp v35, v63, v35 row_newbcast:1 row_mask:0xf bank_mask:0xf
    v_mul_f32_dpp v36, v63, v36 row_newbcast:2 row_mask:0xf bank_mask:0xf
    v_mul_f32_dpp v37, v63, v37 row_newbcast:2 row_mask:0xf bank_mask:0xf
    v_mul_f32_dpp v38, v63, v38 row_newbcast:2 row_mask:0xf bank_mask:0xf
    v_mul_f32_dpp v39, v63, v39 row_newbcast:2 row_mask:0xf bank_mask:0xf
    v_mul_f32_dpp v40, v63, v40 row_newbcast:2 row_mask:0xf bank_mask:0xf
    v_mul_f32_dpp v41, v63, v41 row_newbcast:2 row_mask:0xf bank_mask:0xf
    v_mul_f32_dpp v42, v63, v42 row_newbcast:2 row_mask:0xf bank_mask:0xf
    v_mul_f32_dpp v43, v63, v43 row_newbcast:2 row_mask:0xf bank_mask:0xf
    v_mul_f32_dpp v44, v63, v44 row_newbcast:3 row_mask:0xf bank_mask:0xf
    v_mul_f32_dpp v45, v63, v45 row_newbcast:3 row_mask:0xf bank_mask:0xf
    v_mul_f32_dpp v46, v63, v46 row_newbcast:3 row_mask:0xf bank_mask:0xf
    v_mul_f32_dpp v47, v63, v47 row_newbcast:3 row_mask:0xf bank_mask:0xf
    v_mul_f32_dpp v48, v63, v48 row_newbcast:3 row_mask:0xf bank_mask:0xf
    v_mul_f32_dpp v49, v63, v49 row_newbcast:3 row_mask:0xf bank_mask:0xf
    v_mul_f32_dpp v50, v63, v50 row_newbcast:3 row_mask:0xf bank_mask:0xf
    v_mul_f32_dpp v51, v63, v51 row_newbcast:3 row_mask:0xf bank_mask:0xf
k2_attn_kernel_nr9:
    v_mul_f32 v72, s21, v60
    v_fma_f32 v56, v52, s21, -v72
    v_fma_f32 v57, v53, s21, -v72
    v_fma_f32 v58, v54, s21, -v72
    v_fma_f32 v59, v55, s21, -v72
    v_exp_f32 v56, v56
    v_exp_f32 v57, v57
    v_exp_f32 v58, v58
    v_exp_f32 v59, v59
    s_waitcnt vmcnt(28)
    v_add_f32 v62, v56, v57
    v_add_f32 v63, v58, v59
    v_add_f32 v61, v61, v62
    v_add_f32 v61, v61, v63
    v_lshlrev_b32 v64, 16, v160
    v_and_b32 v65, 0xffff0000, v160
    v_lshlrev_b32 v66, 16, v161
    v_and_b32 v67, 0xffff0000, v161
    v_lshlrev_b32 v68, 16, v162
    v_and_b32 v69, 0xffff0000, v162
    v_lshlrev_b32 v70, 16, v163
    v_and_b32 v71, 0xffff0000, v163
    v_fmac_f32_dpp v20, v56, v64 row_newbcast:0 row_mask:0xf bank_mask:0xf
    v_fmac_f32_dpp v21, v56, v65 row_newbcast:0 row_mask:0xf bank_mask:0xf
    v_fmac_f32_dpp v22, v56, v66 row_newbcast:0 row_mask:0xf bank_mask:0xf
    v_fmac_f32_dpp v23, v56, v67 row_newbcast:0 row_mask:0xf bank_mask:0xf
    v_fmac_f32_dpp v24, v56, v68 row_newbcast:0 row_mask:0xf bank_mask:0xf
    v_fmac_f32_dpp v25, v56, v69 row_newbcast:0 row_mask:0xf bank_mask:0xf
    v_fmac_f32_dpp v26, v56, v70 row_newbcast:0 row_mask:0xf bank_mask:0xf
    v_fmac_f32_dpp v27, v56, v71 row_newbcast:0 row_mask:0xf bank_mask:0xf
    v_fmac_f32_dpp v28, v56, v64 row_newbcast:1 row_mask:0xf bank_mask:0xf
    v_fmac_f32_dpp v29, v56, v65 row_newbcast:1 row_mask:0xf bank_mask:0xf
    v_fmac_f32_dpp v30, v56, v66 row_newbcast:1 row_mask:0xf bank_mask:0xf
    v_fmac_f32_dpp v31, v56, v67 row_newbcast:1 row_mask:0xf bank_mask:0xf
    v_fmac_f32_dpp v32, v56, v68 row_newbcast:1 row_mask:0xf bank_mask:0xf
    v_fmac_f32_dpp v33, v56, v69 row_newbcast:1 row_mask:0xf bank_mask:0xf
    v_fmac_f32_dpp v34, v56, v70 row_newbcast:1 row_mask:0xf bank_mask:0xf
    v_fmac_f32_dpp v35, v56, v71 row_newbcast:1 row_mask:0xf bank_mask:0xf
    v_fmac_f32_dpp v36, v56, v64 row_newbcast:2 row_mask:0xf bank_mask:0xf
    v_fmac_f32_dpp v37, v56, v65 row_newbcast:2 row_mask:0xf bank_mask:0xf
    v_fmac_f32_dpp v38, v56, v66 row_newbcast:2 row_mask:0xf bank_mask:0xf
    v_fmac_f32_dpp v39, v56, v67 row_newbcast:2 row_mask:0xf bank_mask:0xf
    v_fmac_f32_dpp v40, v56, v68 row_newbcast:2 row_mask:0xf bank_mask:0xf
    v_fmac_f32_dpp v41, v56, v69 row_newbcast:2 row_mask:0xf bank_mask:0xf
    v_fmac_f32_dpp v42, v56, v70 row_newbcast:2 row_mask:0xf bank_mask:0xf
    v_fmac_f32_dpp v43, v56, v71 row_newbcast:2 row_mask:0xf bank_mask:0xf
    v_fmac_f32_dpp v44, v56, v64 row_newbcast:3 row_mask:0xf bank_mask:0xf
    v_fmac_f32_dpp v45, v56, v65 row_newbcast:3 row_mask:0xf bank_mask:0xf
    v_fmac_f32_dpp v46, v56, v66 row_newbcast:3 row_mask:0xf bank_mask:0xf
    v_fmac_f32_dpp v47, v56, v67 row_newbcast:3 row_mask:0xf bank_mask:0xf
    v_fmac_f32_dpp v48, v56, v68 row_newbcast:3 row_mask:0xf bank_mask:0xf
    v_fmac_f32_dpp v49, v56, v69 row_newbcast:3 row_mask:0xf bank_mask:0xf
    v_fmac_f32_dpp v50, v56, v70 row_newbcast:3 row_mask:0xf bank_mask:0xf
    v_fmac_f32_dpp v51, v56, v71 row_newbcast:3 row_mask:0xf bank_mask:0xf
    v_lshlrev_b32 v64, 16, v164
    v_and_b32 v65, 0xffff0000, v164
    v_lshlrev_b32 v66, 16, v165
    v_and_b32 v67, 0xffff0000, v165
    v_lshlrev_b32 v68, 16, v166
    v_and_b32 v69, 0xffff0000, v166
    v_lshlrev_b32 v70, 16, v167
    v_and_b32 v71, 0xffff0000, v167
    v_fmac_f32_dpp v20, v57, v64 row_newbcast:0 row_mask:0xf bank_mask:0xf
    v_fmac_f32_dpp v21, v57, v65 row_newbcast:0 row_mask:0xf bank_mask:0xf
    v_fmac_f32_dpp v22, v57, v66 row_newbcast:0 row_mask:0xf bank_mask:0xf
    v_fmac_f32_dpp v23, v57, v67 row_newbcast:0 row_mask:0xf bank_mask:0xf
    v_fmac_f32_dpp v24, v57, v68 row_newbcast:0 row_mask:0xf bank_mask:0xf
    v_fmac_f32_dpp v25, v57, v69 row_newbcast:0 row_mask:0xf bank_mask:0xf
    v_fmac_f32_dpp v26, v57, v70 row_newbcast:0 row_mask:0xf bank_mask:0xf
    v_fmac_f32_dpp v27, v57, v71 row_newbcast:0 row_mask:0xf bank_mask:0xf
    v_fmac_f32_dpp v28, v57, v64 row_newbcast:1 row_mask:0xf bank_mask:0xf
    v_fmac_f32_dpp v29, v57, v65 row_newbcast:1 row_mask:0xf bank_mask:0xf
    v_fmac_f32_dpp v30, v57, v66 row_newbcast:1 row_mask:0xf bank_mask:0xf
    v_fmac_f32_dpp v31, v57, v67 row_newbcast:1 row_mask:0xf bank_mask:0xf
    v_fmac_f32_dpp v32, v57, v68 row_newbcast:1 row_mask:0xf bank_mask:0xf
    v_fmac_f32_dpp v33, v57, v69 row_newbcast:1 row_mask:0xf bank_mask:0xf
    v_fmac_f32_dpp v34, v57, v70 row_newbcast:1 row_mask:0xf bank_mask:0xf
    v_fmac_f32_dpp v35, v57, v71 row_newbcast:1 row_mask:0xf bank_mask:0xf
    v_fmac_f32_dpp v36, v57, v64 row_newbcast:2 row_mask:0xf bank_mask:0xf
    v_fmac_f32_dpp v37, v57, v65 row_newbcast:2 row_mask:0xf bank_mask:0xf
    v_fmac_f32_dpp v38, v57, v66 row_newbcast:2 row_mask:0xf bank_mask:0xf
    v_fmac_f32_dpp v39, v57, v67 row_newbcast:2 row_mask:0xf bank_mask:0xf
    v_fmac_f32_dpp v40, v57, v68 row_newbcast:2 row_mask:0xf bank_mask:0xf
    v_fmac_f32_dpp v41, v57, v69 row_newbcast:2 row_mask:0xf bank_mask:0xf
    v_fmac_f32_dpp v42, v57, v70 row_newbcast:2 row_mask:0xf bank_mask:0xf
    v_fmac_f32_dpp v43, v57, v71 row_newbcast:2 row_mask:0xf bank_mask:0xf
    v_fmac_f32_dpp v44, v57, v64 row_newbcast:3 row_mask:0xf bank_mask:0xf
    v_fmac_f32_dpp v45, v57, v65 row_newbcast:3 row_mask:0xf bank_mask:0xf
    v_fmac_f32_dpp v46, v57, v66 row_newbcast:3 row_mask:0xf bank_mask:0xf
    v_fmac_f32_dpp v47, v57, v67 row_newbcast:3 row_mask:0xf bank_mask:0xf
    v_fmac_f32_dpp v48, v57, v68 row_newbcast:3 row_mask:0xf bank_mask:0xf
    v_fmac_f32_dpp v49, v57, v69 row_newbcast:3 row_mask:0xf bank_mask:0xf
    v_fmac_f32_dpp v50, v57, v70 row_newbcast:3 row_mask:0xf bank_mask:0xf
    v_fmac_f32_dpp v51, v57, v71 row_newbcast:3 row_mask:0xf bank_mask:0xf
    v_lshlrev_b32 v64, 16, v168
    v_and_b32 v65, 0xffff0000, v168
    v_lshlrev_b32 v66, 16, v169
    v_and_b32 v67, 0xffff0000, v169
    v_lshlrev_b32 v68, 16, v170
    v_and_b32 v69, 0xffff0000, v170
    v_lshlrev_b32 v70, 16, v171
    v_and_b32 v71, 0xffff0000, v171
    v_fmac_f32_dpp v20, v58, v64 row_newbcast:0 row_mask:0xf bank_mask:0xf
    v_fmac_f32_dpp v21, v58, v65 row_newbcast:0 row_mask:0xf bank_mask:0xf
    v_fmac_f32_dpp v22, v58, v66 row_newbcast:0 row_mask:0xf bank_mask:0xf
    v_fmac_f32_dpp v23, v58, v67 row_newbcast:0 row_mask:0xf bank_mask:0xf
    v_fmac_f32_dpp v24, v58, v68 row_newbcast:0 row_mask:0xf bank_mask:0xf
    v_fmac_f32_dpp v25, v58, v69 row_newbcast:0 row_mask:0xf bank_mask:0xf
    v_fmac_f32_dpp v26, v58, v70 row_newbcast:0 row_mask:0xf bank_mask:0xf
    v_fmac_f32_dpp v27, v58, v71 row_newbcast:0 row_mask:0xf bank_mask:0xf
    v_fmac_f32_dpp v28, v58, v64 row_newbcast:1 row_mask:0xf bank_mask:0xf
    v_fmac_f32_dpp v29, v58, v65 row_newbcast:1 row_mask:0xf bank_mask:0xf
    v_fmac_f32_dpp v30, v58, v66 row_newbcast:1 row_mask:0xf bank_mask:0xf
    v_fmac_f32_dpp v31, v58, v67 row_newbcast:1 row_mask:0xf bank_mask:0xf
    v_fmac_f32_dpp v32, v58, v68 row_newbcast:1 row_mask:0xf bank_mask:0xf
    v_fmac_f32_dpp v33, v58, v69 row_newbcast:1 row_mask:0xf bank_mask:0xf
    v_fmac_f32_dpp v34, v58, v70 row_newbcast:1 row_mask:0xf bank_mask:0xf
    v_fmac_f32_dpp v35, v58, v71 row_newbcast:1 row_mask:0xf bank_mask:0xf
    v_fmac_f32_dpp v36, v58, v64 row_newbcast:2 row_mask:0xf bank_mask:0xf
    v_fmac_f32_dpp v37, v58, v65 row_newbcast:2 row_mask:0xf bank_mask:0xf
    v_fmac_f32_dpp v38, v58, v66 row_newbcast:2 row_mask:0xf bank_mask:0xf
    v_fmac_f32_dpp v39, v58, v67 row_newbcast:2 row_mask:0xf bank_mask:0xf
    v_fmac_f32_dpp v40, v58, v68 row_newbcast:2 row_mask:0xf bank_mask:0xf
    v_fmac_f32_dpp v41, v58, v69 row_newbcast:2 row_mask:0xf bank_mask:0xf
    v_fmac_f32_dpp v42, v58, v70 row_newbcast:2 row_mask:0xf bank_mask:0xf
    v_fmac_f32_dpp v43, v58, v71 row_newbcast:2 row_mask:0xf bank_mask:0xf
    v_fmac_f32_dpp v44, v58, v64 row_newbcast:3 row_mask:0xf bank_mask:0xf
    v_fmac_f32_dpp v45, v58, v65 row_newbcast:3 row_mask:0xf bank_mask:0xf
    v_fmac_f32_dpp v46, v58, v66 row_newbcast:3 row_mask:0xf bank_mask:0xf
    v_fmac_f32_dpp v47, v58, v67 row_newbcast:3 row_mask:0xf bank_mask:0xf
    v_fmac_f32_dpp v48, v58, v68 row_newbcast:3 row_mask:0xf bank_mask:0xf
    v_fmac_f32_dpp v49, v58, v69 row_newbcast:3 row_mask:0xf bank_mask:0xf
    v_fmac_f32_dpp v50, v58, v70 row_newbcast:3 row_mask:0xf bank_mask:0xf
    v_fmac_f32_dpp v51, v58, v71 row_newbcast:3 row_mask:0xf bank_mask:0xf
    v_lshlrev_b32 v64, 16, v172
    v_and_b32 v65, 0xffff0000, v172
    v_lshlrev_b32 v66, 16, v173
    v_and_b32 v67, 0xffff0000, v173
    v_lshlrev_b32 v68, 16, v174
    v_and_b32 v69, 0xffff0000, v174
    v_lshlrev_b32 v70, 16, v175
    v_and_b32 v71, 0xffff0000, v175
    v_fmac_f32_dpp v20, v59, v64 row_newbcast:0 row_mask:0xf bank_mask:0xf
    v_fmac_f32_dpp v21, v59, v65 row_newbcast:0 row_mask:0xf bank_mask:0xf
    v_fmac_f32_dpp v22, v59, v66 row_newbcast:0 row_mask:0xf bank_mask:0xf
    v_fmac_f32_dpp v23, v59, v67 row_newbcast:0 row_mask:0xf bank_mask:0xf
    v_fmac_f32_dpp v24, v59, v68 row_newbcast:0 row_mask:0xf bank_mask:0xf
    v_fmac_f32_dpp v25, v59, v69 row_newbcast:0 row_mask:0xf bank_mask:0xf
    v_fmac_f32_dpp v26, v59, v70 row_newbcast:0 row_mask:0xf bank_mask:0xf
    v_fmac_f32_dpp v27, v59, v71 row_newbcast:0 row_mask:0xf bank_mask:0xf
    v_fmac_f32_dpp v28, v59, v64 row_newbcast:1 row_mask:0xf bank_mask:0xf
    v_fmac_f32_dpp v29, v59, v65 row_newbcast:1 row_mask:0xf bank_mask:0xf
    v_fmac_f32_dpp v30, v59, v66 row_newbcast:1 row_mask:0xf bank_mask:0xf
    v_fmac_f32_dpp v31, v59, v67 row_newbcast:1 row_mask:0xf bank_mask:0xf
    v_fmac_f32_dpp v32, v59, v68 row_newbcast:1 row_mask:0xf bank_mask:0xf
    v_fmac_f32_dpp v33, v59, v69 row_newbcast:1 row_mask:0xf bank_mask:0xf
    v_fmac_f32_dpp v34, v59, v70 row_newbcast:1 row_mask:0xf bank_mask:0xf
    v_fmac_f32_dpp v35, v59, v71 row_newbcast:1 row_mask:0xf bank_mask:0xf
    v_fmac_f32_dpp v36, v59, v64 row_newbcast:2 row_mask:0xf bank_mask:0xf
    v_fmac_f32_dpp v37, v59, v65 row_newbcast:2 row_mask:0xf bank_mask:0xf
    v_fmac_f32_dpp v38, v59, v66 row_newbcast:2 row_mask:0xf bank_mask:0xf
    v_fmac_f32_dpp v39, v59, v67 row_newbcast:2 row_mask:0xf bank_mask:0xf
    v_fmac_f32_dpp v40, v59, v68 row_newbcast:2 row_mask:0xf bank_mask:0xf
    v_fmac_f32_dpp v41, v59, v69 row_newbcast:2 row_mask:0xf bank_mask:0xf
    v_fmac_f32_dpp v42, v59, v70 row_newbcast:2 row_mask:0xf bank_mask:0xf
    v_fmac_f32_dpp v43, v59, v71 row_newbcast:2 row_mask:0xf bank_mask:0xf
    v_fmac_f32_dpp v44, v59, v64 row_newbcast:3 row_mask:0xf bank_mask:0xf
    v_fmac_f32_dpp v45, v59, v65 row_newbcast:3 row_mask:0xf bank_mask:0xf
    v_fmac_f32_dpp v46, v59, v66 row_newbcast:3 row_mask:0xf bank_mask:0xf
    v_fmac_f32_dpp v47, v59, v67 row_newbcast:3 row_mask:0xf bank_mask:0xf
    v_fmac_f32_dpp v48, v59, v68 row_newbcast:3 row_mask:0xf bank_mask:0xf
    v_fmac_f32_dpp v49, v59, v69 row_newbcast:3 row_mask:0xf bank_mask:0xf
    v_fmac_f32_dpp v50, v59, v70 row_newbcast:3 row_mask:0xf bank_mask:0xf
    v_fmac_f32_dpp v51, v59, v71 row_newbcast:3 row_mask:0xf bank_mask:0xf
    s_add_u32 s19, s17, 53248
    buffer_load_dwordx4 v[160:163], v2, s[8:11], s19 offen offset:0 nt
    buffer_load_dwordx4 v[164:167], v2, s[8:11], s19 offen offset:256 nt
    buffer_load_dwordx4 v[168:171], v2, s[8:11], s19 offen offset:512 nt
    buffer_load_dwordx4 v[172:175], v2, s[8:11], s19 offen offset:768 nt
    s_waitcnt vmcnt(28)
    v_mfma_f32_16x16x32_bf16 v[52:55], v[112:115], v[4:7], 0
    v_mfma_f32_16x16x32_bf16 v[52:55], v[116:119], v[8:11], v[52:55]
    v_mfma_f32_16x16x32_bf16 v[52:55], v[120:123], v[12:15], v[52:55]
    v_mfma_f32_16x16x32_bf16 v[52:55], v[124:127], v[16:19], v[52:55]
    s_add_u32 s18, s17, 57344
    buffer_load_dwordx4 v[112:115], v1, s[4:7], s18 offen offset:0 nt
    buffer_load_dwordx4 v[116:119], v1, s[4:7], s18 offen offset:64 nt
    buffer_load_dwordx4 v[120:123], v1, s[4:7], s18 offen offset:128 nt
    buffer_load_dwordx4 v[124:127], v1, s[4:7], s18 offen offset:192 nt
    s_nop 3
    s_nop 1
    v_max3_f32 v62, v52, v53, v54
    v_max3_f32 v62, v62, v55, v60
    v_cmp_gt_f32 vcc, v62, v60
    s_nop 1
    s_cbranch_vccz k2_attn_kernel_nr10
    v_sub_f32 v63, v60, v62
    v_mul_f32 v63, s21, v63
    v_exp_f32 v63, v63
    v_mov_b32 v60, v62
    v_mul_f32 v61, v61, v63
    s_nop 0
    v_mul_f32_dpp v20, v63, v20 row_newbcast:0 row_mask:0xf bank_mask:0xf
    v_mul_f32_dpp v21, v63, v21 row_newbcast:0 row_mask:0xf bank_mask:0xf
    v_mul_f32_dpp v22, v63, v22 row_newbcast:0 row_mask:0xf bank_mask:0xf
    v_mul_f32_dpp v23, v63, v23 row_newbcast:0 row_mask:0xf bank_mask:0xf
    v_mul_f32_dpp v24, v63, v24 row_newbcast:0 row_mask:0xf bank_mask:0xf
    v_mul_f32_dpp v25, v63, v25 row_newbcast:0 row_mask:0xf bank_mask:0xf
    v_mul_f32_dpp v26, v63, v26 row_newbcast:0 row_mask:0xf bank_mask:0xf
    v_mul_f32_dpp v27, v63, v27 row_newbcast:0 row_mask:0xf bank_mask:0xf
    v_mul_f32_dpp v28, v63, v28 row_newbcast:1 row_mask:0xf bank_mask:0xf
    v_mul_f32_dpp v29, v63, v29 row_newbcast:1 row_mask:0xf bank_mask:0xf
    v_mul_f32_dpp v30, v63, v30 row_newbcast:1 row_mask:0xf bank_mask:0xf
    v_mul_f32_dpp v31, v63, v31 row_newbcast:1 row_mask:0xf bank_mask:0xf
    v_mul_f32_dpp v32, v63, v32 row_newbcast:1 row_mask:0xf bank_mask:0xf
    v_mul_f32_dpp v33, v63, v33 row_newbcast:1 row_mask:0xf bank_mask:0xf
    v_mul_f32_dpp v34, v63, v34 row_newbcast:1 row_mask:0xf bank_mask:0xf
    v_mul_f32_dpp v35, v63, v35 row_newbcast:1 row_mask:0xf bank_mask:0xf
    v_mul_f32_dpp v36, v63, v36 row_newbcast:2 row_mask:0xf bank_mask:0xf
    v_mul_f32_dpp v37, v63, v37 row_newbcast:2 row_mask:0xf bank_mask:0xf
    v_mul_f32_dpp v38, v63, v38 row_newbcast:2 row_mask:0xf bank_mask:0xf
    v_mul_f32_dpp v39, v63, v39 row_newbcast:2 row_mask:0xf bank_mask:0xf
    v_mul_f32_dpp v40, v63, v40 row_newbcast:2 row_mask:0xf bank_mask:0xf
    v_mul_f32_dpp v41, v63, v41 row_newbcast:2 row_mask:0xf bank_mask:0xf
    v_mul_f32_dpp v42, v63, v42 row_newbcast:2 row_mask:0xf bank_mask:0xf
    v_mul_f32_dpp v43, v63, v43 row_newbcast:2 row_mask:0xf bank_mask:0xf
    v_mul_f32_dpp v44, v63, v44 row_newbcast:3 row_mask:0xf bank_mask:0xf
    v_mul_f32_dpp v45, v63, v45 row_newbcast:3 row_mask:0xf bank_mask:0xf
    v_mul_f32_dpp v46, v63, v46 row_newbcast:3 row_mask:0xf bank_mask:0xf
    v_mul_f32_dpp v47, v63, v47 row_newbcast:3 row_mask:0xf bank_mask:0xf
    v_mul_f32_dpp v48, v63, v48 row_newbcast:3 row_mask:0xf bank_mask:0xf
    v_mul_f32_dpp v49, v63, v49 row_newbcast:3 row_mask:0xf bank_mask:0xf
    v_mul_f32_dpp v50, v63, v50 row_newbcast:3 row_mask:0xf bank_mask:0xf
    v_mul_f32_dpp v51, v63, v51 row_newbcast:3 row_mask:0xf bank_mask:0xf
k2_attn_kernel_nr10:
    v_mul_f32 v72, s21, v60
    v_fma_f32 v56, v52, s21, -v72
    v_fma_f32 v57, v53, s21, -v72
    v_fma_f32 v58, v54, s21, -v72
    v_fma_f32 v59, v55, s21, -v72
    v_exp_f32 v56, v56
    v_exp_f32 v57, v57
    v_exp_f32 v58, v58
    v_exp_f32 v59, v59
    s_waitcnt vmcnt(28)
    v_add_f32 v62, v56, v57
    v_add_f32 v63, v58, v59
    v_add_f32 v61, v61, v62
    v_add_f32 v61, v61, v63
    v_lshlrev_b32 v64, 16, v176
    v_and_b32 v65, 0xffff0000, v176
    v_lshlrev_b32 v66, 16, v177
    v_and_b32 v67, 0xffff0000, v177
    v_lshlrev_b32 v68, 16, v178
    v_and_b32 v69, 0xffff0000, v178
    v_lshlrev_b32 v70, 16, v179
    v_and_b32 v71, 0xffff0000, v179
    v_fmac_f32_dpp v20, v56, v64 row_newbcast:0 row_mask:0xf bank_mask:0xf
    v_fmac_f32_dpp v21, v56, v65 row_newbcast:0 row_mask:0xf bank_mask:0xf
    v_fmac_f32_dpp v22, v56, v66 row_newbcast:0 row_mask:0xf bank_mask:0xf
    v_fmac_f32_dpp v23, v56, v67 row_newbcast:0 row_mask:0xf bank_mask:0xf
    v_fmac_f32_dpp v24, v56, v68 row_newbcast:0 row_mask:0xf bank_mask:0xf
    v_fmac_f32_dpp v25, v56, v69 row_newbcast:0 row_mask:0xf bank_mask:0xf
    v_fmac_f32_dpp v26, v56, v70 row_newbcast:0 row_mask:0xf bank_mask:0xf
    v_fmac_f32_dpp v27, v56, v71 row_newbcast:0 row_mask:0xf bank_mask:0xf
    v_fmac_f32_dpp v28, v56, v64 row_newbcast:1 row_mask:0xf bank_mask:0xf
    v_fmac_f32_dpp v29, v56, v65 row_newbcast:1 row_mask:0xf bank_mask:0xf
    v_fmac_f32_dpp v30, v56, v66 row_newbcast:1 row_mask:0xf bank_mask:0xf
    v_fmac_f32_dpp v31, v56, v67 row_newbcast:1 row_mask:0xf bank_mask:0xf
    v_fmac_f32_dpp v32, v56, v68 row_newbcast:1 row_mask:0xf bank_mask:0xf
    v_fmac_f32_dpp v33, v56, v69 row_newbcast:1 row_mask:0xf bank_mask:0xf
    v_fmac_f32_dpp v34, v56, v70 row_newbcast:1 row_mask:0xf bank_mask:0xf
    v_fmac_f32_dpp v35, v56, v71 row_newbcast:1 row_mask:0xf bank_mask:0xf
    v_fmac_f32_dpp v36, v56, v64 row_newbcast:2 row_mask:0xf bank_mask:0xf
    v_fmac_f32_dpp v37, v56, v65 row_newbcast:2 row_mask:0xf bank_mask:0xf
    v_fmac_f32_dpp v38, v56, v66 row_newbcast:2 row_mask:0xf bank_mask:0xf
    v_fmac_f32_dpp v39, v56, v67 row_newbcast:2 row_mask:0xf bank_mask:0xf
    v_fmac_f32_dpp v40, v56, v68 row_newbcast:2 row_mask:0xf bank_mask:0xf
    v_fmac_f32_dpp v41, v56, v69 row_newbcast:2 row_mask:0xf bank_mask:0xf
    v_fmac_f32_dpp v42, v56, v70 row_newbcast:2 row_mask:0xf bank_mask:0xf
    v_fmac_f32_dpp v43, v56, v71 row_newbcast:2 row_mask:0xf bank_mask:0xf
    v_fmac_f32_dpp v44, v56, v64 row_newbcast:3 row_mask:0xf bank_mask:0xf
    v_fmac_f32_dpp v45, v56, v65 row_newbcast:3 row_mask:0xf bank_mask:0xf
    v_fmac_f32_dpp v46, v56, v66 row_newbcast:3 row_mask:0xf bank_mask:0xf
    v_fmac_f32_dpp v47, v56, v67 row_newbcast:3 row_mask:0xf bank_mask:0xf
    v_fmac_f32_dpp v48, v56, v68 row_newbcast:3 row_mask:0xf bank_mask:0xf
    v_fmac_f32_dpp v49, v56, v69 row_newbcast:3 row_mask:0xf bank_mask:0xf
    v_fmac_f32_dpp v50, v56, v70 row_newbcast:3 row_mask:0xf bank_mask:0xf
    v_fmac_f32_dpp v51, v56, v71 row_newbcast:3 row_mask:0xf bank_mask:0xf
    v_lshlrev_b32 v64, 16, v180
    v_and_b32 v65, 0xffff0000, v180
    v_lshlrev_b32 v66, 16, v181
    v_and_b32 v67, 0xffff0000, v181
    v_lshlrev_b32 v68, 16, v182
    v_and_b32 v69, 0xffff0000, v182
    v_lshlrev_b32 v70, 16, v183
    v_and_b32 v71, 0xffff0000, v183
    v_fmac_f32_dpp v20, v57, v64 row_newbcast:0 row_mask:0xf bank_mask:0xf
    v_fmac_f32_dpp v21, v57, v65 row_newbcast:0 row_mask:0xf bank_mask:0xf
    v_fmac_f32_dpp v22, v57, v66 row_newbcast:0 row_mask:0xf bank_mask:0xf
    v_fmac_f32_dpp v23, v57, v67 row_newbcast:0 row_mask:0xf bank_mask:0xf
    v_fmac_f32_dpp v24, v57, v68 row_newbcast:0 row_mask:0xf bank_mask:0xf
    v_fmac_f32_dpp v25, v57, v69 row_newbcast:0 row_mask:0xf bank_mask:0xf
    v_fmac_f32_dpp v26, v57, v70 row_newbcast:0 row_mask:0xf bank_mask:0xf
    v_fmac_f32_dpp v27, v57, v71 row_newbcast:0 row_mask:0xf bank_mask:0xf
    v_fmac_f32_dpp v28, v57, v64 row_newbcast:1 row_mask:0xf bank_mask:0xf
    v_fmac_f32_dpp v29, v57, v65 row_newbcast:1 row_mask:0xf bank_mask:0xf
    v_fmac_f32_dpp v30, v57, v66 row_newbcast:1 row_mask:0xf bank_mask:0xf
    v_fmac_f32_dpp v31, v57, v67 row_newbcast:1 row_mask:0xf bank_mask:0xf
    v_fmac_f32_dpp v32, v57, v68 row_newbcast:1 row_mask:0xf bank_mask:0xf
    v_fmac_f32_dpp v33, v57, v69 row_newbcast:1 row_mask:0xf bank_mask:0xf
    v_fmac_f32_dpp v34, v57, v70 row_newbcast:1 row_mask:0xf bank_mask:0xf
    v_fmac_f32_dpp v35, v57, v71 row_newbcast:1 row_mask:0xf bank_mask:0xf
    v_fmac_f32_dpp v36, v57, v64 row_newbcast:2 row_mask:0xf bank_mask:0xf
    v_fmac_f32_dpp v37, v57, v65 row_newbcast:2 row_mask:0xf bank_mask:0xf
    v_fmac_f32_dpp v38, v57, v66 row_newbcast:2 row_mask:0xf bank_mask:0xf
    v_fmac_f32_dpp v39, v57, v67 row_newbcast:2 row_mask:0xf bank_mask:0xf
    v_fmac_f32_dpp v40, v57, v68 row_newbcast:2 row_mask:0xf bank_mask:0xf
    v_fmac_f32_dpp v41, v57, v69 row_newbcast:2 row_mask:0xf bank_mask:0xf
    v_fmac_f32_dpp v42, v57, v70 row_newbcast:2 row_mask:0xf bank_mask:0xf
    v_fmac_f32_dpp v43, v57, v71 row_newbcast:2 row_mask:0xf bank_mask:0xf
    v_fmac_f32_dpp v44, v57, v64 row_newbcast:3 row_mask:0xf bank_mask:0xf
    v_fmac_f32_dpp v45, v57, v65 row_newbcast:3 row_mask:0xf bank_mask:0xf
    v_fmac_f32_dpp v46, v57, v66 row_newbcast:3 row_mask:0xf bank_mask:0xf
    v_fmac_f32_dpp v47, v57, v67 row_newbcast:3 row_mask:0xf bank_mask:0xf
    v_fmac_f32_dpp v48, v57, v68 row_newbcast:3 row_mask:0xf bank_mask:0xf
    v_fmac_f32_dpp v49, v57, v69 row_newbcast:3 row_mask:0xf bank_mask:0xf
    v_fmac_f32_dpp v50, v57, v70 row_newbcast:3 row_mask:0xf bank_mask:0xf
    v_fmac_f32_dpp v51, v57, v71 row_newbcast:3 row_mask:0xf bank_mask:0xf
    v_lshlrev_b32 v64, 16, v184
    v_and_b32 v65, 0xffff0000, v184
    v_lshlrev_b32 v66, 16, v185
    v_and_b32 v67, 0xffff0000, v185
    v_lshlrev_b32 v68, 16, v186
    v_and_b32 v69, 0xffff0000, v186
    v_lshlrev_b32 v70, 16, v187
    v_and_b32 v71, 0xffff0000, v187
    v_fmac_f32_dpp v20, v58, v64 row_newbcast:0 row_mask:0xf bank_mask:0xf
    v_fmac_f32_dpp v21, v58, v65 row_newbcast:0 row_mask:0xf bank_mask:0xf
    v_fmac_f32_dpp v22, v58, v66 row_newbcast:0 row_mask:0xf bank_mask:0xf
    v_fmac_f32_dpp v23, v58, v67 row_newbcast:0 row_mask:0xf bank_mask:0xf
    v_fmac_f32_dpp v24, v58, v68 row_newbcast:0 row_mask:0xf bank_mask:0xf
    v_fmac_f32_dpp v25, v58, v69 row_newbcast:0 row_mask:0xf bank_mask:0xf
    v_fmac_f32_dpp v26, v58, v70 row_newbcast:0 row_mask:0xf bank_mask:0xf
    v_fmac_f32_dpp v27, v58, v71 row_newbcast:0 row_mask:0xf bank_mask:0xf
    v_fmac_f32_dpp v28, v58, v64 row_newbcast:1 row_mask:0xf bank_mask:0xf
    v_fmac_f32_dpp v29, v58, v65 row_newbcast:1 row_mask:0xf bank_mask:0xf
    v_fmac_f32_dpp v30, v58, v66 row_newbcast:1 row_mask:0xf bank_mask:0xf
    v_fmac_f32_dpp v31, v58, v67 row_newbcast:1 row_mask:0xf bank_mask:0xf
    v_fmac_f32_dpp v32, v58, v68 row_newbcast:1 row_mask:0xf bank_mask:0xf
    v_fmac_f32_dpp v33, v58, v69 row_newbcast:1 row_mask:0xf bank_mask:0xf
    v_fmac_f32_dpp v34, v58, v70 row_newbcast:1 row_mask:0xf bank_mask:0xf
    v_fmac_f32_dpp v35, v58, v71 row_newbcast:1 row_mask:0xf bank_mask:0xf
    v_fmac_f32_dpp v36, v58, v64 row_newbcast:2 row_mask:0xf bank_mask:0xf
    v_fmac_f32_dpp v37, v58, v65 row_newbcast:2 row_mask:0xf bank_mask:0xf
    v_fmac_f32_dpp v38, v58, v66 row_newbcast:2 row_mask:0xf bank_mask:0xf
    v_fmac_f32_dpp v39, v58, v67 row_newbcast:2 row_mask:0xf bank_mask:0xf
    v_fmac_f32_dpp v40, v58, v68 row_newbcast:2 row_mask:0xf bank_mask:0xf
    v_fmac_f32_dpp v41, v58, v69 row_newbcast:2 row_mask:0xf bank_mask:0xf
    v_fmac_f32_dpp v42, v58, v70 row_newbcast:2 row_mask:0xf bank_mask:0xf
    v_fmac_f32_dpp v43, v58, v71 row_newbcast:2 row_mask:0xf bank_mask:0xf
    v_fmac_f32_dpp v44, v58, v64 row_newbcast:3 row_mask:0xf bank_mask:0xf
    v_fmac_f32_dpp v45, v58, v65 row_newbcast:3 row_mask:0xf bank_mask:0xf
    v_fmac_f32_dpp v46, v58, v66 row_newbcast:3 row_mask:0xf bank_mask:0xf
    v_fmac_f32_dpp v47, v58, v67 row_newbcast:3 row_mask:0xf bank_mask:0xf
    v_fmac_f32_dpp v48, v58, v68 row_newbcast:3 row_mask:0xf bank_mask:0xf
    v_fmac_f32_dpp v49, v58, v69 row_newbcast:3 row_mask:0xf bank_mask:0xf
    v_fmac_f32_dpp v50, v58, v70 row_newbcast:3 row_mask:0xf bank_mask:0xf
    v_fmac_f32_dpp v51, v58, v71 row_newbcast:3 row_mask:0xf bank_mask:0xf
    v_lshlrev_b32 v64, 16, v188
    v_and_b32 v65, 0xffff0000, v188
    v_lshlrev_b32 v66, 16, v189
    v_and_b32 v67, 0xffff0000, v189
    v_lshlrev_b32 v68, 16, v190
    v_and_b32 v69, 0xffff0000, v190
    v_lshlrev_b32 v70, 16, v191
    v_and_b32 v71, 0xffff0000, v191
    v_fmac_f32_dpp v20, v59, v64 row_newbcast:0 row_mask:0xf bank_mask:0xf
    v_fmac_f32_dpp v21, v59, v65 row_newbcast:0 row_mask:0xf bank_mask:0xf
    v_fmac_f32_dpp v22, v59, v66 row_newbcast:0 row_mask:0xf bank_mask:0xf
    v_fmac_f32_dpp v23, v59, v67 row_newbcast:0 row_mask:0xf bank_mask:0xf
    v_fmac_f32_dpp v24, v59, v68 row_newbcast:0 row_mask:0xf bank_mask:0xf
    v_fmac_f32_dpp v25, v59, v69 row_newbcast:0 row_mask:0xf bank_mask:0xf
    v_fmac_f32_dpp v26, v59, v70 row_newbcast:0 row_mask:0xf bank_mask:0xf
    v_fmac_f32_dpp v27, v59, v71 row_newbcast:0 row_mask:0xf bank_mask:0xf
    v_fmac_f32_dpp v28, v59, v64 row_newbcast:1 row_mask:0xf bank_mask:0xf
    v_fmac_f32_dpp v29, v59, v65 row_newbcast:1 row_mask:0xf bank_mask:0xf
    v_fmac_f32_dpp v30, v59, v66 row_newbcast:1 row_mask:0xf bank_mask:0xf
    v_fmac_f32_dpp v31, v59, v67 row_newbcast:1 row_mask:0xf bank_mask:0xf
    v_fmac_f32_dpp v32, v59, v68 row_newbcast:1 row_mask:0xf bank_mask:0xf
    v_fmac_f32_dpp v33, v59, v69 row_newbcast:1 row_mask:0xf bank_mask:0xf
    v_fmac_f32_dpp v34, v59, v70 row_newbcast:1 row_mask:0xf bank_mask:0xf
    v_fmac_f32_dpp v35, v59, v71 row_newbcast:1 row_mask:0xf bank_mask:0xf
    v_fmac_f32_dpp v36, v59, v64 row_newbcast:2 row_mask:0xf bank_mask:0xf
    v_fmac_f32_dpp v37, v59, v65 row_newbcast:2 row_mask:0xf bank_mask:0xf
    v_fmac_f32_dpp v38, v59, v66 row_newbcast:2 row_mask:0xf bank_mask:0xf
    v_fmac_f32_dpp v39, v59, v67 row_newbcast:2 row_mask:0xf bank_mask:0xf
    v_fmac_f32_dpp v40, v59, v68 row_newbcast:2 row_mask:0xf bank_mask:0xf
    v_fmac_f32_dpp v41, v59, v69 row_newbcast:2 row_mask:0xf bank_mask:0xf
    v_fmac_f32_dpp v42, v59, v70 row_newbcast:2 row_mask:0xf bank_mask:0xf
    v_fmac_f32_dpp v43, v59, v71 row_newbcast:2 row_mask:0xf bank_mask:0xf
    v_fmac_f32_dpp v44, v59, v64 row_newbcast:3 row_mask:0xf bank_mask:0xf
    v_fmac_f32_dpp v45, v59, v65 row_newbcast:3 row_mask:0xf bank_mask:0xf
    v_fmac_f32_dpp v46, v59, v66 row_newbcast:3 row_mask:0xf bank_mask:0xf
    v_fmac_f32_dpp v47, v59, v67 row_newbcast:3 row_mask:0xf bank_mask:0xf
    v_fmac_f32_dpp v48, v59, v68 row_newbcast:3 row_mask:0xf bank_mask:0xf
    v_fmac_f32_dpp v49, v59, v69 row_newbcast:3 row_mask:0xf bank_mask:0xf
    v_fmac_f32_dpp v50, v59, v70 row_newbcast:3 row_mask:0xf bank_mask:0xf
    v_fmac_f32_dpp v51, v59, v71 row_newbcast:3 row_mask:0xf bank_mask:0xf
    s_add_u32 s19, s17, 57344
    buffer_load_dwordx4 v[176:179], v2, s[8:11], s19 offen offset:0 nt
    buffer_load_dwordx4 v[180:183], v2, s[8:11], s19 offen offset:256 nt
    buffer_load_dwordx4 v[184:187], v2, s[8:11], s19 offen offset:512 nt
    buffer_load_dwordx4 v[188:191], v2, s[8:11], s19 offen offset:768 nt
    s_waitcnt vmcnt(28)
    v_mfma_f32_16x16x32_bf16 v[52:55], v[128:131], v[4:7], 0
    v_mfma_f32_16x16x32_bf16 v[52:55], v[132:135], v[8:11], v[52:55]
    v_mfma_f32_16x16x32_bf16 v[52:55], v[136:139], v[12:15], v[52:55]
    v_mfma_f32_16x16x32_bf16 v[52:55], v[140:143], v[16:19], v[52:55]
    s_add_u32 s18, s17, 61440
    buffer_load_dwordx4 v[128:131], v1, s[4:7], s18 offen offset:0 nt
    buffer_load_dwordx4 v[132:135], v1, s[4:7], s18 offen offset:64 nt
    buffer_load_dwordx4 v[136:139], v1, s[4:7], s18 offen offset:128 nt
    buffer_load_dwordx4 v[140:143], v1, s[4:7], s18 offen offset:192 nt
    s_nop 3
    s_nop 1
    v_max3_f32 v62, v52, v53, v54
    v_max3_f32 v62, v62, v55, v60
    v_cmp_gt_f32 vcc, v62, v60
    s_nop 1
    s_cbranch_vccz k2_attn_kernel_nr11
    v_sub_f32 v63, v60, v62
    v_mul_f32 v63, s21, v63
    v_exp_f32 v63, v63
    v_mov_b32 v60, v62
    v_mul_f32 v61, v61, v63
    s_nop 0
    v_mul_f32_dpp v20, v63, v20 row_newbcast:0 row_mask:0xf bank_mask:0xf
    v_mul_f32_dpp v21, v63, v21 row_newbcast:0 row_mask:0xf bank_mask:0xf
    v_mul_f32_dpp v22, v63, v22 row_newbcast:0 row_mask:0xf bank_mask:0xf
    v_mul_f32_dpp v23, v63, v23 row_newbcast:0 row_mask:0xf bank_mask:0xf
    v_mul_f32_dpp v24, v63, v24 row_newbcast:0 row_mask:0xf bank_mask:0xf
    v_mul_f32_dpp v25, v63, v25 row_newbcast:0 row_mask:0xf bank_mask:0xf
    v_mul_f32_dpp v26, v63, v26 row_newbcast:0 row_mask:0xf bank_mask:0xf
    v_mul_f32_dpp v27, v63, v27 row_newbcast:0 row_mask:0xf bank_mask:0xf
    v_mul_f32_dpp v28, v63, v28 row_newbcast:1 row_mask:0xf bank_mask:0xf
    v_mul_f32_dpp v29, v63, v29 row_newbcast:1 row_mask:0xf bank_mask:0xf
    v_mul_f32_dpp v30, v63, v30 row_newbcast:1 row_mask:0xf bank_mask:0xf
    v_mul_f32_dpp v31, v63, v31 row_newbcast:1 row_mask:0xf bank_mask:0xf
    v_mul_f32_dpp v32, v63, v32 row_newbcast:1 row_mask:0xf bank_mask:0xf
    v_mul_f32_dpp v33, v63, v33 row_newbcast:1 row_mask:0xf bank_mask:0xf
    v_mul_f32_dpp v34, v63, v34 row_newbcast:1 row_mask:0xf bank_mask:0xf
    v_mul_f32_dpp v35, v63, v35 row_newbcast:1 row_mask:0xf bank_mask:0xf
    v_mul_f32_dpp v36, v63, v36 row_newbcast:2 row_mask:0xf bank_mask:0xf
    v_mul_f32_dpp v37, v63, v37 row_newbcast:2 row_mask:0xf bank_mask:0xf
    v_mul_f32_dpp v38, v63, v38 row_newbcast:2 row_mask:0xf bank_mask:0xf
    v_mul_f32_dpp v39, v63, v39 row_newbcast:2 row_mask:0xf bank_mask:0xf
    v_mul_f32_dpp v40, v63, v40 row_newbcast:2 row_mask:0xf bank_mask:0xf
    v_mul_f32_dpp v41, v63, v41 row_newbcast:2 row_mask:0xf bank_mask:0xf
    v_mul_f32_dpp v42, v63, v42 row_newbcast:2 row_mask:0xf bank_mask:0xf
    v_mul_f32_dpp v43, v63, v43 row_newbcast:2 row_mask:0xf bank_mask:0xf
    v_mul_f32_dpp v44, v63, v44 row_newbcast:3 row_mask:0xf bank_mask:0xf
    v_mul_f32_dpp v45, v63, v45 row_newbcast:3 row_mask:0xf bank_mask:0xf
    v_mul_f32_dpp v46, v63, v46 row_newbcast:3 row_mask:0xf bank_mask:0xf
    v_mul_f32_dpp v47, v63, v47 row_newbcast:3 row_mask:0xf bank_mask:0xf
    v_mul_f32_dpp v48, v63, v48 row_newbcast:3 row_mask:0xf bank_mask:0xf
    v_mul_f32_dpp v49, v63, v49 row_newbcast:3 row_mask:0xf bank_mask:0xf
    v_mul_f32_dpp v50, v63, v50 row_newbcast:3 row_mask:0xf bank_mask:0xf
    v_mul_f32_dpp v51, v63, v51 row_newbcast:3 row_mask:0xf bank_mask:0xf
k2_attn_kernel_nr11:
    v_mul_f32 v72, s21, v60
    v_fma_f32 v56, v52, s21, -v72
    v_fma_f32 v57, v53, s21, -v72
    v_fma_f32 v58, v54, s21, -v72
    v_fma_f32 v59, v55, s21, -v72
    v_exp_f32 v56, v56
    v_exp_f32 v57, v57
    v_exp_f32 v58, v58
    v_exp_f32 v59, v59
    s_waitcnt vmcnt(28)
    v_add_f32 v62, v56, v57
    v_add_f32 v63, v58, v59
    v_add_f32 v61, v61, v62
    v_add_f32 v61, v61, v63
    v_lshlrev_b32 v64, 16, v192
    v_and_b32 v65, 0xffff0000, v192
    v_lshlrev_b32 v66, 16, v193
    v_and_b32 v67, 0xffff0000, v193
    v_lshlrev_b32 v68, 16, v194
    v_and_b32 v69, 0xffff0000, v194
    v_lshlrev_b32 v70, 16, v195
    v_and_b32 v71, 0xffff0000, v195
    v_fmac_f32_dpp v20, v56, v64 row_newbcast:0 row_mask:0xf bank_mask:0xf
    v_fmac_f32_dpp v21, v56, v65 row_newbcast:0 row_mask:0xf bank_mask:0xf
    v_fmac_f32_dpp v22, v56, v66 row_newbcast:0 row_mask:0xf bank_mask:0xf
    v_fmac_f32_dpp v23, v56, v67 row_newbcast:0 row_mask:0xf bank_mask:0xf
    v_fmac_f32_dpp v24, v56, v68 row_newbcast:0 row_mask:0xf bank_mask:0xf
    v_fmac_f32_dpp v25, v56, v69 row_newbcast:0 row_mask:0xf bank_mask:0xf
    v_fmac_f32_dpp v26, v56, v70 row_newbcast:0 row_mask:0xf bank_mask:0xf
    v_fmac_f32_dpp v27, v56, v71 row_newbcast:0 row_mask:0xf bank_mask:0xf
    v_fmac_f32_dpp v28, v56, v64 row_newbcast:1 row_mask:0xf bank_mask:0xf
    v_fmac_f32_dpp v29, v56, v65 row_newbcast:1 row_mask:0xf bank_mask:0xf
    v_fmac_f32_dpp v30, v56, v66 row_newbcast:1 row_mask:0xf bank_mask:0xf
    v_fmac_f32_dpp v31, v56, v67 row_newbcast:1 row_mask:0xf bank_mask:0xf
    v_fmac_f32_dpp v32, v56, v68 row_newbcast:1 row_mask:0xf bank_mask:0xf
    v_fmac_f32_dpp v33, v56, v69 row_newbcast:1 row_mask:0xf bank_mask:0xf
    v_fmac_f32_dpp v34, v56, v70 row_newbcast:1 row_mask:0xf bank_mask:0xf
    v_fmac_f32_dpp v35, v56, v71 row_newbcast:1 row_mask:0xf bank_mask:0xf
    v_fmac_f32_dpp v36, v56, v64 row_newbcast:2 row_mask:0xf bank_mask:0xf
    v_fmac_f32_dpp v37, v56, v65 row_newbcast:2 row_mask:0xf bank_mask:0xf
    v_fmac_f32_dpp v38, v56, v66 row_newbcast:2 row_mask:0xf bank_mask:0xf
    v_fmac_f32_dpp v39, v56, v67 row_newbcast:2 row_mask:0xf bank_mask:0xf
    v_fmac_f32_dpp v40, v56, v68 row_newbcast:2 row_mask:0xf bank_mask:0xf
    v_fmac_f32_dpp v41, v56, v69 row_newbcast:2 row_mask:0xf bank_mask:0xf
    v_fmac_f32_dpp v42, v56, v70 row_newbcast:2 row_mask:0xf bank_mask:0xf
    v_fmac_f32_dpp v43, v56, v71 row_newbcast:2 row_mask:0xf bank_mask:0xf
    v_fmac_f32_dpp v44, v56, v64 row_newbcast:3 row_mask:0xf bank_mask:0xf
    v_fmac_f32_dpp v45, v56, v65 row_newbcast:3 row_mask:0xf bank_mask:0xf
    v_fmac_f32_dpp v46, v56, v66 row_newbcast:3 row_mask:0xf bank_mask:0xf
    v_fmac_f32_dpp v47, v56, v67 row_newbcast:3 row_mask:0xf bank_mask:0xf
    v_fmac_f32_dpp v48, v56, v68 row_newbcast:3 row_mask:0xf bank_mask:0xf
    v_fmac_f32_dpp v49, v56, v69 row_newbcast:3 row_mask:0xf bank_mask:0xf
    v_fmac_f32_dpp v50, v56, v70 row_newbcast:3 row_mask:0xf bank_mask:0xf
    v_fmac_f32_dpp v51, v56, v71 row_newbcast:3 row_mask:0xf bank_mask:0xf
    v_lshlrev_b32 v64, 16, v196
    v_and_b32 v65, 0xffff0000, v196
    v_lshlrev_b32 v66, 16, v197
    v_and_b32 v67, 0xffff0000, v197
    v_lshlrev_b32 v68, 16, v198
    v_and_b32 v69, 0xffff0000, v198
    v_lshlrev_b32 v70, 16, v199
    v_and_b32 v71, 0xffff0000, v199
    v_fmac_f32_dpp v20, v57, v64 row_newbcast:0 row_mask:0xf bank_mask:0xf
    v_fmac_f32_dpp v21, v57, v65 row_newbcast:0 row_mask:0xf bank_mask:0xf
    v_fmac_f32_dpp v22, v57, v66 row_newbcast:0 row_mask:0xf bank_mask:0xf
    v_fmac_f32_dpp v23, v57, v67 row_newbcast:0 row_mask:0xf bank_mask:0xf
    v_fmac_f32_dpp v24, v57, v68 row_newbcast:0 row_mask:0xf bank_mask:0xf
    v_fmac_f32_dpp v25, v57, v69 row_newbcast:0 row_mask:0xf bank_mask:0xf
    v_fmac_f32_dpp v26, v57, v70 row_newbcast:0 row_mask:0xf bank_mask:0xf
    v_fmac_f32_dpp v27, v57, v71 row_newbcast:0 row_mask:0xf bank_mask:0xf
    v_fmac_f32_dpp v28, v57, v64 row_newbcast:1 row_mask:0xf bank_mask:0xf
    v_fmac_f32_dpp v29, v57, v65 row_newbcast:1 row_mask:0xf bank_mask:0xf
    v_fmac_f32_dpp v30, v57, v66 row_newbcast:1 row_mask:0xf bank_mask:0xf
    v_fmac_f32_dpp v31, v57, v67 row_newbcast:1 row_mask:0xf bank_mask:0xf
    v_fmac_f32_dpp v32, v57, v68 row_newbcast:1 row_mask:0xf bank_mask:0xf
    v_fmac_f32_dpp v33, v57, v69 row_newbcast:1 row_mask:0xf bank_mask:0xf
    v_fmac_f32_dpp v34, v57, v70 row_newbcast:1 row_mask:0xf bank_mask:0xf
    v_fmac_f32_dpp v35, v57, v71 row_newbcast:1 row_mask:0xf bank_mask:0xf
    v_fmac_f32_dpp v36, v57, v64 row_newbcast:2 row_mask:0xf bank_mask:0xf
    v_fmac_f32_dpp v37, v57, v65 row_newbcast:2 row_mask:0xf bank_mask:0xf
    v_fmac_f32_dpp v38, v57, v66 row_newbcast:2 row_mask:0xf bank_mask:0xf
    v_fmac_f32_dpp v39, v57, v67 row_newbcast:2 row_mask:0xf bank_mask:0xf
    v_fmac_f32_dpp v40, v57, v68 row_newbcast:2 row_mask:0xf bank_mask:0xf
    v_fmac_f32_dpp v41, v57, v69 row_newbcast:2 row_mask:0xf bank_mask:0xf
    v_fmac_f32_dpp v42, v57, v70 row_newbcast:2 row_mask:0xf bank_mask:0xf
    v_fmac_f32_dpp v43, v57, v71 row_newbcast:2 row_mask:0xf bank_mask:0xf
    v_fmac_f32_dpp v44, v57, v64 row_newbcast:3 row_mask:0xf bank_mask:0xf
    v_fmac_f32_dpp v45, v57, v65 row_newbcast:3 row_mask:0xf bank_mask:0xf
    v_fmac_f32_dpp v46, v57, v66 row_newbcast:3 row_mask:0xf bank_mask:0xf
    v_fmac_f32_dpp v47, v57, v67 row_newbcast:3 row_mask:0xf bank_mask:0xf
    v_fmac_f32_dpp v48, v57, v68 row_newbcast:3 row_mask:0xf bank_mask:0xf
    v_fmac_f32_dpp v49, v57, v69 row_newbcast:3 row_mask:0xf bank_mask:0xf
    v_fmac_f32_dpp v50, v57, v70 row_newbcast:3 row_mask:0xf bank_mask:0xf
    v_fmac_f32_dpp v51, v57, v71 row_newbcast:3 row_mask:0xf bank_mask:0xf
    v_lshlrev_b32 v64, 16, v200
    v_and_b32 v65, 0xffff0000, v200
    v_lshlrev_b32 v66, 16, v201
    v_and_b32 v67, 0xffff0000, v201
    v_lshlrev_b32 v68, 16, v202
    v_and_b32 v69, 0xffff0000, v202
    v_lshlrev_b32 v70, 16, v203
    v_and_b32 v71, 0xffff0000, v203
    v_fmac_f32_dpp v20, v58, v64 row_newbcast:0 row_mask:0xf bank_mask:0xf
    v_fmac_f32_dpp v21, v58, v65 row_newbcast:0 row_mask:0xf bank_mask:0xf
    v_fmac_f32_dpp v22, v58, v66 row_newbcast:0 row_mask:0xf bank_mask:0xf
    v_fmac_f32_dpp v23, v58, v67 row_newbcast:0 row_mask:0xf bank_mask:0xf
    v_fmac_f32_dpp v24, v58, v68 row_newbcast:0 row_mask:0xf bank_mask:0xf
    v_fmac_f32_dpp v25, v58, v69 row_newbcast:0 row_mask:0xf bank_mask:0xf
    v_fmac_f32_dpp v26, v58, v70 row_newbcast:0 row_mask:0xf bank_mask:0xf
    v_fmac_f32_dpp v27, v58, v71 row_newbcast:0 row_mask:0xf bank_mask:0xf
    v_fmac_f32_dpp v28, v58, v64 row_newbcast:1 row_mask:0xf bank_mask:0xf
    v_fmac_f32_dpp v29, v58, v65 row_newbcast:1 row_mask:0xf bank_mask:0xf
    v_fmac_f32_dpp v30, v58, v66 row_newbcast:1 row_mask:0xf bank_mask:0xf
    v_fmac_f32_dpp v31, v58, v67 row_newbcast:1 row_mask:0xf bank_mask:0xf
    v_fmac_f32_dpp v32, v58, v68 row_newbcast:1 row_mask:0xf bank_mask:0xf
    v_fmac_f32_dpp v33, v58, v69 row_newbcast:1 row_mask:0xf bank_mask:0xf
    v_fmac_f32_dpp v34, v58, v70 row_newbcast:1 row_mask:0xf bank_mask:0xf
    v_fmac_f32_dpp v35, v58, v71 row_newbcast:1 row_mask:0xf bank_mask:0xf
    v_fmac_f32_dpp v36, v58, v64 row_newbcast:2 row_mask:0xf bank_mask:0xf
    v_fmac_f32_dpp v37, v58, v65 row_newbcast:2 row_mask:0xf bank_mask:0xf
    v_fmac_f32_dpp v38, v58, v66 row_newbcast:2 row_mask:0xf bank_mask:0xf
    v_fmac_f32_dpp v39, v58, v67 row_newbcast:2 row_mask:0xf bank_mask:0xf
    v_fmac_f32_dpp v40, v58, v68 row_newbcast:2 row_mask:0xf bank_mask:0xf
    v_fmac_f32_dpp v41, v58, v69 row_newbcast:2 row_mask:0xf bank_mask:0xf
    v_fmac_f32_dpp v42, v58, v70 row_newbcast:2 row_mask:0xf bank_mask:0xf
    v_fmac_f32_dpp v43, v58, v71 row_newbcast:2 row_mask:0xf bank_mask:0xf
    v_fmac_f32_dpp v44, v58, v64 row_newbcast:3 row_mask:0xf bank_mask:0xf
    v_fmac_f32_dpp v45, v58, v65 row_newbcast:3 row_mask:0xf bank_mask:0xf
    v_fmac_f32_dpp v46, v58, v66 row_newbcast:3 row_mask:0xf bank_mask:0xf
    v_fmac_f32_dpp v47, v58, v67 row_newbcast:3 row_mask:0xf bank_mask:0xf
    v_fmac_f32_dpp v48, v58, v68 row_newbcast:3 row_mask:0xf bank_mask:0xf
    v_fmac_f32_dpp v49, v58, v69 row_newbcast:3 row_mask:0xf bank_mask:0xf
    v_fmac_f32_dpp v50, v58, v70 row_newbcast:3 row_mask:0xf bank_mask:0xf
    v_fmac_f32_dpp v51, v58, v71 row_newbcast:3 row_mask:0xf bank_mask:0xf
    v_lshlrev_b32 v64, 16, v204
    v_and_b32 v65, 0xffff0000, v204
    v_lshlrev_b32 v66, 16, v205
    v_and_b32 v67, 0xffff0000, v205
    v_lshlrev_b32 v68, 16, v206
    v_and_b32 v69, 0xffff0000, v206
    v_lshlrev_b32 v70, 16, v207
    v_and_b32 v71, 0xffff0000, v207
    v_fmac_f32_dpp v20, v59, v64 row_newbcast:0 row_mask:0xf bank_mask:0xf
    v_fmac_f32_dpp v21, v59, v65 row_newbcast:0 row_mask:0xf bank_mask:0xf
    v_fmac_f32_dpp v22, v59, v66 row_newbcast:0 row_mask:0xf bank_mask:0xf
    v_fmac_f32_dpp v23, v59, v67 row_newbcast:0 row_mask:0xf bank_mask:0xf
    v_fmac_f32_dpp v24, v59, v68 row_newbcast:0 row_mask:0xf bank_mask:0xf
    v_fmac_f32_dpp v25, v59, v69 row_newbcast:0 row_mask:0xf bank_mask:0xf
    v_fmac_f32_dpp v26, v59, v70 row_newbcast:0 row_mask:0xf bank_mask:0xf
    v_fmac_f32_dpp v27, v59, v71 row_newbcast:0 row_mask:0xf bank_mask:0xf
    v_fmac_f32_dpp v28, v59, v64 row_newbcast:1 row_mask:0xf bank_mask:0xf
    v_fmac_f32_dpp v29, v59, v65 row_newbcast:1 row_mask:0xf bank_mask:0xf
    v_fmac_f32_dpp v30, v59, v66 row_newbcast:1 row_mask:0xf bank_mask:0xf
    v_fmac_f32_dpp v31, v59, v67 row_newbcast:1 row_mask:0xf bank_mask:0xf
    v_fmac_f32_dpp v32, v59, v68 row_newbcast:1 row_mask:0xf bank_mask:0xf
    v_fmac_f32_dpp v33, v59, v69 row_newbcast:1 row_mask:0xf bank_mask:0xf
    v_fmac_f32_dpp v34, v59, v70 row_newbcast:1 row_mask:0xf bank_mask:0xf
    v_fmac_f32_dpp v35, v59, v71 row_newbcast:1 row_mask:0xf bank_mask:0xf
    v_fmac_f32_dpp v36, v59, v64 row_newbcast:2 row_mask:0xf bank_mask:0xf
    v_fmac_f32_dpp v37, v59, v65 row_newbcast:2 row_mask:0xf bank_mask:0xf
    v_fmac_f32_dpp v38, v59, v66 row_newbcast:2 row_mask:0xf bank_mask:0xf
    v_fmac_f32_dpp v39, v59, v67 row_newbcast:2 row_mask:0xf bank_mask:0xf
    v_fmac_f32_dpp v40, v59, v68 row_newbcast:2 row_mask:0xf bank_mask:0xf
    v_fmac_f32_dpp v41, v59, v69 row_newbcast:2 row_mask:0xf bank_mask:0xf
    v_fmac_f32_dpp v42, v59, v70 row_newbcast:2 row_mask:0xf bank_mask:0xf
    v_fmac_f32_dpp v43, v59, v71 row_newbcast:2 row_mask:0xf bank_mask:0xf
    v_fmac_f32_dpp v44, v59, v64 row_newbcast:3 row_mask:0xf bank_mask:0xf
    v_fmac_f32_dpp v45, v59, v65 row_newbcast:3 row_mask:0xf bank_mask:0xf
    v_fmac_f32_dpp v46, v59, v66 row_newbcast:3 row_mask:0xf bank_mask:0xf
    v_fmac_f32_dpp v47, v59, v67 row_newbcast:3 row_mask:0xf bank_mask:0xf
    v_fmac_f32_dpp v48, v59, v68 row_newbcast:3 row_mask:0xf bank_mask:0xf
    v_fmac_f32_dpp v49, v59, v69 row_newbcast:3 row_mask:0xf bank_mask:0xf
    v_fmac_f32_dpp v50, v59, v70 row_newbcast:3 row_mask:0xf bank_mask:0xf
    v_fmac_f32_dpp v51, v59, v71 row_newbcast:3 row_mask:0xf bank_mask:0xf
    s_add_u32 s19, s17, 61440
    buffer_load_dwordx4 v[192:195], v2, s[8:11], s19 offen offset:0 nt
    buffer_load_dwordx4 v[196:199], v2, s[8:11], s19 offen offset:256 nt
    buffer_load_dwordx4 v[200:203], v2, s[8:11], s19 offen offset:512 nt
    buffer_load_dwordx4 v[204:207], v2, s[8:11], s19 offen offset:768 nt
    s_waitcnt vmcnt(28)
    v_mfma_f32_16x16x32_bf16 v[52:55], v[80:83], v[4:7], 0
    v_mfma_f32_16x16x32_bf16 v[52:55], v[84:87], v[8:11], v[52:55]
    v_mfma_f32_16x16x32_bf16 v[52:55], v[88:91], v[12:15], v[52:55]
    v_mfma_f32_16x16x32_bf16 v[52:55], v[92:95], v[16:19], v[52:55]
    s_nop 7
    s_nop 1
    v_max3_f32 v62, v52, v53, v54
    v_max3_f32 v62, v62, v55, v60
    v_cmp_gt_f32 vcc, v62, v60
    s_nop 1
    s_cbranch_vccz k2_attn_kernel_nr12
    v_sub_f32 v63, v60, v62
    v_mul_f32 v63, s21, v63
    v_exp_f32 v63, v63
    v_mov_b32 v60, v62
    v_mul_f32 v61, v61, v63
    s_nop 0
    v_mul_f32_dpp v20, v63, v20 row_newbcast:0 row_mask:0xf bank_mask:0xf
    v_mul_f32_dpp v21, v63, v21 row_newbcast:0 row_mask:0xf bank_mask:0xf
    v_mul_f32_dpp v22, v63, v22 row_newbcast:0 row_mask:0xf bank_mask:0xf
    v_mul_f32_dpp v23, v63, v23 row_newbcast:0 row_mask:0xf bank_mask:0xf
    v_mul_f32_dpp v24, v63, v24 row_newbcast:0 row_mask:0xf bank_mask:0xf
    v_mul_f32_dpp v25, v63, v25 row_newbcast:0 row_mask:0xf bank_mask:0xf
    v_mul_f32_dpp v26, v63, v26 row_newbcast:0 row_mask:0xf bank_mask:0xf
    v_mul_f32_dpp v27, v63, v27 row_newbcast:0 row_mask:0xf bank_mask:0xf
    v_mul_f32_dpp v28, v63, v28 row_newbcast:1 row_mask:0xf bank_mask:0xf
    v_mul_f32_dpp v29, v63, v29 row_newbcast:1 row_mask:0xf bank_mask:0xf
    v_mul_f32_dpp v30, v63, v30 row_newbcast:1 row_mask:0xf bank_mask:0xf
    v_mul_f32_dpp v31, v63, v31 row_newbcast:1 row_mask:0xf bank_mask:0xf
    v_mul_f32_dpp v32, v63, v32 row_newbcast:1 row_mask:0xf bank_mask:0xf
    v_mul_f32_dpp v33, v63, v33 row_newbcast:1 row_mask:0xf bank_mask:0xf
    v_mul_f32_dpp v34, v63, v34 row_newbcast:1 row_mask:0xf bank_mask:0xf
    v_mul_f32_dpp v35, v63, v35 row_newbcast:1 row_mask:0xf bank_mask:0xf
    v_mul_f32_dpp v36, v63, v36 row_newbcast:2 row_mask:0xf bank_mask:0xf
    v_mul_f32_dpp v37, v63, v37 row_newbcast:2 row_mask:0xf bank_mask:0xf
    v_mul_f32_dpp v38, v63, v38 row_newbcast:2 row_mask:0xf bank_mask:0xf
    v_mul_f32_dpp v39, v63, v39 row_newbcast:2 row_mask:0xf bank_mask:0xf
    v_mul_f32_dpp v40, v63, v40 row_newbcast:2 row_mask:0xf bank_mask:0xf
    v_mul_f32_dpp v41, v63, v41 row_newbcast:2 row_mask:0xf bank_mask:0xf
    v_mul_f32_dpp v42, v63, v42 row_newbcast:2 row_mask:0xf bank_mask:0xf
    v_mul_f32_dpp v43, v63, v43 row_newbcast:2 row_mask:0xf bank_mask:0xf
    v_mul_f32_dpp v44, v63, v44 row_newbcast:3 row_mask:0xf bank_mask:0xf
    v_mul_f32_dpp v45, v63, v45 row_newbcast:3 row_mask:0xf bank_mask:0xf
    v_mul_f32_dpp v46, v63, v46 row_newbcast:3 row_mask:0xf bank_mask:0xf
    v_mul_f32_dpp v47, v63, v47 row_newbcast:3 row_mask:0xf bank_mask:0xf
    v_mul_f32_dpp v48, v63, v48 row_newbcast:3 row_mask:0xf bank_mask:0xf
    v_mul_f32_dpp v49, v63, v49 row_newbcast:3 row_mask:0xf bank_mask:0xf
    v_mul_f32_dpp v50, v63, v50 row_newbcast:3 row_mask:0xf bank_mask:0xf
    v_mul_f32_dpp v51, v63, v51 row_newbcast:3 row_mask:0xf bank_mask:0xf
k2_attn_kernel_nr12:
    v_mul_f32 v72, s21, v60
    v_fma_f32 v56, v52, s21, -v72
    v_fma_f32 v57, v53, s21, -v72
    v_fma_f32 v58, v54, s21, -v72
    v_fma_f32 v59, v55, s21, -v72
    v_exp_f32 v56, v56
    v_exp_f32 v57, v57
    v_exp_f32 v58, v58
    v_exp_f32 v59, v59
    s_waitcnt vmcnt(24)
    v_add_f32 v62, v56, v57
    v_add_f32 v63, v58, v59
    v_add_f32 v61, v61, v62
    v_add_f32 v61, v61, v63
    v_lshlrev_b32 v64, 16, v144
    v_and_b32 v65, 0xffff0000, v144
    v_lshlrev_b32 v66, 16, v145
    v_and_b32 v67, 0xffff0000, v145
    v_lshlrev_b32 v68, 16, v146
    v_and_b32 v69, 0xffff0000, v146
    v_lshlrev_b32 v70, 16, v147
    v_and_b32 v71, 0xffff0000, v147
    v_fmac_f32_dpp v20, v56, v64 row_newbcast:0 row_mask:0xf bank_mask:0xf
    v_fmac_f32_dpp v21, v56, v65 row_newbcast:0 row_mask:0xf bank_mask:0xf
    v_fmac_f32_dpp v22, v56, v66 row_newbcast:0 row_mask:0xf bank_mask:0xf
    v_fmac_f32_dpp v23, v56, v67 row_newbcast:0 row_mask:0xf bank_mask:0xf
    v_fmac_f32_dpp v24, v56, v68 row_newbcast:0 row_mask:0xf bank_mask:0xf
    v_fmac_f32_dpp v25, v56, v69 row_newbcast:0 row_mask:0xf bank_mask:0xf
    v_fmac_f32_dpp v26, v56, v70 row_newbcast:0 row_mask:0xf bank_mask:0xf
    v_fmac_f32_dpp v27, v56, v71 row_newbcast:0 row_mask:0xf bank_mask:0xf
    v_fmac_f32_dpp v28, v56, v64 row_newbcast:1 row_mask:0xf bank_mask:0xf
    v_fmac_f32_dpp v29, v56, v65 row_newbcast:1 row_mask:0xf bank_mask:0xf
    v_fmac_f32_dpp v30, v56, v66 row_newbcast:1 row_mask:0xf bank_mask:0xf
    v_fmac_f32_dpp v31, v56, v67 row_newbcast:1 row_mask:0xf bank_mask:0xf
    v_fmac_f32_dpp v32, v56, v68 row_newbcast:1 row_mask:0xf bank_mask:0xf
    v_fmac_f32_dpp v33, v56, v69 row_newbcast:1 row_mask:0xf bank_mask:0xf
    v_fmac_f32_dpp v34, v56, v70 row_newbcast:1 row_mask:0xf bank_mask:0xf
    v_fmac_f32_dpp v35, v56, v71 row_newbcast:1 row_mask:0xf bank_mask:0xf
    v_fmac_f32_dpp v36, v56, v64 row_newbcast:2 row_mask:0xf bank_mask:0xf
    v_fmac_f32_dpp v37, v56, v65 row_newbcast:2 row_mask:0xf bank_mask:0xf
    v_fmac_f32_dpp v38, v56, v66 row_newbcast:2 row_mask:0xf bank_mask:0xf
    v_fmac_f32_dpp v39, v56, v67 row_newbcast:2 row_mask:0xf bank_mask:0xf
    v_fmac_f32_dpp v40, v56, v68 row_newbcast:2 row_mask:0xf bank_mask:0xf
    v_fmac_f32_dpp v41, v56, v69 row_newbcast:2 row_mask:0xf bank_mask:0xf
    v_fmac_f32_dpp v42, v56, v70 row_newbcast:2 row_mask:0xf bank_mask:0xf
    v_fmac_f32_dpp v43, v56, v71 row_newbcast:2 row_mask:0xf bank_mask:0xf
    v_fmac_f32_dpp v44, v56, v64 row_newbcast:3 row_mask:0xf bank_mask:0xf
    v_fmac_f32_dpp v45, v56, v65 row_newbcast:3 row_mask:0xf bank_mask:0xf
    v_fmac_f32_dpp v46, v56, v66 row_newbcast:3 row_mask:0xf bank_mask:0xf
    v_fmac_f32_dpp v47, v56, v67 row_newbcast:3 row_mask:0xf bank_mask:0xf
    v_fmac_f32_dpp v48, v56, v68 row_newbcast:3 row_mask:0xf bank_mask:0xf
    v_fmac_f32_dpp v49, v56, v69 row_newbcast:3 row_mask:0xf bank_mask:0xf
    v_fmac_f32_dpp v50, v56, v70 row_newbcast:3 row_mask:0xf bank_mask:0xf
    v_fmac_f32_dpp v51, v56, v71 row_newbcast:3 row_mask:0xf bank_mask:0xf
    v_lshlrev_b32 v64, 16, v148
    v_and_b32 v65, 0xffff0000, v148
    v_lshlrev_b32 v66, 16, v149
    v_and_b32 v67, 0xffff0000, v149
    v_lshlrev_b32 v68, 16, v150
    v_and_b32 v69, 0xffff0000, v150
    v_lshlrev_b32 v70, 16, v151
    v_and_b32 v71, 0xffff0000, v151
    v_fmac_f32_dpp v20, v57, v64 row_newbcast:0 row_mask:0xf bank_mask:0xf
    v_fmac_f32_dpp v21, v57, v65 row_newbcast:0 row_mask:0xf bank_mask:0xf
    v_fmac_f32_dpp v22, v57, v66 row_newbcast:0 row_mask:0xf bank_mask:0xf
    v_fmac_f32_dpp v23, v57, v67 row_newbcast:0 row_mask:0xf bank_mask:0xf
    v_fmac_f32_dpp v24, v57, v68 row_newbcast:0 row_mask:0xf bank_mask:0xf
    v_fmac_f32_dpp v25, v57, v69 row_newbcast:0 row_mask:0xf bank_mask:0xf
    v_fmac_f32_dpp v26, v57, v70 row_newbcast:0 row_mask:0xf bank_mask:0xf
    v_fmac_f32_dpp v27, v57, v71 row_newbcast:0 row_mask:0xf bank_mask:0xf
    v_fmac_f32_dpp v28, v57, v64 row_newbcast:1 row_mask:0xf bank_mask:0xf
    v_fmac_f32_dpp v29, v57, v65 row_newbcast:1 row_mask:0xf bank_mask:0xf
    v_fmac_f32_dpp v30, v57, v66 row_newbcast:1 row_mask:0xf bank_mask:0xf
    v_fmac_f32_dpp v31, v57, v67 row_newbcast:1 row_mask:0xf bank_mask:0xf
    v_fmac_f32_dpp v32, v57, v68 row_newbcast:1 row_mask:0xf bank_mask:0xf
    v_fmac_f32_dpp v33, v57, v69 row_newbcast:1 row_mask:0xf bank_mask:0xf
    v_fmac_f32_dpp v34, v57, v70 row_newbcast:1 row_mask:0xf bank_mask:0xf
    v_fmac_f32_dpp v35, v57, v71 row_newbcast:1 row_mask:0xf bank_mask:0xf
    v_fmac_f32_dpp v36, v57, v64 row_newbcast:2 row_mask:0xf bank_mask:0xf
    v_fmac_f32_dpp v37, v57, v65 row_newbcast:2 row_mask:0xf bank_mask:0xf
    v_fmac_f32_dpp v38, v57, v66 row_newbcast:2 row_mask:0xf bank_mask:0xf
    v_fmac_f32_dpp v39, v57, v67 row_newbcast:2 row_mask:0xf bank_mask:0xf
    v_fmac_f32_dpp v40, v57, v68 row_newbcast:2 row_mask:0xf bank_mask:0xf
    v_fmac_f32_dpp v41, v57, v69 row_newbcast:2 row_mask:0xf bank_mask:0xf
    v_fmac_f32_dpp v42, v57, v70 row_newbcast:2 row_mask:0xf bank_mask:0xf
    v_fmac_f32_dpp v43, v57, v71 row_newbcast:2 row_mask:0xf bank_mask:0xf
    v_fmac_f32_dpp v44, v57, v64 row_newbcast:3 row_mask:0xf bank_mask:0xf
    v_fmac_f32_dpp v45, v57, v65 row_newbcast:3 row_mask:0xf bank_mask:0xf
    v_fmac_f32_dpp v46, v57, v66 row_newbcast:3 row_mask:0xf bank_mask:0xf
    v_fmac_f32_dpp v47, v57, v67 row_newbcast:3 row_mask:0xf bank_mask:0xf
    v_fmac_f32_dpp v48, v57, v68 row_newbcast:3 row_mask:0xf bank_mask:0xf
    v_fmac_f32_dpp v49, v57, v69 row_newbcast:3 row_mask:0xf bank_mask:0xf
    v_fmac_f32_dpp v50, v57, v70 row_newbcast:3 row_mask:0xf bank_mask:0xf
    v_fmac_f32_dpp v51, v57, v71 row_newbcast:3 row_mask:0xf bank_mask:0xf
    v_lshlrev_b32 v64, 16, v152
    v_and_b32 v65, 0xffff0000, v152
    v_lshlrev_b32 v66, 16, v153
    v_and_b32 v67, 0xffff0000, v153
    v_lshlrev_b32 v68, 16, v154
    v_and_b32 v69, 0xffff0000, v154
    v_lshlrev_b32 v70, 16, v155
    v_and_b32 v71, 0xffff0000, v155
    v_fmac_f32_dpp v20, v58, v64 row_newbcast:0 row_mask:0xf bank_mask:0xf
    v_fmac_f32_dpp v21, v58, v65 row_newbcast:0 row_mask:0xf bank_mask:0xf
    v_fmac_f32_dpp v22, v58, v66 row_newbcast:0 row_mask:0xf bank_mask:0xf
    v_fmac_f32_dpp v23, v58, v67 row_newbcast:0 row_mask:0xf bank_mask:0xf
    v_fmac_f32_dpp v24, v58, v68 row_newbcast:0 row_mask:0xf bank_mask:0xf
    v_fmac_f32_dpp v25, v58, v69 row_newbcast:0 row_mask:0xf bank_mask:0xf
    v_fmac_f32_dpp v26, v58, v70 row_newbcast:0 row_mask:0xf bank_mask:0xf
    v_fmac_f32_dpp v27, v58, v71 row_newbcast:0 row_mask:0xf bank_mask:0xf
    v_fmac_f32_dpp v28, v58, v64 row_newbcast:1 row_mask:0xf bank_mask:0xf
    v_fmac_f32_dpp v29, v58, v65 row_newbcast:1 row_mask:0xf bank_mask:0xf
    v_fmac_f32_dpp v30, v58, v66 row_newbcast:1 row_mask:0xf bank_mask:0xf
    v_fmac_f32_dpp v31, v58, v67 row_newbcast:1 row_mask:0xf bank_mask:0xf
    v_fmac_f32_dpp v32, v58, v68 row_newbcast:1 row_mask:0xf bank_mask:0xf
    v_fmac_f32_dpp v33, v58, v69 row_newbcast:1 row_mask:0xf bank_mask:0xf
    v_fmac_f32_dpp v34, v58, v70 row_newbcast:1 row_mask:0xf bank_mask:0xf
    v_fmac_f32_dpp v35, v58, v71 row_newbcast:1 row_mask:0xf bank_mask:0xf
    v_fmac_f32_dpp v36, v58, v64 row_newbcast:2 row_mask:0xf bank_mask:0xf
    v_fmac_f32_dpp v37, v58, v65 row_newbcast:2 row_mask:0xf bank_mask:0xf
    v_fmac_f32_dpp v38, v58, v66 row_newbcast:2 row_mask:0xf bank_mask:0xf
    v_fmac_f32_dpp v39, v58, v67 row_newbcast:2 row_mask:0xf bank_mask:0xf
    v_fmac_f32_dpp v40, v58, v68 row_newbcast:2 row_mask:0xf bank_mask:0xf
    v_fmac_f32_dpp v41, v58, v69 row_newbcast:2 row_mask:0xf bank_mask:0xf
    v_fmac_f32_dpp v42, v58, v70 row_newbcast:2 row_mask:0xf bank_mask:0xf
    v_fmac_f32_dpp v43, v58, v71 row_newbcast:2 row_mask:0xf bank_mask:0xf
    v_fmac_f32_dpp v44, v58, v64 row_newbcast:3 row_mask:0xf bank_mask:0xf
    v_fmac_f32_dpp v45, v58, v65 row_newbcast:3 row_mask:0xf bank_mask:0xf
    v_fmac_f32_dpp v46, v58, v66 row_newbcast:3 row_mask:0xf bank_mask:0xf
    v_fmac_f32_dpp v47, v58, v67 row_newbcast:3 row_mask:0xf bank_mask:0xf
    v_fmac_f32_dpp v48, v58, v68 row_newbcast:3 row_mask:0xf bank_mask:0xf
    v_fmac_f32_dpp v49, v58, v69 row_newbcast:3 row_mask:0xf bank_mask:0xf
    v_fmac_f32_dpp v50, v58, v70 row_newbcast:3 row_mask:0xf bank_mask:0xf
    v_fmac_f32_dpp v51, v58, v71 row_newbcast:3 row_mask:0xf bank_mask:0xf
    v_lshlrev_b32 v64, 16, v156
    v_and_b32 v65, 0xffff0000, v156
    v_lshlrev_b32 v66, 16, v157
    v_and_b32 v67, 0xffff0000, v157
    v_lshlrev_b32 v68, 16, v158
    v_and_b32 v69, 0xffff0000, v158
    v_lshlrev_b32 v70, 16, v159
    v_and_b32 v71, 0xffff0000, v159
    v_fmac_f32_dpp v20, v59, v64 row_newbcast:0 row_mask:0xf bank_mask:0xf
    v_fmac_f32_dpp v21, v59, v65 row_newbcast:0 row_mask:0xf bank_mask:0xf
    v_fmac_f32_dpp v22, v59, v66 row_newbcast:0 row_mask:0xf bank_mask:0xf
    v_fmac_f32_dpp v23, v59, v67 row_newbcast:0 row_mask:0xf bank_mask:0xf
    v_fmac_f32_dpp v24, v59, v68 row_newbcast:0 row_mask:0xf bank_mask:0xf
    v_fmac_f32_dpp v25, v59, v69 row_newbcast:0 row_mask:0xf bank_mask:0xf
    v_fmac_f32_dpp v26, v59, v70 row_newbcast:0 row_mask:0xf bank_mask:0xf
    v_fmac_f32_dpp v27, v59, v71 row_newbcast:0 row_mask:0xf bank_mask:0xf
    v_fmac_f32_dpp v28, v59, v64 row_newbcast:1 row_mask:0xf bank_mask:0xf
    v_fmac_f32_dpp v29, v59, v65 row_newbcast:1 row_mask:0xf bank_mask:0xf
    v_fmac_f32_dpp v30, v59, v66 row_newbcast:1 row_mask:0xf bank_mask:0xf
    v_fmac_f32_dpp v31, v59, v67 row_newbcast:1 row_mask:0xf bank_mask:0xf
    v_fmac_f32_dpp v32, v59, v68 row_newbcast:1 row_mask:0xf bank_mask:0xf
    v_fmac_f32_dpp v33, v59, v69 row_newbcast:1 row_mask:0xf bank_mask:0xf
    v_fmac_f32_dpp v34, v59, v70 row_newbcast:1 row_mask:0xf bank_mask:0xf
    v_fmac_f32_dpp v35, v59, v71 row_newbcast:1 row_mask:0xf bank_mask:0xf
    v_fmac_f32_dpp v36, v59, v64 row_newbcast:2 row_mask:0xf bank_mask:0xf
    v_fmac_f32_dpp v37, v59, v65 row_newbcast:2 row_mask:0xf bank_mask:0xf
    v_fmac_f32_dpp v38, v59, v66 row_newbcast:2 row_mask:0xf bank_mask:0xf
    v_fmac_f32_dpp v39, v59, v67 row_newbcast:2 row_mask:0xf bank_mask:0xf
    v_fmac_f32_dpp v40, v59, v68 row_newbcast:2 row_mask:0xf bank_mask:0xf
    v_fmac_f32_dpp v41, v59, v69 row_newbcast:2 row_mask:0xf bank_mask:0xf
    v_fmac_f32_dpp v42, v59, v70 row_newbcast:2 row_mask:0xf bank_mask:0xf
    v_fmac_f32_dpp v43, v59, v71 row_newbcast:2 row_mask:0xf bank_mask:0xf
    v_fmac_f32_dpp v44, v59, v64 row_newbcast:3 row_mask:0xf bank_mask:0xf
    v_fmac_f32_dpp v45, v59, v65 row_newbcast:3 row_mask:0xf bank_mask:0xf
    v_fmac_f32_dpp v46, v59, v66 row_newbcast:3 row_mask:0xf bank_mask:0xf
    v_fmac_f32_dpp v47, v59, v67 row_newbcast:3 row_mask:0xf bank_mask:0xf
    v_fmac_f32_dpp v48, v59, v68 row_newbcast:3 row_mask:0xf bank_mask:0xf
    v_fmac_f32_dpp v49, v59, v69 row_newbcast:3 row_mask:0xf bank_mask:0xf
    v_fmac_f32_dpp v50, v59, v70 row_newbcast:3 row_mask:0xf bank_mask:0xf
    v_fmac_f32_dpp v51, v59, v71 row_newbcast:3 row_mask:0xf bank_mask:0xf
    s_waitcnt vmcnt(20)
    v_mfma_f32_16x16x32_bf16 v[52:55], v[96:99], v[4:7], 0
    v_mfma_f32_16x16x32_bf16 v[52:55], v[100:103], v[8:11], v[52:55]
    v_mfma_f32_16x16x32_bf16 v[52:55], v[104:107], v[12:15], v[52:55]
    v_mfma_f32_16x16x32_bf16 v[52:55], v[108:111], v[16:19], v[52:55]
    s_nop 7
    s_nop 1
    v_max3_f32 v62, v52, v53, v54
    v_max3_f32 v62, v62, v55, v60
    v_cmp_gt_f32 vcc, v62, v60
    s_nop 1
    s_cbranch_vccz k2_attn_kernel_nr13
    v_sub_f32 v63, v60, v62
    v_mul_f32 v63, s21, v63
    v_exp_f32 v63, v63
    v_mov_b32 v60, v62
    v_mul_f32 v61, v61, v63
    s_nop 0
    v_mul_f32_dpp v20, v63, v20 row_newbcast:0 row_mask:0xf bank_mask:0xf
    v_mul_f32_dpp v21, v63, v21 row_newbcast:0 row_mask:0xf bank_mask:0xf
    v_mul_f32_dpp v22, v63, v22 row_newbcast:0 row_mask:0xf bank_mask:0xf
    v_mul_f32_dpp v23, v63, v23 row_newbcast:0 row_mask:0xf bank_mask:0xf
    v_mul_f32_dpp v24, v63, v24 row_newbcast:0 row_mask:0xf bank_mask:0xf
    v_mul_f32_dpp v25, v63, v25 row_newbcast:0 row_mask:0xf bank_mask:0xf
    v_mul_f32_dpp v26, v63, v26 row_newbcast:0 row_mask:0xf bank_mask:0xf
    v_mul_f32_dpp v27, v63, v27 row_newbcast:0 row_mask:0xf bank_mask:0xf
    v_mul_f32_dpp v28, v63, v28 row_newbcast:1 row_mask:0xf bank_mask:0xf
    v_mul_f32_dpp v29, v63, v29 row_newbcast:1 row_mask:0xf bank_mask:0xf
    v_mul_f32_dpp v30, v63, v30 row_newbcast:1 row_mask:0xf bank_mask:0xf
    v_mul_f32_dpp v31, v63, v31 row_newbcast:1 row_mask:0xf bank_mask:0xf
    v_mul_f32_dpp v32, v63, v32 row_newbcast:1 row_mask:0xf bank_mask:0xf
    v_mul_f32_dpp v33, v63, v33 row_newbcast:1 row_mask:0xf bank_mask:0xf
    v_mul_f32_dpp v34, v63, v34 row_newbcast:1 row_mask:0xf bank_mask:0xf
    v_mul_f32_dpp v35, v63, v35 row_newbcast:1 row_mask:0xf bank_mask:0xf
    v_mul_f32_dpp v36, v63, v36 row_newbcast:2 row_mask:0xf bank_mask:0xf
    v_mul_f32_dpp v37, v63, v37 row_newbcast:2 row_mask:0xf bank_mask:0xf
    v_mul_f32_dpp v38, v63, v38 row_newbcast:2 row_mask:0xf bank_mask:0xf
    v_mul_f32_dpp v39, v63, v39 row_newbcast:2 row_mask:0xf bank_mask:0xf
    v_mul_f32_dpp v40, v63, v40 row_newbcast:2 row_mask:0xf bank_mask:0xf
    v_mul_f32_dpp v41, v63, v41 row_newbcast:2 row_mask:0xf bank_mask:0xf
    v_mul_f32_dpp v42, v63, v42 row_newbcast:2 row_mask:0xf bank_mask:0xf
    v_mul_f32_dpp v43, v63, v43 row_newbcast:2 row_mask:0xf bank_mask:0xf
    v_mul_f32_dpp v44, v63, v44 row_newbcast:3 row_mask:0xf bank_mask:0xf
    v_mul_f32_dpp v45, v63, v45 row_newbcast:3 row_mask:0xf bank_mask:0xf
    v_mul_f32_dpp v46, v63, v46 row_newbcast:3 row_mask:0xf bank_mask:0xf
    v_mul_f32_dpp v47, v63, v47 row_newbcast:3 row_mask:0xf bank_mask:0xf
    v_mul_f32_dpp v48, v63, v48 row_newbcast:3 row_mask:0xf bank_mask:0xf
    v_mul_f32_dpp v49, v63, v49 row_newbcast:3 row_mask:0xf bank_mask:0xf
    v_mul_f32_dpp v50, v63, v50 row_newbcast:3 row_mask:0xf bank_mask:0xf
    v_mul_f32_dpp v51, v63, v51 row_newbcast:3 row_mask:0xf bank_mask:0xf
k2_attn_kernel_nr13:
    v_mul_f32 v72, s21, v60
    v_fma_f32 v56, v52, s21, -v72
    v_fma_f32 v57, v53, s21, -v72
    v_fma_f32 v58, v54, s21, -v72
    v_fma_f32 v59, v55, s21, -v72
    v_exp_f32 v56, v56
    v_exp_f32 v57, v57
    v_exp_f32 v58, v58
    v_exp_f32 v59, v59
    s_waitcnt vmcnt(16)
    v_add_f32 v62, v56, v57
    v_add_f32 v63, v58, v59
    v_add_f32 v61, v61, v62
    v_add_f32 v61, v61, v63
    v_lshlrev_b32 v64, 16, v160
    v_and_b32 v65, 0xffff0000, v160
    v_lshlrev_b32 v66, 16, v161
    v_and_b32 v67, 0xffff0000, v161
    v_lshlrev_b32 v68, 16, v162
    v_and_b32 v69, 0xffff0000, v162
    v_lshlrev_b32 v70, 16, v163
    v_and_b32 v71, 0xffff0000, v163
    v_fmac_f32_dpp v20, v56, v64 row_newbcast:0 row_mask:0xf bank_mask:0xf
    v_fmac_f32_dpp v21, v56, v65 row_newbcast:0 row_mask:0xf bank_mask:0xf
    v_fmac_f32_dpp v22, v56, v66 row_newbcast:0 row_mask:0xf bank_mask:0xf
    v_fmac_f32_dpp v23, v56, v67 row_newbcast:0 row_mask:0xf bank_mask:0xf
    v_fmac_f32_dpp v24, v56, v68 row_newbcast:0 row_mask:0xf bank_mask:0xf
    v_fmac_f32_dpp v25, v56, v69 row_newbcast:0 row_mask:0xf bank_mask:0xf
    v_fmac_f32_dpp v26, v56, v70 row_newbcast:0 row_mask:0xf bank_mask:0xf
    v_fmac_f32_dpp v27, v56, v71 row_newbcast:0 row_mask:0xf bank_mask:0xf
    v_fmac_f32_dpp v28, v56, v64 row_newbcast:1 row_mask:0xf bank_mask:0xf
    v_fmac_f32_dpp v29, v56, v65 row_newbcast:1 row_mask:0xf bank_mask:0xf
    v_fmac_f32_dpp v30, v56, v66 row_newbcast:1 row_mask:0xf bank_mask:0xf
    v_fmac_f32_dpp v31, v56, v67 row_newbcast:1 row_mask:0xf bank_mask:0xf
    v_fmac_f32_dpp v32, v56, v68 row_newbcast:1 row_mask:0xf bank_mask:0xf
    v_fmac_f32_dpp v33, v56, v69 row_newbcast:1 row_mask:0xf bank_mask:0xf
    v_fmac_f32_dpp v34, v56, v70 row_newbcast:1 row_mask:0xf bank_mask:0xf
    v_fmac_f32_dpp v35, v56, v71 row_newbcast:1 row_mask:0xf bank_mask:0xf
    v_fmac_f32_dpp v36, v56, v64 row_newbcast:2 row_mask:0xf bank_mask:0xf
    v_fmac_f32_dpp v37, v56, v65 row_newbcast:2 row_mask:0xf bank_mask:0xf
    v_fmac_f32_dpp v38, v56, v66 row_newbcast:2 row_mask:0xf bank_mask:0xf
    v_fmac_f32_dpp v39, v56, v67 row_newbcast:2 row_mask:0xf bank_mask:0xf
    v_fmac_f32_dpp v40, v56, v68 row_newbcast:2 row_mask:0xf bank_mask:0xf
    v_fmac_f32_dpp v41, v56, v69 row_newbcast:2 row_mask:0xf bank_mask:0xf
    v_fmac_f32_dpp v42, v56, v70 row_newbcast:2 row_mask:0xf bank_mask:0xf
    v_fmac_f32_dpp v43, v56, v71 row_newbcast:2 row_mask:0xf bank_mask:0xf
    v_fmac_f32_dpp v44, v56, v64 row_newbcast:3 row_mask:0xf bank_mask:0xf
    v_fmac_f32_dpp v45, v56, v65 row_newbcast:3 row_mask:0xf bank_mask:0xf
    v_fmac_f32_dpp v46, v56, v66 row_newbcast:3 row_mask:0xf bank_mask:0xf
    v_fmac_f32_dpp v47, v56, v67 row_newbcast:3 row_mask:0xf bank_mask:0xf
    v_fmac_f32_dpp v48, v56, v68 row_newbcast:3 row_mask:0xf bank_mask:0xf
    v_fmac_f32_dpp v49, v56, v69 row_newbcast:3 row_mask:0xf bank_mask:0xf
    v_fmac_f32_dpp v50, v56, v70 row_newbcast:3 row_mask:0xf bank_mask:0xf
    v_fmac_f32_dpp v51, v56, v71 row_newbcast:3 row_mask:0xf bank_mask:0xf
    v_lshlrev_b32 v64, 16, v164
    v_and_b32 v65, 0xffff0000, v164
    v_lshlrev_b32 v66, 16, v165
    v_and_b32 v67, 0xffff0000, v165
    v_lshlrev_b32 v68, 16, v166
    v_and_b32 v69, 0xffff0000, v166
    v_lshlrev_b32 v70, 16, v167
    v_and_b32 v71, 0xffff0000, v167
    v_fmac_f32_dpp v20, v57, v64 row_newbcast:0 row_mask:0xf bank_mask:0xf
    v_fmac_f32_dpp v21, v57, v65 row_newbcast:0 row_mask:0xf bank_mask:0xf
    v_fmac_f32_dpp v22, v57, v66 row_newbcast:0 row_mask:0xf bank_mask:0xf
    v_fmac_f32_dpp v23, v57, v67 row_newbcast:0 row_mask:0xf bank_mask:0xf
    v_fmac_f32_dpp v24, v57, v68 row_newbcast:0 row_mask:0xf bank_mask:0xf
    v_fmac_f32_dpp v25, v57, v69 row_newbcast:0 row_mask:0xf bank_mask:0xf
    v_fmac_f32_dpp v26, v57, v70 row_newbcast:0 row_mask:0xf bank_mask:0xf
    v_fmac_f32_dpp v27, v57, v71 row_newbcast:0 row_mask:0xf bank_mask:0xf
    v_fmac_f32_dpp v28, v57, v64 row_newbcast:1 row_mask:0xf bank_mask:0xf
    v_fmac_f32_dpp v29, v57, v65 row_newbcast:1 row_mask:0xf bank_mask:0xf
    v_fmac_f32_dpp v30, v57, v66 row_newbcast:1 row_mask:0xf bank_mask:0xf
    v_fmac_f32_dpp v31, v57, v67 row_newbcast:1 row_mask:0xf bank_mask:0xf
    v_fmac_f32_dpp v32, v57, v68 row_newbcast:1 row_mask:0xf bank_mask:0xf
    v_fmac_f32_dpp v33, v57, v69 row_newbcast:1 row_mask:0xf bank_mask:0xf
    v_fmac_f32_dpp v34, v57, v70 row_newbcast:1 row_mask:0xf bank_mask:0xf
    v_fmac_f32_dpp v35, v57, v71 row_newbcast:1 row_mask:0xf bank_mask:0xf
    v_fmac_f32_dpp v36, v57, v64 row_newbcast:2 row_mask:0xf bank_mask:0xf
    v_fmac_f32_dpp v37, v57, v65 row_newbcast:2 row_mask:0xf bank_mask:0xf
    v_fmac_f32_dpp v38, v57, v66 row_newbcast:2 row_mask:0xf bank_mask:0xf
    v_fmac_f32_dpp v39, v57, v67 row_newbcast:2 row_mask:0xf bank_mask:0xf
    v_fmac_f32_dpp v40, v57, v68 row_newbcast:2 row_mask:0xf bank_mask:0xf
    v_fmac_f32_dpp v41, v57, v69 row_newbcast:2 row_mask:0xf bank_mask:0xf
    v_fmac_f32_dpp v42, v57, v70 row_newbcast:2 row_mask:0xf bank_mask:0xf
    v_fmac_f32_dpp v43, v57, v71 row_newbcast:2 row_mask:0xf bank_mask:0xf
    v_fmac_f32_dpp v44, v57, v64 row_newbcast:3 row_mask:0xf bank_mask:0xf
    v_fmac_f32_dpp v45, v57, v65 row_newbcast:3 row_mask:0xf bank_mask:0xf
    v_fmac_f32_dpp v46, v57, v66 row_newbcast:3 row_mask:0xf bank_mask:0xf
    v_fmac_f32_dpp v47, v57, v67 row_newbcast:3 row_mask:0xf bank_mask:0xf
    v_fmac_f32_dpp v48, v57, v68 row_newbcast:3 row_mask:0xf bank_mask:0xf
    v_fmac_f32_dpp v49, v57, v69 row_newbcast:3 row_mask:0xf bank_mask:0xf
    v_fmac_f32_dpp v50, v57, v70 row_newbcast:3 row_mask:0xf bank_mask:0xf
    v_fmac_f32_dpp v51, v57, v71 row_newbcast:3 row_mask:0xf bank_mask:0xf
    v_lshlrev_b32 v64, 16, v168
    v_and_b32 v65, 0xffff0000, v168
    v_lshlrev_b32 v66, 16, v169
    v_and_b32 v67, 0xffff0000, v169
    v_lshlrev_b32 v68, 16, v170
    v_and_b32 v69, 0xffff0000, v170
    v_lshlrev_b32 v70, 16, v171
    v_and_b32 v71, 0xffff0000, v171
    v_fmac_f32_dpp v20, v58, v64 row_newbcast:0 row_mask:0xf bank_mask:0xf
    v_fmac_f32_dpp v21, v58, v65 row_newbcast:0 row_mask:0xf bank_mask:0xf
    v_fmac_f32_dpp v22, v58, v66 row_newbcast:0 row_mask:0xf bank_mask:0xf
    v_fmac_f32_dpp v23, v58, v67 row_newbcast:0 row_mask:0xf bank_mask:0xf
    v_fmac_f32_dpp v24, v58, v68 row_newbcast:0 row_mask:0xf bank_mask:0xf
    v_fmac_f32_dpp v25, v58, v69 row_newbcast:0 row_mask:0xf bank_mask:0xf
    v_fmac_f32_dpp v26, v58, v70 row_newbcast:0 row_mask:0xf bank_mask:0xf
    v_fmac_f32_dpp v27, v58, v71 row_newbcast:0 row_mask:0xf bank_mask:0xf
    v_fmac_f32_dpp v28, v58, v64 row_newbcast:1 row_mask:0xf bank_mask:0xf
    v_fmac_f32_dpp v29, v58, v65 row_newbcast:1 row_mask:0xf bank_mask:0xf
    v_fmac_f32_dpp v30, v58, v66 row_newbcast:1 row_mask:0xf bank_mask:0xf
    v_fmac_f32_dpp v31, v58, v67 row_newbcast:1 row_mask:0xf bank_mask:0xf
    v_fmac_f32_dpp v32, v58, v68 row_newbcast:1 row_mask:0xf bank_mask:0xf
    v_fmac_f32_dpp v33, v58, v69 row_newbcast:1 row_mask:0xf bank_mask:0xf
    v_fmac_f32_dpp v34, v58, v70 row_newbcast:1 row_mask:0xf bank_mask:0xf
    v_fmac_f32_dpp v35, v58, v71 row_newbcast:1 row_mask:0xf bank_mask:0xf
    v_fmac_f32_dpp v36, v58, v64 row_newbcast:2 row_mask:0xf bank_mask:0xf
    v_fmac_f32_dpp v37, v58, v65 row_newbcast:2 row_mask:0xf bank_mask:0xf
    v_fmac_f32_dpp v38, v58, v66 row_newbcast:2 row_mask:0xf bank_mask:0xf
    v_fmac_f32_dpp v39, v58, v67 row_newbcast:2 row_mask:0xf bank_mask:0xf
    v_fmac_f32_dpp v40, v58, v68 row_newbcast:2 row_mask:0xf bank_mask:0xf
    v_fmac_f32_dpp v41, v58, v69 row_newbcast:2 row_mask:0xf bank_mask:0xf
    v_fmac_f32_dpp v42, v58, v70 row_newbcast:2 row_mask:0xf bank_mask:0xf
    v_fmac_f32_dpp v43, v58, v71 row_newbcast:2 row_mask:0xf bank_mask:0xf
    v_fmac_f32_dpp v44, v58, v64 row_newbcast:3 row_mask:0xf bank_mask:0xf
    v_fmac_f32_dpp v45, v58, v65 row_newbcast:3 row_mask:0xf bank_mask:0xf
    v_fmac_f32_dpp v46, v58, v66 row_newbcast:3 row_mask:0xf bank_mask:0xf
    v_fmac_f32_dpp v47, v58, v67 row_newbcast:3 row_mask:0xf bank_mask:0xf
    v_fmac_f32_dpp v48, v58, v68 row_newbcast:3 row_mask:0xf bank_mask:0xf
    v_fmac_f32_dpp v49, v58, v69 row_newbcast:3 row_mask:0xf bank_mask:0xf
    v_fmac_f32_dpp v50, v58, v70 row_newbcast:3 row_mask:0xf bank_mask:0xf
    v_fmac_f32_dpp v51, v58, v71 row_newbcast:3 row_mask:0xf bank_mask:0xf
    v_lshlrev_b32 v64, 16, v172
    v_and_b32 v65, 0xffff0000, v172
    v_lshlrev_b32 v66, 16, v173
    v_and_b32 v67, 0xffff0000, v173
    v_lshlrev_b32 v68, 16, v174
    v_and_b32 v69, 0xffff0000, v174
    v_lshlrev_b32 v70, 16, v175
    v_and_b32 v71, 0xffff0000, v175
    v_fmac_f32_dpp v20, v59, v64 row_newbcast:0 row_mask:0xf bank_mask:0xf
    v_fmac_f32_dpp v21, v59, v65 row_newbcast:0 row_mask:0xf bank_mask:0xf
    v_fmac_f32_dpp v22, v59, v66 row_newbcast:0 row_mask:0xf bank_mask:0xf
    v_fmac_f32_dpp v23, v59, v67 row_newbcast:0 row_mask:0xf bank_mask:0xf
    v_fmac_f32_dpp v24, v59, v68 row_newbcast:0 row_mask:0xf bank_mask:0xf
    v_fmac_f32_dpp v25, v59, v69 row_newbcast:0 row_mask:0xf bank_mask:0xf
    v_fmac_f32_dpp v26, v59, v70 row_newbcast:0 row_mask:0xf bank_mask:0xf
    v_fmac_f32_dpp v27, v59, v71 row_newbcast:0 row_mask:0xf bank_mask:0xf
    v_fmac_f32_dpp v28, v59, v64 row_newbcast:1 row_mask:0xf bank_mask:0xf
    v_fmac_f32_dpp v29, v59, v65 row_newbcast:1 row_mask:0xf bank_mask:0xf
    v_fmac_f32_dpp v30, v59, v66 row_newbcast:1 row_mask:0xf bank_mask:0xf
    v_fmac_f32_dpp v31, v59, v67 row_newbcast:1 row_mask:0xf bank_mask:0xf
    v_fmac_f32_dpp v32, v59, v68 row_newbcast:1 row_mask:0xf bank_mask:0xf
    v_fmac_f32_dpp v33, v59, v69 row_newbcast:1 row_mask:0xf bank_mask:0xf
    v_fmac_f32_dpp v34, v59, v70 row_newbcast:1 row_mask:0xf bank_mask:0xf
    v_fmac_f32_dpp v35, v59, v71 row_newbcast:1 row_mask:0xf bank_mask:0xf
    v_fmac_f32_dpp v36, v59, v64 row_newbcast:2 row_mask:0xf bank_mask:0xf
    v_fmac_f32_dpp v37, v59, v65 row_newbcast:2 row_mask:0xf bank_mask:0xf
    v_fmac_f32_dpp v38, v59, v66 row_newbcast:2 row_mask:0xf bank_mask:0xf
    v_fmac_f32_dpp v39, v59, v67 row_newbcast:2 row_mask:0xf bank_mask:0xf
    v_fmac_f32_dpp v40, v59, v68 row_newbcast:2 row_mask:0xf bank_mask:0xf
    v_fmac_f32_dpp v41, v59, v69 row_newbcast:2 row_mask:0xf bank_mask:0xf
    v_fmac_f32_dpp v42, v59, v70 row_newbcast:2 row_mask:0xf bank_mask:0xf
    v_fmac_f32_dpp v43, v59, v71 row_newbcast:2 row_mask:0xf bank_mask:0xf
    v_fmac_f32_dpp v44, v59, v64 row_newbcast:3 row_mask:0xf bank_mask:0xf
    v_fmac_f32_dpp v45, v59, v65 row_newbcast:3 row_mask:0xf bank_mask:0xf
    v_fmac_f32_dpp v46, v59, v66 row_newbcast:3 row_mask:0xf bank_mask:0xf
    v_fmac_f32_dpp v47, v59, v67 row_newbcast:3 row_mask:0xf bank_mask:0xf
    v_fmac_f32_dpp v48, v59, v68 row_newbcast:3 row_mask:0xf bank_mask:0xf
    v_fmac_f32_dpp v49, v59, v69 row_newbcast:3 row_mask:0xf bank_mask:0xf
    v_fmac_f32_dpp v50, v59, v70 row_newbcast:3 row_mask:0xf bank_mask:0xf
    v_fmac_f32_dpp v51, v59, v71 row_newbcast:3 row_mask:0xf bank_mask:0xf
    s_waitcnt vmcnt(12)
    v_mfma_f32_16x16x32_bf16 v[52:55], v[112:115], v[4:7], 0
    v_mfma_f32_16x16x32_bf16 v[52:55], v[116:119], v[8:11], v[52:55]
    v_mfma_f32_16x16x32_bf16 v[52:55], v[120:123], v[12:15], v[52:55]
    v_mfma_f32_16x16x32_bf16 v[52:55], v[124:127], v[16:19], v[52:55]
    s_nop 7
    s_nop 1
    v_max3_f32 v62, v52, v53, v54
    v_max3_f32 v62, v62, v55, v60
    v_cmp_gt_f32 vcc, v62, v60
    s_nop 1
    s_cbranch_vccz k2_attn_kernel_nr14
    v_sub_f32 v63, v60, v62
    v_mul_f32 v63, s21, v63
    v_exp_f32 v63, v63
    v_mov_b32 v60, v62
    v_mul_f32 v61, v61, v63
    s_nop 0
    v_mul_f32_dpp v20, v63, v20 row_newbcast:0 row_mask:0xf bank_mask:0xf
    v_mul_f32_dpp v21, v63, v21 row_newbcast:0 row_mask:0xf bank_mask:0xf
    v_mul_f32_dpp v22, v63, v22 row_newbcast:0 row_mask:0xf bank_mask:0xf
    v_mul_f32_dpp v23, v63, v23 row_newbcast:0 row_mask:0xf bank_mask:0xf
    v_mul_f32_dpp v24, v63, v24 row_newbcast:0 row_mask:0xf bank_mask:0xf
    v_mul_f32_dpp v25, v63, v25 row_newbcast:0 row_mask:0xf bank_mask:0xf
    v_mul_f32_dpp v26, v63, v26 row_newbcast:0 row_mask:0xf bank_mask:0xf
    v_mul_f32_dpp v27, v63, v27 row_newbcast:0 row_mask:0xf bank_mask:0xf
    v_mul_f32_dpp v28, v63, v28 row_newbcast:1 row_mask:0xf bank_mask:0xf
    v_mul_f32_dpp v29, v63, v29 row_newbcast:1 row_mask:0xf bank_mask:0xf
    v_mul_f32_dpp v30, v63, v30 row_newbcast:1 row_mask:0xf bank_mask:0xf
    v_mul_f32_dpp v31, v63, v31 row_newbcast:1 row_mask:0xf bank_mask:0xf
    v_mul_f32_dpp v32, v63, v32 row_newbcast:1 row_mask:0xf bank_mask:0xf
    v_mul_f32_dpp v33, v63, v33 row_newbcast:1 row_mask:0xf bank_mask:0xf
    v_mul_f32_dpp v34, v63, v34 row_newbcast:1 row_mask:0xf bank_mask:0xf
    v_mul_f32_dpp v35, v63, v35 row_newbcast:1 row_mask:0xf bank_mask:0xf
    v_mul_f32_dpp v36, v63, v36 row_newbcast:2 row_mask:0xf bank_mask:0xf
    v_mul_f32_dpp v37, v63, v37 row_newbcast:2 row_mask:0xf bank_mask:0xf
    v_mul_f32_dpp v38, v63, v38 row_newbcast:2 row_mask:0xf bank_mask:0xf
    v_mul_f32_dpp v39, v63, v39 row_newbcast:2 row_mask:0xf bank_mask:0xf
    v_mul_f32_dpp v40, v63, v40 row_newbcast:2 row_mask:0xf bank_mask:0xf
    v_mul_f32_dpp v41, v63, v41 row_newbcast:2 row_mask:0xf bank_mask:0xf
    v_mul_f32_dpp v42, v63, v42 row_newbcast:2 row_mask:0xf bank_mask:0xf
    v_mul_f32_dpp v43, v63, v43 row_newbcast:2 row_mask:0xf bank_mask:0xf
    v_mul_f32_dpp v44, v63, v44 row_newbcast:3 row_mask:0xf bank_mask:0xf
    v_mul_f32_dpp v45, v63, v45 row_newbcast:3 row_mask:0xf bank_mask:0xf
    v_mul_f32_dpp v46, v63, v46 row_newbcast:3 row_mask:0xf bank_mask:0xf
    v_mul_f32_dpp v47, v63, v47 row_newbcast:3 row_mask:0xf bank_mask:0xf
    v_mul_f32_dpp v48, v63, v48 row_newbcast:3 row_mask:0xf bank_mask:0xf
    v_mul_f32_dpp v49, v63, v49 row_newbcast:3 row_mask:0xf bank_mask:0xf
    v_mul_f32_dpp v50, v63, v50 row_newbcast:3 row_mask:0xf bank_mask:0xf
    v_mul_f32_dpp v51, v63, v51 row_newbcast:3 row_mask:0xf bank_mask:0xf
k2_attn_kernel_nr14:
    v_mul_f32 v72, s21, v60
    v_fma_f32 v56, v52, s21, -v72
    v_fma_f32 v57, v53, s21, -v72
    v_fma_f32 v58, v54, s21, -v72
    v_fma_f32 v59, v55, s21, -v72
    v_exp_f32 v56, v56
    v_exp_f32 v57, v57
    v_exp_f32 v58, v58
    v_exp_f32 v59, v59
    s_waitcnt vmcnt(8)
    v_add_f32 v62, v56, v57
    v_add_f32 v63, v58, v59
    v_add_f32 v61, v61, v62
    v_add_f32 v61, v61, v63
    v_lshlrev_b32 v64, 16, v176
    v_and_b32 v65, 0xffff0000, v176
    v_lshlrev_b32 v66, 16, v177
    v_and_b32 v67, 0xffff0000, v177
    v_lshlrev_b32 v68, 16, v178
    v_and_b32 v69, 0xffff0000, v178
    v_lshlrev_b32 v70, 16, v179
    v_and_b32 v71, 0xffff0000, v179
    v_fmac_f32_dpp v20, v56, v64 row_newbcast:0 row_mask:0xf bank_mask:0xf
    v_fmac_f32_dpp v21, v56, v65 row_newbcast:0 row_mask:0xf bank_mask:0xf
    v_fmac_f32_dpp v22, v56, v66 row_newbcast:0 row_mask:0xf bank_mask:0xf
    v_fmac_f32_dpp v23, v56, v67 row_newbcast:0 row_mask:0xf bank_mask:0xf
    v_fmac_f32_dpp v24, v56, v68 row_newbcast:0 row_mask:0xf bank_mask:0xf
    v_fmac_f32_dpp v25, v56, v69 row_newbcast:0 row_mask:0xf bank_mask:0xf
    v_fmac_f32_dpp v26, v56, v70 row_newbcast:0 row_mask:0xf bank_mask:0xf
    v_fmac_f32_dpp v27, v56, v71 row_newbcast:0 row_mask:0xf bank_mask:0xf
    v_fmac_f32_dpp v28, v56, v64 row_newbcast:1 row_mask:0xf bank_mask:0xf
    v_fmac_f32_dpp v29, v56, v65 row_newbcast:1 row_mask:0xf bank_mask:0xf
    v_fmac_f32_dpp v30, v56, v66 row_newbcast:1 row_mask:0xf bank_mask:0xf
    v_fmac_f32_dpp v31, v56, v67 row_newbcast:1 row_mask:0xf bank_mask:0xf
    v_fmac_f32_dpp v32, v56, v68 row_newbcast:1 row_mask:0xf bank_mask:0xf
    v_fmac_f32_dpp v33, v56, v69 row_newbcast:1 row_mask:0xf bank_mask:0xf
    v_fmac_f32_dpp v34, v56, v70 row_newbcast:1 row_mask:0xf bank_mask:0xf
    v_fmac_f32_dpp v35, v56, v71 row_newbcast:1 row_mask:0xf bank_mask:0xf
    v_fmac_f32_dpp v36, v56, v64 row_newbcast:2 row_mask:0xf bank_mask:0xf
    v_fmac_f32_dpp v37, v56, v65 row_newbcast:2 row_mask:0xf bank_mask:0xf
    v_fmac_f32_dpp v38, v56, v66 row_newbcast:2 row_mask:0xf bank_mask:0xf
    v_fmac_f32_dpp v39, v56, v67 row_newbcast:2 row_mask:0xf bank_mask:0xf
    v_fmac_f32_dpp v40, v56, v68 row_newbcast:2 row_mask:0xf bank_mask:0xf
    v_fmac_f32_dpp v41, v56, v69 row_newbcast:2 row_mask:0xf bank_mask:0xf
    v_fmac_f32_dpp v42, v56, v70 row_newbcast:2 row_mask:0xf bank_mask:0xf
    v_fmac_f32_dpp v43, v56, v71 row_newbcast:2 row_mask:0xf bank_mask:0xf
    v_fmac_f32_dpp v44, v56, v64 row_newbcast:3 row_mask:0xf bank_mask:0xf
    v_fmac_f32_dpp v45, v56, v65 row_newbcast:3 row_mask:0xf bank_mask:0xf
    v_fmac_f32_dpp v46, v56, v66 row_newbcast:3 row_mask:0xf bank_mask:0xf
    v_fmac_f32_dpp v47, v56, v67 row_newbcast:3 row_mask:0xf bank_mask:0xf
    v_fmac_f32_dpp v48, v56, v68 row_newbcast:3 row_mask:0xf bank_mask:0xf
    v_fmac_f32_dpp v49, v56, v69 row_newbcast:3 row_mask:0xf bank_mask:0xf
    v_fmac_f32_dpp v50, v56, v70 row_newbcast:3 row_mask:0xf bank_mask:0xf
    v_fmac_f32_dpp v51, v56, v71 row_newbcast:3 row_mask:0xf bank_mask:0xf
    v_lshlrev_b32 v64, 16, v180
    v_and_b32 v65, 0xffff0000, v180
    v_lshlrev_b32 v66, 16, v181
    v_and_b32 v67, 0xffff0000, v181
    v_lshlrev_b32 v68, 16, v182
    v_and_b32 v69, 0xffff0000, v182
    v_lshlrev_b32 v70, 16, v183
    v_and_b32 v71, 0xffff0000, v183
    v_fmac_f32_dpp v20, v57, v64 row_newbcast:0 row_mask:0xf bank_mask:0xf
    v_fmac_f32_dpp v21, v57, v65 row_newbcast:0 row_mask:0xf bank_mask:0xf
    v_fmac_f32_dpp v22, v57, v66 row_newbcast:0 row_mask:0xf bank_mask:0xf
    v_fmac_f32_dpp v23, v57, v67 row_newbcast:0 row_mask:0xf bank_mask:0xf
    v_fmac_f32_dpp v24, v57, v68 row_newbcast:0 row_mask:0xf bank_mask:0xf
    v_fmac_f32_dpp v25, v57, v69 row_newbcast:0 row_mask:0xf bank_mask:0xf
    v_fmac_f32_dpp v26, v57, v70 row_newbcast:0 row_mask:0xf bank_mask:0xf
    v_fmac_f32_dpp v27, v57, v71 row_newbcast:0 row_mask:0xf bank_mask:0xf
    v_fmac_f32_dpp v28, v57, v64 row_newbcast:1 row_mask:0xf bank_mask:0xf
    v_fmac_f32_dpp v29, v57, v65 row_newbcast:1 row_mask:0xf bank_mask:0xf
    v_fmac_f32_dpp v30, v57, v66 row_newbcast:1 row_mask:0xf bank_mask:0xf
    v_fmac_f32_dpp v31, v57, v67 row_newbcast:1 row_mask:0xf bank_mask:0xf
    v_fmac_f32_dpp v32, v57, v68 row_newbcast:1 row_mask:0xf bank_mask:0xf
    v_fmac_f32_dpp v33, v57, v69 row_newbcast:1 row_mask:0xf bank_mask:0xf
    v_fmac_f32_dpp v34, v57, v70 row_newbcast:1 row_mask:0xf bank_mask:0xf
    v_fmac_f32_dpp v35, v57, v71 row_newbcast:1 row_mask:0xf bank_mask:0xf
    v_fmac_f32_dpp v36, v57, v64 row_newbcast:2 row_mask:0xf bank_mask:0xf
    v_fmac_f32_dpp v37, v57, v65 row_newbcast:2 row_mask:0xf bank_mask:0xf
    v_fmac_f32_dpp v38, v57, v66 row_newbcast:2 row_mask:0xf bank_mask:0xf
    v_fmac_f32_dpp v39, v57, v67 row_newbcast:2 row_mask:0xf bank_mask:0xf
    v_fmac_f32_dpp v40, v57, v68 row_newbcast:2 row_mask:0xf bank_mask:0xf
    v_fmac_f32_dpp v41, v57, v69 row_newbcast:2 row_mask:0xf bank_mask:0xf
    v_fmac_f32_dpp v42, v57, v70 row_newbcast:2 row_mask:0xf bank_mask:0xf
    v_fmac_f32_dpp v43, v57, v71 row_newbcast:2 row_mask:0xf bank_mask:0xf
    v_fmac_f32_dpp v44, v57, v64 row_newbcast:3 row_mask:0xf bank_mask:0xf
    v_fmac_f32_dpp v45, v57, v65 row_newbcast:3 row_mask:0xf bank_mask:0xf
    v_fmac_f32_dpp v46, v57, v66 row_newbcast:3 row_mask:0xf bank_mask:0xf
    v_fmac_f32_dpp v47, v57, v67 row_newbcast:3 row_mask:0xf bank_mask:0xf
    v_fmac_f32_dpp v48, v57, v68 row_newbcast:3 row_mask:0xf bank_mask:0xf
    v_fmac_f32_dpp v49, v57, v69 row_newbcast:3 row_mask:0xf bank_mask:0xf
    v_fmac_f32_dpp v50, v57, v70 row_newbcast:3 row_mask:0xf bank_mask:0xf
    v_fmac_f32_dpp v51, v57, v71 row_newbcast:3 row_mask:0xf bank_mask:0xf
    v_lshlrev_b32 v64, 16, v184
    v_and_b32 v65, 0xffff0000, v184
    v_lshlrev_b32 v66, 16, v185
    v_and_b32 v67, 0xffff0000, v185
    v_lshlrev_b32 v68, 16, v186
    v_and_b32 v69, 0xffff0000, v186
    v_lshlrev_b32 v70, 16, v187
    v_and_b32 v71, 0xffff0000, v187
    v_fmac_f32_dpp v20, v58, v64 row_newbcast:0 row_mask:0xf bank_mask:0xf
    v_fmac_f32_dpp v21, v58, v65 row_newbcast:0 row_mask:0xf bank_mask:0xf
    v_fmac_f32_dpp v22, v58, v66 row_newbcast:0 row_mask:0xf bank_mask:0xf
    v_fmac_f32_dpp v23, v58, v67 row_newbcast:0 row_mask:0xf bank_mask:0xf
    v_fmac_f32_dpp v24, v58, v68 row_newbcast:0 row_mask:0xf bank_mask:0xf
    v_fmac_f32_dpp v25, v58, v69 row_newbcast:0 row_mask:0xf bank_mask:0xf
    v_fmac_f32_dpp v26, v58, v70 row_newbcast:0 row_mask:0xf bank_mask:0xf
    v_fmac_f32_dpp v27, v58, v71 row_newbcast:0 row_mask:0xf bank_mask:0xf
    v_fmac_f32_dpp v28, v58, v64 row_newbcast:1 row_mask:0xf bank_mask:0xf
    v_fmac_f32_dpp v29, v58, v65 row_newbcast:1 row_mask:0xf bank_mask:0xf
    v_fmac_f32_dpp v30, v58, v66 row_newbcast:1 row_mask:0xf bank_mask:0xf
    v_fmac_f32_dpp v31, v58, v67 row_newbcast:1 row_mask:0xf bank_mask:0xf
    v_fmac_f32_dpp v32, v58, v68 row_newbcast:1 row_mask:0xf bank_mask:0xf
    v_fmac_f32_dpp v33, v58, v69 row_newbcast:1 row_mask:0xf bank_mask:0xf
    v_fmac_f32_dpp v34, v58, v70 row_newbcast:1 row_mask:0xf bank_mask:0xf
    v_fmac_f32_dpp v35, v58, v71 row_newbcast:1 row_mask:0xf bank_mask:0xf
    v_fmac_f32_dpp v36, v58, v64 row_newbcast:2 row_mask:0xf bank_mask:0xf
    v_fmac_f32_dpp v37, v58, v65 row_newbcast:2 row_mask:0xf bank_mask:0xf
    v_fmac_f32_dpp v38, v58, v66 row_newbcast:2 row_mask:0xf bank_mask:0xf
    v_fmac_f32_dpp v39, v58, v67 row_newbcast:2 row_mask:0xf bank_mask:0xf
    v_fmac_f32_dpp v40, v58, v68 row_newbcast:2 row_mask:0xf bank_mask:0xf
    v_fmac_f32_dpp v41, v58, v69 row_newbcast:2 row_mask:0xf bank_mask:0xf
    v_fmac_f32_dpp v42, v58, v70 row_newbcast:2 row_mask:0xf bank_mask:0xf
    v_fmac_f32_dpp v43, v58, v71 row_newbcast:2 row_mask:0xf bank_mask:0xf
    v_fmac_f32_dpp v44, v58, v64 row_newbcast:3 row_mask:0xf bank_mask:0xf
    v_fmac_f32_dpp v45, v58, v65 row_newbcast:3 row_mask:0xf bank_mask:0xf
    v_fmac_f32_dpp v46, v58, v66 row_newbcast:3 row_mask:0xf bank_mask:0xf
    v_fmac_f32_dpp v47, v58, v67 row_newbcast:3 row_mask:0xf bank_mask:0xf
    v_fmac_f32_dpp v48, v58, v68 row_newbcast:3 row_mask:0xf bank_mask:0xf
    v_fmac_f32_dpp v49, v58, v69 row_newbcast:3 row_mask:0xf bank_mask:0xf
    v_fmac_f32_dpp v50, v58, v70 row_newbcast:3 row_mask:0xf bank_mask:0xf
    v_fmac_f32_dpp v51, v58, v71 row_newbcast:3 row_mask:0xf bank_mask:0xf
    v_lshlrev_b32 v64, 16, v188
    v_and_b32 v65, 0xffff0000, v188
    v_lshlrev_b32 v66, 16, v189
    v_and_b32 v67, 0xffff0000, v189
    v_lshlrev_b32 v68, 16, v190
    v_and_b32 v69, 0xffff0000, v190
    v_lshlrev_b32 v70, 16, v191
    v_and_b32 v71, 0xffff0000, v191
    v_fmac_f32_dpp v20, v59, v64 row_newbcast:0 row_mask:0xf bank_mask:0xf
    v_fmac_f32_dpp v21, v59, v65 row_newbcast:0 row_mask:0xf bank_mask:0xf
    v_fmac_f32_dpp v22, v59, v66 row_newbcast:0 row_mask:0xf bank_mask:0xf
    v_fmac_f32_dpp v23, v59, v67 row_newbcast:0 row_mask:0xf bank_mask:0xf
    v_fmac_f32_dpp v24, v59, v68 row_newbcast:0 row_mask:0xf bank_mask:0xf
    v_fmac_f32_dpp v25, v59, v69 row_newbcast:0 row_mask:0xf bank_mask:0xf
    v_fmac_f32_dpp v26, v59, v70 row_newbcast:0 row_mask:0xf bank_mask:0xf
    v_fmac_f32_dpp v27, v59, v71 row_newbcast:0 row_mask:0xf bank_mask:0xf
    v_fmac_f32_dpp v28, v59, v64 row_newbcast:1 row_mask:0xf bank_mask:0xf
    v_fmac_f32_dpp v29, v59, v65 row_newbcast:1 row_mask:0xf bank_mask:0xf
    v_fmac_f32_dpp v30, v59, v66 row_newbcast:1 row_mask:0xf bank_mask:0xf
    v_fmac_f32_dpp v31, v59, v67 row_newbcast:1 row_mask:0xf bank_mask:0xf
    v_fmac_f32_dpp v32, v59, v68 row_newbcast:1 row_mask:0xf bank_mask:0xf
    v_fmac_f32_dpp v33, v59, v69 row_newbcast:1 row_mask:0xf bank_mask:0xf
    v_fmac_f32_dpp v34, v59, v70 row_newbcast:1 row_mask:0xf bank_mask:0xf
    v_fmac_f32_dpp v35, v59, v71 row_newbcast:1 row_mask:0xf bank_mask:0xf
    v_fmac_f32_dpp v36, v59, v64 row_newbcast:2 row_mask:0xf bank_mask:0xf
    v_fmac_f32_dpp v37, v59, v65 row_newbcast:2 row_mask:0xf bank_mask:0xf
    v_fmac_f32_dpp v38, v59, v66 row_newbcast:2 row_mask:0xf bank_mask:0xf
    v_fmac_f32_dpp v39, v59, v67 row_newbcast:2 row_mask:0xf bank_mask:0xf
    v_fmac_f32_dpp v40, v59, v68 row_newbcast:2 row_mask:0xf bank_mask:0xf
    v_fmac_f32_dpp v41, v59, v69 row_newbcast:2 row_mask:0xf bank_mask:0xf
    v_fmac_f32_dpp v42, v59, v70 row_newbcast:2 row_mask:0xf bank_mask:0xf
    v_fmac_f32_dpp v43, v59, v71 row_newbcast:2 row_mask:0xf bank_mask:0xf
    v_fmac_f32_dpp v44, v59, v64 row_newbcast:3 row_mask:0xf bank_mask:0xf
    v_fmac_f32_dpp v45, v59, v65 row_newbcast:3 row_mask:0xf bank_mask:0xf
    v_fmac_f32_dpp v46, v59, v66 row_newbcast:3 row_mask:0xf bank_mask:0xf
    v_fmac_f32_dpp v47, v59, v67 row_newbcast:3 row_mask:0xf bank_mask:0xf
    v_fmac_f32_dpp v48, v59, v68 row_newbcast:3 row_mask:0xf bank_mask:0xf
    v_fmac_f32_dpp v49, v59, v69 row_newbcast:3 row_mask:0xf bank_mask:0xf
    v_fmac_f32_dpp v50, v59, v70 row_newbcast:3 row_mask:0xf bank_mask:0xf
    v_fmac_f32_dpp v51, v59, v71 row_newbcast:3 row_mask:0xf bank_mask:0xf
    s_waitcnt vmcnt(4)
    v_mfma_f32_16x16x32_bf16 v[52:55], v[128:131], v[4:7], 0
    v_mfma_f32_16x16x32_bf16 v[52:55], v[132:135], v[8:11], v[52:55]
    v_mfma_f32_16x16x32_bf16 v[52:55], v[136:139], v[12:15], v[52:55]
    v_mfma_f32_16x16x32_bf16 v[52:55], v[140:143], v[16:19], v[52:55]
    s_nop 7
    s_nop 1
    v_max3_f32 v62, v52, v53, v54
    v_max3_f32 v62, v62, v55, v60
    v_cmp_gt_f32 vcc, v62, v60
    s_nop 1
    s_cbranch_vccz k2_attn_kernel_nr15
    v_sub_f32 v63, v60, v62
    v_mul_f32 v63, s21, v63
    v_exp_f32 v63, v63
    v_mov_b32 v60, v62
    v_mul_f32 v61, v61, v63
    s_nop 0
    v_mul_f32_dpp v20, v63, v20 row_newbcast:0 row_mask:0xf bank_mask:0xf
    v_mul_f32_dpp v21, v63, v21 row_newbcast:0 row_mask:0xf bank_mask:0xf
    v_mul_f32_dpp v22, v63, v22 row_newbcast:0 row_mask:0xf bank_mask:0xf
    v_mul_f32_dpp v23, v63, v23 row_newbcast:0 row_mask:0xf bank_mask:0xf
    v_mul_f32_dpp v24, v63, v24 row_newbcast:0 row_mask:0xf bank_mask:0xf
    v_mul_f32_dpp v25, v63, v25 row_newbcast:0 row_mask:0xf bank_mask:0xf
    v_mul_f32_dpp v26, v63, v26 row_newbcast:0 row_mask:0xf bank_mask:0xf
    v_mul_f32_dpp v27, v63, v27 row_newbcast:0 row_mask:0xf bank_mask:0xf
    v_mul_f32_dpp v28, v63, v28 row_newbcast:1 row_mask:0xf bank_mask:0xf
    v_mul_f32_dpp v29, v63, v29 row_newbcast:1 row_mask:0xf bank_mask:0xf
    v_mul_f32_dpp v30, v63, v30 row_newbcast:1 row_mask:0xf bank_mask:0xf
    v_mul_f32_dpp v31, v63, v31 row_newbcast:1 row_mask:0xf bank_mask:0xf
    v_mul_f32_dpp v32, v63, v32 row_newbcast:1 row_mask:0xf bank_mask:0xf
    v_mul_f32_dpp v33, v63, v33 row_newbcast:1 row_mask:0xf bank_mask:0xf
    v_mul_f32_dpp v34, v63, v34 row_newbcast:1 row_mask:0xf bank_mask:0xf
    v_mul_f32_dpp v35, v63, v35 row_newbcast:1 row_mask:0xf bank_mask:0xf
    v_mul_f32_dpp v36, v63, v36 row_newbcast:2 row_mask:0xf bank_mask:0xf
    v_mul_f32_dpp v37, v63, v37 row_newbcast:2 row_mask:0xf bank_mask:0xf
    v_mul_f32_dpp v38, v63, v38 row_newbcast:2 row_mask:0xf bank_mask:0xf
    v_mul_f32_dpp v39, v63, v39 row_newbcast:2 row_mask:0xf bank_mask:0xf
    v_mul_f32_dpp v40, v63, v40 row_newbcast:2 row_mask:0xf bank_mask:0xf
    v_mul_f32_dpp v41, v63, v41 row_newbcast:2 row_mask:0xf bank_mask:0xf
    v_mul_f32_dpp v42, v63, v42 row_newbcast:2 row_mask:0xf bank_mask:0xf
    v_mul_f32_dpp v43, v63, v43 row_newbcast:2 row_mask:0xf bank_mask:0xf
    v_mul_f32_dpp v44, v63, v44 row_newbcast:3 row_mask:0xf bank_mask:0xf
    v_mul_f32_dpp v45, v63, v45 row_newbcast:3 row_mask:0xf bank_mask:0xf
    v_mul_f32_dpp v46, v63, v46 row_newbcast:3 row_mask:0xf bank_mask:0xf
    v_mul_f32_dpp v47, v63, v47 row_newbcast:3 row_mask:0xf bank_mask:0xf
    v_mul_f32_dpp v48, v63, v48 row_newbcast:3 row_mask:0xf bank_mask:0xf
    v_mul_f32_dpp v49, v63, v49 row_newbcast:3 row_mask:0xf bank_mask:0xf
    v_mul_f32_dpp v50, v63, v50 row_newbcast:3 row_mask:0xf bank_mask:0xf
    v_mul_f32_dpp v51, v63, v51 row_newbcast:3 row_mask:0xf bank_mask:0xf
k2_attn_kernel_nr15:
    v_mul_f32 v72, s21, v60
    v_fma_f32 v56, v52, s21, -v72
    v_fma_f32 v57, v53, s21, -v72
    v_fma_f32 v58, v54, s21, -v72
    v_fma_f32 v59, v55, s21, -v72
    v_exp_f32 v56, v56
    v_exp_f32 v57, v57
    v_exp_f32 v58, v58
    v_exp_f32 v59, v59
    s_waitcnt vmcnt(0)
    v_add_f32 v62, v56, v57
    v_add_f32 v63, v58, v59
    v_add_f32 v61, v61, v62
    v_add_f32 v61, v61, v63
    v_lshlrev_b32 v64, 16, v192
    v_and_b32 v65, 0xffff0000, v192
    v_lshlrev_b32 v66, 16, v193
    v_and_b32 v67, 0xffff0000, v193
    v_lshlrev_b32 v68, 16, v194
    v_and_b32 v69, 0xffff0000, v194
    v_lshlrev_b32 v70, 16, v195
    v_and_b32 v71, 0xffff0000, v195
    v_fmac_f32_dpp v20, v56, v64 row_newbcast:0 row_mask:0xf bank_mask:0xf
    v_fmac_f32_dpp v21, v56, v65 row_newbcast:0 row_mask:0xf bank_mask:0xf
    v_fmac_f32_dpp v22, v56, v66 row_newbcast:0 row_mask:0xf bank_mask:0xf
    v_fmac_f32_dpp v23, v56, v67 row_newbcast:0 row_mask:0xf bank_mask:0xf
    v_fmac_f32_dpp v24, v56, v68 row_newbcast:0 row_mask:0xf bank_mask:0xf
    v_fmac_f32_dpp v25, v56, v69 row_newbcast:0 row_mask:0xf bank_mask:0xf
    v_fmac_f32_dpp v26, v56, v70 row_newbcast:0 row_mask:0xf bank_mask:0xf
    v_fmac_f32_dpp v27, v56, v71 row_newbcast:0 row_mask:0xf bank_mask:0xf
    v_fmac_f32_dpp v28, v56, v64 row_newbcast:1 row_mask:0xf bank_mask:0xf
    v_fmac_f32_dpp v29, v56, v65 row_newbcast:1 row_mask:0xf bank_mask:0xf
    v_fmac_f32_dpp v30, v56, v66 row_newbcast:1 row_mask:0xf bank_mask:0xf
    v_fmac_f32_dpp v31, v56, v67 row_newbcast:1 row_mask:0xf bank_mask:0xf
    v_fmac_f32_dpp v32, v56, v68 row_newbcast:1 row_mask:0xf bank_mask:0xf
    v_fmac_f32_dpp v33, v56, v69 row_newbcast:1 row_mask:0xf bank_mask:0xf
    v_fmac_f32_dpp v34, v56, v70 row_newbcast:1 row_mask:0xf bank_mask:0xf
    v_fmac_f32_dpp v35, v56, v71 row_newbcast:1 row_mask:0xf bank_mask:0xf
    v_fmac_f32_dpp v36, v56, v64 row_newbcast:2 row_mask:0xf bank_mask:0xf
    v_fmac_f32_dpp v37, v56, v65 row_newbcast:2 row_mask:0xf bank_mask:0xf
    v_fmac_f32_dpp v38, v56, v66 row_newbcast:2 row_mask:0xf bank_mask:0xf
    v_fmac_f32_dpp v39, v56, v67 row_newbcast:2 row_mask:0xf bank_mask:0xf
    v_fmac_f32_dpp v40, v56, v68 row_newbcast:2 row_mask:0xf bank_mask:0xf
    v_fmac_f32_dpp v41, v56, v69 row_newbcast:2 row_mask:0xf bank_mask:0xf
    v_fmac_f32_dpp v42, v56, v70 row_newbcast:2 row_mask:0xf bank_mask:0xf
    v_fmac_f32_dpp v43, v56, v71 row_newbcast:2 row_mask:0xf bank_mask:0xf
    v_fmac_f32_dpp v44, v56, v64 row_newbcast:3 row_mask:0xf bank_mask:0xf
    v_fmac_f32_dpp v45, v56, v65 row_newbcast:3 row_mask:0xf bank_mask:0xf
    v_fmac_f32_dpp v46, v56, v66 row_newbcast:3 row_mask:0xf bank_mask:0xf
    v_fmac_f32_dpp v47, v56, v67 row_newbcast:3 row_mask:0xf bank_mask:0xf
    v_fmac_f32_dpp v48, v56, v68 row_newbcast:3 row_mask:0xf bank_mask:0xf
    v_fmac_f32_dpp v49, v56, v69 row_newbcast:3 row_mask:0xf bank_mask:0xf
    v_fmac_f32_dpp v50, v56, v70 row_newbcast:3 row_mask:0xf bank_mask:0xf
    v_fmac_f32_dpp v51, v56, v71 row_newbcast:3 row_mask:0xf bank_mask:0xf
    v_lshlrev_b32 v64, 16, v196
    v_and_b32 v65, 0xffff0000, v196
    v_lshlrev_b32 v66, 16, v197
    v_and_b32 v67, 0xffff0000, v197
    v_lshlrev_b32 v68, 16, v198
    v_and_b32 v69, 0xffff0000, v198
    v_lshlrev_b32 v70, 16, v199
    v_and_b32 v71, 0xffff0000, v199
    v_fmac_f32_dpp v20, v57, v64 row_newbcast:0 row_mask:0xf bank_mask:0xf
    v_fmac_f32_dpp v21, v57, v65 row_newbcast:0 row_mask:0xf bank_mask:0xf
    v_fmac_f32_dpp v22, v57, v66 row_newbcast:0 row_mask:0xf bank_mask:0xf
    v_fmac_f32_dpp v23, v57, v67 row_newbcast:0 row_mask:0xf bank_mask:0xf
    v_fmac_f32_dpp v24, v57, v68 row_newbcast:0 row_mask:0xf bank_mask:0xf
    v_fmac_f32_dpp v25, v57, v69 row_newbcast:0 row_mask:0xf bank_mask:0xf
    v_fmac_f32_dpp v26, v57, v70 row_newbcast:0 row_mask:0xf bank_mask:0xf
    v_fmac_f32_dpp v27, v57, v71 row_newbcast:0 row_mask:0xf bank_mask:0xf
    v_fmac_f32_dpp v28, v57, v64 row_newbcast:1 row_mask:0xf bank_mask:0xf
    v_fmac_f32_dpp v29, v57, v65 row_newbcast:1 row_mask:0xf bank_mask:0xf
    v_fmac_f32_dpp v30, v57, v66 row_newbcast:1 row_mask:0xf bank_mask:0xf
    v_fmac_f32_dpp v31, v57, v67 row_newbcast:1 row_mask:0xf bank_mask:0xf
    v_fmac_f32_dpp v32, v57, v68 row_newbcast:1 row_mask:0xf bank_mask:0xf
    v_fmac_f32_dpp v33, v57, v69 row_newbcast:1 row_mask:0xf bank_mask:0xf
    v_fmac_f32_dpp v34, v57, v70 row_newbcast:1 row_mask:0xf bank_mask:0xf
    v_fmac_f32_dpp v35, v57, v71 row_newbcast:1 row_mask:0xf bank_mask:0xf
    v_fmac_f32_dpp v36, v57, v64 row_newbcast:2 row_mask:0xf bank_mask:0xf
    v_fmac_f32_dpp v37, v57, v65 row_newbcast:2 row_mask:0xf bank_mask:0xf
    v_fmac_f32_dpp v38, v57, v66 row_newbcast:2 row_mask:0xf bank_mask:0xf
    v_fmac_f32_dpp v39, v57, v67 row_newbcast:2 row_mask:0xf bank_mask:0xf
    v_fmac_f32_dpp v40, v57, v68 row_newbcast:2 row_mask:0xf bank_mask:0xf
    v_fmac_f32_dpp v41, v57, v69 row_newbcast:2 row_mask:0xf bank_mask:0xf
    v_fmac_f32_dpp v42, v57, v70 row_newbcast:2 row_mask:0xf bank_mask:0xf
    v_fmac_f32_dpp v43, v57, v71 row_newbcast:2 row_mask:0xf bank_mask:0xf
    v_fmac_f32_dpp v44, v57, v64 row_newbcast:3 row_mask:0xf bank_mask:0xf
    v_fmac_f32_dpp v45, v57, v65 row_newbcast:3 row_mask:0xf bank_mask:0xf
    v_fmac_f32_dpp v46, v57, v66 row_newbcast:3 row_mask:0xf bank_mask:0xf
    v_fmac_f32_dpp v47, v57, v67 row_newbcast:3 row_mask:0xf bank_mask:0xf
    v_fmac_f32_dpp v48, v57, v68 row_newbcast:3 row_mask:0xf bank_mask:0xf
    v_fmac_f32_dpp v49, v57, v69 row_newbcast:3 row_mask:0xf bank_mask:0xf
    v_fmac_f32_dpp v50, v57, v70 row_newbcast:3 row_mask:0xf bank_mask:0xf
    v_fmac_f32_dpp v51, v57, v71 row_newbcast:3 row_mask:0xf bank_mask:0xf
    v_lshlrev_b32 v64, 16, v200
    v_and_b32 v65, 0xffff0000, v200
    v_lshlrev_b32 v66, 16, v201
    v_and_b32 v67, 0xffff0000, v201
    v_lshlrev_b32 v68, 16, v202
    v_and_b32 v69, 0xffff0000, v202
    v_lshlrev_b32 v70, 16, v203
    v_and_b32 v71, 0xffff0000, v203
    v_fmac_f32_dpp v20, v58, v64 row_newbcast:0 row_mask:0xf bank_mask:0xf
    v_fmac_f32_dpp v21, v58, v65 row_newbcast:0 row_mask:0xf bank_mask:0xf
    v_fmac_f32_dpp v22, v58, v66 row_newbcast:0 row_mask:0xf bank_mask:0xf
    v_fmac_f32_dpp v23, v58, v67 row_newbcast:0 row_mask:0xf bank_mask:0xf
    v_fmac_f32_dpp v24, v58, v68 row_newbcast:0 row_mask:0xf bank_mask:0xf
    v_fmac_f32_dpp v25, v58, v69 row_newbcast:0 row_mask:0xf bank_mask:0xf
    v_fmac_f32_dpp v26, v58, v70 row_newbcast:0 row_mask:0xf bank_mask:0xf
    v_fmac_f32_dpp v27, v58, v71 row_newbcast:0 row_mask:0xf bank_mask:0xf
    v_fmac_f32_dpp v28, v58, v64 row_newbcast:1 row_mask:0xf bank_mask:0xf
    v_fmac_f32_dpp v29, v58, v65 row_newbcast:1 row_mask:0xf bank_mask:0xf
    v_fmac_f32_dpp v30, v58, v66 row_newbcast:1 row_mask:0xf bank_mask:0xf
    v_fmac_f32_dpp v31, v58, v67 row_newbcast:1 row_mask:0xf bank_mask:0xf
    v_fmac_f32_dpp v32, v58, v68 row_newbcast:1 row_mask:0xf bank_mask:0xf
    v_fmac_f32_dpp v33, v58, v69 row_newbcast:1 row_mask:0xf bank_mask:0xf
    v_fmac_f32_dpp v34, v58, v70 row_newbcast:1 row_mask:0xf bank_mask:0xf
    v_fmac_f32_dpp v35, v58, v71 row_newbcast:1 row_mask:0xf bank_mask:0xf
    v_fmac_f32_dpp v36, v58, v64 row_newbcast:2 row_mask:0xf bank_mask:0xf
    v_fmac_f32_dpp v37, v58, v65 row_newbcast:2 row_mask:0xf bank_mask:0xf
    v_fmac_f32_dpp v38, v58, v66 row_newbcast:2 row_mask:0xf bank_mask:0xf
    v_fmac_f32_dpp v39, v58, v67 row_newbcast:2 row_mask:0xf bank_mask:0xf
    v_fmac_f32_dpp v40, v58, v68 row_newbcast:2 row_mask:0xf bank_mask:0xf
    v_fmac_f32_dpp v41, v58, v69 row_newbcast:2 row_mask:0xf bank_mask:0xf
    v_fmac_f32_dpp v42, v58, v70 row_newbcast:2 row_mask:0xf bank_mask:0xf
    v_fmac_f32_dpp v43, v58, v71 row_newbcast:2 row_mask:0xf bank_mask:0xf
    v_fmac_f32_dpp v44, v58, v64 row_newbcast:3 row_mask:0xf bank_mask:0xf
    v_fmac_f32_dpp v45, v58, v65 row_newbcast:3 row_mask:0xf bank_mask:0xf
    v_fmac_f32_dpp v46, v58, v66 row_newbcast:3 row_mask:0xf bank_mask:0xf
    v_fmac_f32_dpp v47, v58, v67 row_newbcast:3 row_mask:0xf bank_mask:0xf
    v_fmac_f32_dpp v48, v58, v68 row_newbcast:3 row_mask:0xf bank_mask:0xf
    v_fmac_f32_dpp v49, v58, v69 row_newbcast:3 row_mask:0xf bank_mask:0xf
    v_fmac_f32_dpp v50, v58, v70 row_newbcast:3 row_mask:0xf bank_mask:0xf
    v_fmac_f32_dpp v51, v58, v71 row_newbcast:3 row_mask:0xf bank_mask:0xf
    v_lshlrev_b32 v64, 16, v204
    v_and_b32 v65, 0xffff0000, v204
    v_lshlrev_b32 v66, 16, v205
    v_and_b32 v67, 0xffff0000, v205
    v_lshlrev_b32 v68, 16, v206
    v_and_b32 v69, 0xffff0000, v206
    v_lshlrev_b32 v70, 16, v207
    v_and_b32 v71, 0xffff0000, v207
    v_fmac_f32_dpp v20, v59, v64 row_newbcast:0 row_mask:0xf bank_mask:0xf
    v_fmac_f32_dpp v21, v59, v65 row_newbcast:0 row_mask:0xf bank_mask:0xf
    v_fmac_f32_dpp v22, v59, v66 row_newbcast:0 row_mask:0xf bank_mask:0xf
    v_fmac_f32_dpp v23, v59, v67 row_newbcast:0 row_mask:0xf bank_mask:0xf
    v_fmac_f32_dpp v24, v59, v68 row_newbcast:0 row_mask:0xf bank_mask:0xf
    v_fmac_f32_dpp v25, v59, v69 row_newbcast:0 row_mask:0xf bank_mask:0xf
    v_fmac_f32_dpp v26, v59, v70 row_newbcast:0 row_mask:0xf bank_mask:0xf
    v_fmac_f32_dpp v27, v59, v71 row_newbcast:0 row_mask:0xf bank_mask:0xf
    v_fmac_f32_dpp v28, v59, v64 row_newbcast:1 row_mask:0xf bank_mask:0xf
    v_fmac_f32_dpp v29, v59, v65 row_newbcast:1 row_mask:0xf bank_mask:0xf
    v_fmac_f32_dpp v30, v59, v66 row_newbcast:1 row_mask:0xf bank_mask:0xf
    v_fmac_f32_dpp v31, v59, v67 row_newbcast:1 row_mask:0xf bank_mask:0xf
    v_fmac_f32_dpp v32, v59, v68 row_newbcast:1 row_mask:0xf bank_mask:0xf
    v_fmac_f32_dpp v33, v59, v69 row_newbcast:1 row_mask:0xf bank_mask:0xf
    v_fmac_f32_dpp v34, v59, v70 row_newbcast:1 row_mask:0xf bank_mask:0xf
    v_fmac_f32_dpp v35, v59, v71 row_newbcast:1 row_mask:0xf bank_mask:0xf
    v_fmac_f32_dpp v36, v59, v64 row_newbcast:2 row_mask:0xf bank_mask:0xf
    v_fmac_f32_dpp v37, v59, v65 row_newbcast:2 row_mask:0xf bank_mask:0xf
    v_fmac_f32_dpp v38, v59, v66 row_newbcast:2 row_mask:0xf bank_mask:0xf
    v_fmac_f32_dpp v39, v59, v67 row_newbcast:2 row_mask:0xf bank_mask:0xf
    v_fmac_f32_dpp v40, v59, v68 row_newbcast:2 row_mask:0xf bank_mask:0xf
    v_fmac_f32_dpp v41, v59, v69 row_newbcast:2 row_mask:0xf bank_mask:0xf
    v_fmac_f32_dpp v42, v59, v70 row_newbcast:2 row_mask:0xf bank_mask:0xf
    v_fmac_f32_dpp v43, v59, v71 row_newbcast:2 row_mask:0xf bank_mask:0xf
    v_fmac_f32_dpp v44, v59, v64 row_newbcast:3 row_mask:0xf bank_mask:0xf
    v_fmac_f32_dpp v45, v59, v65 row_newbcast:3 row_mask:0xf bank_mask:0xf
    v_fmac_f32_dpp v46, v59, v66 row_newbcast:3 row_mask:0xf bank_mask:0xf
    v_fmac_f32_dpp v47, v59, v67 row_newbcast:3 row_mask:0xf bank_mask:0xf
    v_fmac_f32_dpp v48, v59, v68 row_newbcast:3 row_mask:0xf bank_mask:0xf
    v_fmac_f32_dpp v49, v59, v69 row_newbcast:3 row_mask:0xf bank_mask:0xf
    v_fmac_f32_dpp v50, v59, v70 row_newbcast:3 row_mask:0xf bank_mask:0xf
    v_fmac_f32_dpp v51, v59, v71 row_newbcast:3 row_mask:0xf bank_mask:0xf
    v_lshrrev_b32 v1, 4, v0
    v_lshlrev_b32 v2, 11, v1
    v_and_b32 v3, 15, v0
    v_lshl_add_u32 v2, v3, 5, v2
    ds_write_b128 v2, v[20:23] offset:0
    ds_write_b128 v2, v[24:27] offset:16
    ds_write_b128 v2, v[28:31] offset:512
    ds_write_b128 v2, v[32:35] offset:528
    ds_write_b128 v2, v[36:39] offset:1024
    ds_write_b128 v2, v[40:43] offset:1040
    ds_write_b128 v2, v[44:47] offset:1536
    ds_write_b128 v2, v[48:51] offset:1552
    v_lshlrev_b32 v2, 5, v1
    v_lshl_add_u32 v2, v3, 3, v2
    v_cmp_gt_u32 vcc, 4, v3
    s_and_saveexec_b64 s[24:25], vcc
    ds_write_b64 v2, v[60:61] offset:32768
    s_mov_b64 exec, s[24:25]
    s_waitcnt lgkmcnt(0)
    s_barrier
    v_lshrrev_b32 v1, 6, v0
    v_lshlrev_b32 v2, 3, v1
    ds_read_b64 v[80:81], v2 offset:32768
    ds_read_b64 v[82:83], v2 offset:32800
    ds_read_b64 v[84:85], v2 offset:32832
    ds_read_b64 v[86:87], v2 offset:32864
    ds_read_b64 v[88:89], v2 offset:32896
    ds_read_b64 v[90:91], v2 offset:32928
    ds_read_b64 v[92:93], v2 offset:32960
    ds_read_b64 v[94:95], v2 offset:32992
    ds_read_b64 v[96:97], v2 offset:33024
    ds_read_b64 v[98:99], v2 offset:33056
    ds_read_b64 v[100:101], v2 offset:33088
    ds_read_b64 v[102:103], v2 offset:33120
    ds_read_b64 v[104:105], v2 offset:33152
    ds_read_b64 v[106:107], v2 offset:33184
    ds_read_b64 v[108:109], v2 offset:33216
    ds_read_b64 v[110:111], v2 offset:33248
    v_and_b32 v3, 63, v0
    v_lshlrev_b32 v3, 3, v3
    v_lshl_add_u32 v3, v1, 9, v3
    ds_read_b64 v[120:121], v3 offset:0
    ds_read_b64 v[122:123], v3 offset:2048
    ds_read_b64 v[124:125], v3 offset:4096
    ds_read_b64 v[126:127], v3 offset:6144
    ds_read_b64 v[128:129], v3 offset:8192
    ds_read_b64 v[130:131], v3 offset:10240
    ds_read_b64 v[132:133], v3 offset:12288
    ds_read_b64 v[134:135], v3 offset:14336
    ds_read_b64 v[136:137], v3 offset:16384
    ds_read_b64 v[138:139], v3 offset:18432
    ds_read_b64 v[140:141], v3 offset:20480
    ds_read_b64 v[142:143], v3 offset:22528
    ds_read_b64 v[144:145], v3 offset:24576
    ds_read_b64 v[146:147], v3 offset:26624
    ds_read_b64 v[148:149], v3 offset:28672
    ds_read_b64 v[150:151], v3 offset:30720
    s_waitcnt lgkmcnt(0)
    v_max_f32 v4, v80, v82
    v_max_f32 v4, v4, v84
    v_max_f32 v4, v4, v86
    v_max_f32 v4, v4, v88
    v_max_f32 v4, v4, v90
    v_max_f32 v4, v4, v92
    v_max_f32 v4, v4, v94
    v_max_f32 v4, v4, v96
    v_max_f32 v4, v4, v98
    v_max_f32 v4, v4, v100
    v_max_f32 v4, v4, v102
    v_max_f32 v4, v4, v104
    v_max_f32 v4, v4, v106
    v_max_f32 v4, v4, v108
    v_max_f32 v4, v4, v110
    v_mov_b32 v5, 0
    v_mov_b32 v6, 0
    v_mov_b32 v7, 0
    v_sub_f32 v8, v80, v4
    v_mul_f32 v8, s21, v8
    v_exp_f32 v8, v8
    s_nop 0
    v_fmac_f32 v5, v8, v81
    v_fmac_f32 v6, v8, v120
    v_fmac_f32 v7, v8, v121
    v_sub_f32 v8, v82, v4
    v_mul_f32 v8, s21, v8
    v_exp_f32 v8, v8
    s_nop 0
    v_fmac_f32 v5, v8, v83
    v_fmac_f32 v6, v8, v122
    v_fmac_f32 v7, v8, v123
    v_sub_f32 v8, v84, v4
    v_mul_f32 v8, s21, v8
    v_exp_f32 v8, v8
    s_nop 0
    v_fmac_f32 v5, v8, v85
    v_fmac_f32 v6, v8, v124
    v_fmac_f32 v7, v8, v125
    v_sub_f32 v8, v86, v4
    v_mul_f32 v8, s21, v8
    v_exp_f32 v8, v8
    s_nop 0
    v_fmac_f32 v5, v8, v87
    v_fmac_f32 v6, v8, v126
    v_fmac_f32 v7, v8, v127
    v_sub_f32 v8, v88, v4
    v_mul_f32 v8, s21, v8
    v_exp_f32 v8, v8
    s_nop 0
    v_fmac_f32 v5, v8, v89
    v_fmac_f32 v6, v8, v128
    v_fmac_f32 v7, v8, v129
    v_sub_f32 v8, v90, v4
    v_mul_f32 v8, s21, v8
    v_exp_f32 v8, v8
    s_nop 0
    v_fmac_f32 v5, v8, v91
    v_fmac_f32 v6, v8, v130
    v_fmac_f32 v7, v8, v131
    v_sub_f32 v8, v92, v4
    v_mul_f32 v8, s21, v8
    v_exp_f32 v8, v8
    s_nop 0
    v_fmac_f32 v5, v8, v93
    v_fmac_f32 v6, v8, v132
    v_fmac_f32 v7, v8, v133
    v_sub_f32 v8, v94, v4
    v_mul_f32 v8, s21, v8
    v_exp_f32 v8, v8
    s_nop 0
    v_fmac_f32 v5, v8, v95
    v_fmac_f32 v6, v8, v134
    v_fmac_f32 v7, v8, v135
    v_sub_f32 v8, v96, v4
    v_mul_f32 v8, s21, v8
    v_exp_f32 v8, v8
    s_nop 0
    v_fmac_f32 v5, v8, v97
    v_fmac_f32 v6, v8, v136
    v_fmac_f32 v7, v8, v137
    v_sub_f32 v8, v98, v4
    v_mul_f32 v8, s21, v8
    v_exp_f32 v8, v8
    s_nop 0
    v_fmac_f32 v5, v8, v99
    v_fmac_f32 v6, v8, v138
    v_fmac_f32 v7, v8, v139
    v_sub_f32 v8, v100, v4
    v_mul_f32 v8, s21, v8
    v_exp_f32 v8, v8
    s_nop 0
    v_fmac_f32 v5, v8, v101
    v_fmac_f32 v6, v8, v140
    v_fmac_f32 v7, v8, v141
    v_sub_f32 v8, v102, v4
    v_mul_f32 v8, s21, v8
    v_exp_f32 v8, v8
    s_nop 0
    v_fmac_f32 v5, v8, v103
    v_fmac_f32 v6, v8, v142
    v_fmac_f32 v7, v8, v143
    v_sub_f32 v8, v104, v4
    v_mul_f32 v8, s21, v8
    v_exp_f32 v8, v8
    s_nop 0
    v_fmac_f32 v5, v8, v105
    v_fmac_f32 v6, v8, v144
    v_fmac_f32 v7, v8, v145
    v_sub_f32 v8, v106, v4
    v_mul_f32 v8, s21, v8
    v_exp_f32 v8, v8
    s_nop 0
    v_fmac_f32 v5, v8, v107
    v_fmac_f32 v6, v8, v146
    v_fmac_f32 v7, v8, v147
    v_sub_f32 v8, v108, v4
    v_mul_f32 v8, s21, v8
    v_exp_f32 v8, v8
    s_nop 0
    v_fmac_f32 v5, v8, v109
    v_fmac_f32 v6, v8, v148
    v_fmac_f32 v7, v8, v149
    v_sub_f32 v8, v110, v4
    v_mul_f32 v8, s21, v8
    v_exp_f32 v8, v8
    s_nop 0
    v_fmac_f32 v5, v8, v111
    v_fmac_f32 v6, v8, v150
    v_fmac_f32 v7, v8, v151
    s_lshl_b32 s20, s2, 11
    s_add_u32 s20, s20, 262144
    buffer_store_dwordx2 v[6:7], v3, s[12:15], s20 offen
    v_and_b32 v9, 63, v0
    v_cmp_eq_u32 vcc, 0, v9
    s_and_saveexec_b64 s[24:25], vcc
    s_lshr_b32 s20, s2, 5
    s_lshl_b32 s20, s20, 9
    s_and_b32 s22, s2, 31
    s_lshl_b32 s22, s22, 2
    s_add_u32 s20, s20, s22
    s_add_u32 s22, s20, 139264
    s_add_u32 s20, s20, 131072
    v_lshlrev_b32 v1, 7, v1
    buffer_store_dword v4, v1, s[12:15], s20 offen
    buffer_store_dword v5, v1, s[12:15], s22 offen
k2_attn_kernel_end:
    s_endpgm
.globl k3_wo_kernel
.p2align 8
.type k3_wo_kernel,@function
k3_wo_kernel:
    s_cmp_ge_u32 s2, 64
    s_cbranch_scc1 k3_wo_kernel_end
    s_load_dwordx2 s[8:9], s[0:1], 32
    s_load_dwordx2 s[12:13], s[0:1], 104
    s_waitcnt lgkmcnt(0)
    s_mov_b32 s10, 4194304
    s_mov_b32 s11, 0x00020000
    s_mov_b32 s14, 536870912
    s_mov_b32 s15, 0x00020000
    v_lshrrev_b32 v1, 6, v0
    v_lshlrev_b32 v1, 13, v1
    v_and_b32 v2, 63, v0
    v_lshl_add_u32 v1, v2, 4, v1
    s_lshl_b32 s20, s2, 16
    s_add_u32 s21, s20, 4096
    buffer_load_dwordx4 v[32:35], v1, s[8:11], s20 offen offset:0
    buffer_load_dwordx4 v[36:39], v1, s[8:11], s20 offen offset:1024
    buffer_load_dwordx4 v[40:43], v1, s[8:11], s20 offen offset:2048
    buffer_load_dwordx4 v[44:47], v1, s[8:11], s20 offen offset:3072
    buffer_load_dwordx4 v[48:51], v1, s[8:11], s21 offen offset:0
    buffer_load_dwordx4 v[52:55], v1, s[8:11], s21 offen offset:1024
    buffer_load_dwordx4 v[56:59], v1, s[8:11], s21 offen offset:2048
    buffer_load_dwordx4 v[60:63], v1, s[8:11], s21 offen offset:3072
    s_lshr_b32 s22, s2, 1
    s_lshr_b32 s23, s22, 2
    s_and_b32 s24, s22, 3
    s_lshl_b32 s25, s23, 9
    s_lshl_b32 s26, s24, 7
    s_add_u32 s25, s25, s26
    v_lshrrev_b32 v3, 8, v0
    v_lshlrev_b32 v4, 12, v3
    s_add_u32 s26, s25, 131072
    s_add_u32 s27, s25, 139264
    buffer_load_dwordx4 v[64:67], v4, s[12:15], s26 offen offset:0
    buffer_load_dwordx4 v[68:71], v4, s[12:15], s26 offen offset:16
    buffer_load_dwordx4 v[72:75], v4, s[12:15], s26 offen offset:32
    buffer_load_dwordx4 v[76:79], v4, s[12:15], s26 offen offset:48
    buffer_load_dwordx4 v[80:83], v4, s[12:15], s26 offen offset:64
    buffer_load_dwordx4 v[84:87], v4, s[12:15], s26 offen offset:80
    buffer_load_dwordx4 v[88:91], v4, s[12:15], s26 offen offset:96
    buffer_load_dwordx4 v[92:95], v4, s[12:15], s26 offen offset:112
    buffer_load_dwordx4 v[96:99], v4, s[12:15], s27 offen offset:0
    buffer_load_dwordx4 v[100:103], v4, s[12:15], s27 offen offset:16
    buffer_load_dwordx4 v[104:107], v4, s[12:15], s27 offen offset:32
    buffer_load_dwordx4 v[108:111], v4, s[12:15], s27 offen offset:48
    buffer_load_dwordx4 v[112:115], v4, s[12:15], s27 offen offset:64
    buffer_load_dwordx4 v[116:119], v4, s[12:15], s27 offen offset:80
    buffer_load_dwordx4 v[120:123], v4, s[12:15], s27 offen offset:96
    buffer_load_dwordx4 v[124:127], v4, s[12:15], s27 offen offset:112
    s_lshl_b32 s25, s23, 16
    s_lshl_b32 s26, s24, 9
    s_add_u32 s25, s25, s26
    s_and_b32 s26, s2, 1
    s_lshl_b32 s26, s26, 8
    s_add_u32 s25, s25, s26
    s_add_u32 s25, s25, 262144
    v_lshlrev_b32 v5, 19, v3
    v_bfe_u32 v6, v0, 6, 2
    v_lshl_add_u32 v5, v6, 14, v5
    v_lshl_add_u32 v5, v2, 2, v5
    s_add_u32 s26, s25, 0
    buffer_load_dword v128, v5, s[12:15], s26 offen
    s_add_u32 s26, s25, 2048
    buffer_load_dword v129, v5, s[12:15], s26 offen
    s_add_u32 s26, s25, 4096
    buffer_load_dword v130, v5, s[12:15], s26 offen
    s_add_u32 s26, s25, 6144
    buffer_load_dword v131, v5, s[12:15], s26 offen
    s_add_u32 s26, s25, 8192
    buffer_load_dword v132, v5, s[12:15], s26 offen
    s_add_u32 s26, s25, 10240
    buffer_load_dword v133, v5, s[12:15], s26 offen
    s_add_u32 s26, s25, 12288
    buffer_load_dword v134, v5, s[12:15], s26 offen
    s_add_u32 s26, s25, 14336
    buffer_load_dword v135, v5, s[12:15], s26 offen
    s_mov_b32 s28, 0x3e0293ee
    s_waitcnt vmcnt(8)
    v_max_f32 v7, v64, v65
    v_max_f32 v7, v7, v66
    v_max_f32 v7, v7, v67
    v_max_f32 v7, v7, v68
    v_max_f32 v7, v7, v69
    v_max_f32 v7, v7, v70
    v_max_f32 v7, v7, v71
    v_max_f32 v7, v7, v72
    v_max_f32 v7, v7, v73
    v_max_f32 v7, v7, v74
    v_max_f32 v7, v7, v75
    v_max_f32 v7, v7, v76
    v_max_f32 v7, v7, v77
    v_max_f32 v7, v7, v78
    v_max_f32 v7, v7, v79
    v_max_f32 v7, v7, v80
    v_max_f32 v7, v7, v81
    v_max_f32 v7, v7, v82
    v_max_f32 v7, v7, v83
    v_max_f32 v7, v7, v84
    v_max_f32 v7, v7, v85
    v_max_f32 v7, v7, v86
    v_max_f32 v7, v7, v87
    v_max_f32 v7, v7, v88
    v_max_f32 v7, v7, v89
    v_max_f32 v7, v7, v90
    v_max_f32 v7, v7, v91
    v_max_f32 v7, v7, v92
    v_max_f32 v7, v7, v93
    v_max_f32 v7, v7, v94
    v_max_f32 v7, v7, v95
    v_mov_b32 v8, 0
    v_sub_f32 v64, v64, v7
    v_mul_f32 v64, s28, v64
    v_exp_f32 v64, v64
    s_nop 0
    v_fmac_f32 v8, v64, v96
    v_sub_f32 v65, v65, v7
    v_mul_f32 v65, s28, v65
    v_exp_f32 v65, v65
    s_nop 0
    v_fmac_f32 v8, v65, v97
    v_sub_f32 v66, v66, v7
    v_mul_f32 v66, s28, v66
    v_exp_f32 v66, v66
    s_nop 0
    v_fmac_f32 v8, v66, v98
    v_sub_f32 v67, v67, v7
    v_mul_f32 v67, s28, v67
    v_exp_f32 v67, v67
    s_nop 0
    v_fmac_f32 v8, v67, v99
    v_sub_f32 v68, v68, v7
    v_mul_f32 v68, s28, v68
    v_exp_f32 v68, v68
    s_nop 0
    v_fmac_f32 v8, v68, v100
    v_sub_f32 v69, v69, v7
    v_mul_f32 v69, s28, v69
    v_exp_f32 v69, v69
    s_nop 0
    v_fmac_f32 v8, v69, v101
    v_sub_f32 v70, v70, v7
    v_mul_f32 v70, s28, v70
    v_exp_f32 v70, v70
    s_nop 0
    v_fmac_f32 v8, v70, v102
    v_sub_f32 v71, v71, v7
    v_mul_f32 v71, s28, v71
    v_exp_f32 v71, v71
    s_nop 0
    v_fmac_f32 v8, v71, v103
    v_sub_f32 v72, v72, v7
    v_mul_f32 v72, s28, v72
    v_exp_f32 v72, v72
    s_nop 0
    v_fmac_f32 v8, v72, v104
    v_sub_f32 v73, v73, v7
    v_mul_f32 v73, s28, v73
    v_exp_f32 v73, v73
    s_nop 0
    v_fmac_f32 v8, v73, v105
    v_sub_f32 v74, v74, v7
    v_mul_f32 v74, s28, v74
    v_exp_f32 v74, v74
    s_nop 0
    v_fmac_f32 v8, v74, v106
    v_sub_f32 v75, v75, v7
    v_mul_f32 v75, s28, v75
    v_exp_f32 v75, v75
    s_nop 0
    v_fmac_f32 v8, v75, v107
    v_sub_f32 v76, v76, v7
    v_mul_f32 v76, s28, v76
    v_exp_f32 v76, v76
    s_nop 0
    v_fmac_f32 v8, v76, v108
    v_sub_f32 v77, v77, v7
    v_mul_f32 v77, s28, v77
    v_exp_f32 v77, v77
    s_nop 0
    v_fmac_f32 v8, v77, v109
    v_sub_f32 v78, v78, v7
    v_mul_f32 v78, s28, v78
    v_exp_f32 v78, v78
    s_nop 0
    v_fmac_f32 v8, v78, v110
    v_sub_f32 v79, v79, v7
    v_mul_f32 v79, s28, v79
    v_exp_f32 v79, v79
    s_nop 0
    v_fmac_f32 v8, v79, v111
    v_sub_f32 v80, v80, v7
    v_mul_f32 v80, s28, v80
    v_exp_f32 v80, v80
    s_nop 0
    v_fmac_f32 v8, v80, v112
    v_sub_f32 v81, v81, v7
    v_mul_f32 v81, s28, v81
    v_exp_f32 v81, v81
    s_nop 0
    v_fmac_f32 v8, v81, v113
    v_sub_f32 v82, v82, v7
    v_mul_f32 v82, s28, v82
    v_exp_f32 v82, v82
    s_nop 0
    v_fmac_f32 v8, v82, v114
    v_sub_f32 v83, v83, v7
    v_mul_f32 v83, s28, v83
    v_exp_f32 v83, v83
    s_nop 0
    v_fmac_f32 v8, v83, v115
    v_sub_f32 v84, v84, v7
    v_mul_f32 v84, s28, v84
    v_exp_f32 v84, v84
    s_nop 0
    v_fmac_f32 v8, v84, v116
    v_sub_f32 v85, v85, v7
    v_mul_f32 v85, s28, v85
    v_exp_f32 v85, v85
    s_nop 0
    v_fmac_f32 v8, v85, v117
    v_sub_f32 v86, v86, v7
    v_mul_f32 v86, s28, v86
    v_exp_f32 v86, v86
    s_nop 0
    v_fmac_f32 v8, v86, v118
    v_sub_f32 v87, v87, v7
    v_mul_f32 v87, s28, v87
    v_exp_f32 v87, v87
    s_nop 0
    v_fmac_f32 v8, v87, v119
    v_sub_f32 v88, v88, v7
    v_mul_f32 v88, s28, v88
    v_exp_f32 v88, v88
    s_nop 0
    v_fmac_f32 v8, v88, v120
    v_sub_f32 v89, v89, v7
    v_mul_f32 v89, s28, v89
    v_exp_f32 v89, v89
    s_nop 0
    v_fmac_f32 v8, v89, v121
    v_sub_f32 v90, v90, v7
    v_mul_f32 v90, s28, v90
    v_exp_f32 v90, v90
    s_nop 0
    v_fmac_f32 v8, v90, v122
    v_sub_f32 v91, v91, v7
    v_mul_f32 v91, s28, v91
    v_exp_f32 v91, v91
    s_nop 0
    v_fmac_f32 v8, v91, v123
    v_sub_f32 v92, v92, v7
    v_mul_f32 v92, s28, v92
    v_exp_f32 v92, v92
    s_nop 0
    v_fmac_f32 v8, v92, v124
    v_sub_f32 v93, v93, v7
    v_mul_f32 v93, s28, v93
    v_exp_f32 v93, v93
    s_nop 0
    v_fmac_f32 v8, v93, v125
    v_sub_f32 v94, v94, v7
    v_mul_f32 v94, s28, v94
    v_exp_f32 v94, v94
    s_nop 0
    v_fmac_f32 v8, v94, v126
    v_sub_f32 v95, v95, v7
    v_mul_f32 v95, s28, v95
    v_exp_f32 v95, v95
    s_nop 0
    v_fmac_f32 v8, v95, v127
    v_mov_b32 v136, v64
    v_mov_b32 v137, v65
    v_mov_b32 v138, v66
    v_mov_b32 v139, v67
    v_mov_b32 v140, v68
    v_mov_b32 v141, v69
    v_mov_b32 v142, v70
    v_mov_b32 v143, v71
    v_cmp_eq_u32 vcc, 1, v6
    s_nop 1
    v_cndmask_b32 v136, v136, v72, vcc
    v_cndmask_b32 v137, v137, v73, vcc
    v_cndmask_b32 v138, v138, v74, vcc
    v_cndmask_b32 v139, v139, v75, vcc
    v_cndmask_b32 v140, v140, v76, vcc
    v_cndmask_b32 v141, v141, v77, vcc
    v_cndmask_b32 v142, v142, v78, vcc
    v_cndmask_b32 v143, v143, v79, vcc
    v_cmp_eq_u32 vcc, 2, v6
    s_nop 1
    v_cndmask_b32 v136, v136, v80, vcc
    v_cndmask_b32 v137, v137, v81, vcc
    v_cndmask_b32 v138, v138, v82, vcc
    v_cndmask_b32 v139, v139, v83, vcc
    v_cndmask_b32 v140, v140, v84, vcc
    v_cndmask_b32 v141, v141, v85, vcc
    v_cndmask_b32 v142, v142, v86, vcc
    v_cndmask_b32 v143, v143, v87, vcc
    v_cmp_eq_u32 vcc, 3, v6
    s_nop 1
    v_cndmask_b32 v136, v136, v88, vcc
    v_cndmask_b32 v137, v137, v89, vcc
    v_cndmask_b32 v138, v138, v90, vcc
    v_cndmask_b32 v139, v139, v91, vcc
    v_cndmask_b32 v140, v140, v92, vcc
    v_cndmask_b32 v141, v141, v93, vcc
    v_cndmask_b32 v142, v142, v94, vcc
    v_cndmask_b32 v143, v143, v95, vcc
    s_waitcnt vmcnt(0)
    v_mul_f32 v9, v136, v128
    v_fmac_f32 v9, v137, v129
    v_fmac_f32 v9, v138, v130
    v_fmac_f32 v9, v139, v131
    v_fmac_f32 v9, v140, v132
    v_fmac_f32 v9, v141, v133
    v_fmac_f32 v9, v142, v134
    v_fmac_f32 v9, v143, v135
    v_lshlrev_b32 v10, 2, v0
    ds_write_b32 v10, v9
    s_waitcnt lgkmcnt(0)
    s_barrier
    v_lshlrev_b32 v10, 10, v3
    v_lshl_add_u32 v10, v2, 2, v10
    ds_read_b32 v11, v10 offset:0
    ds_read_b32 v12, v10 offset:256
    ds_read_b32 v13, v10 offset:512
    ds_read_b32 v14, v10 offset:768
    v_rcp_f32 v8, v8
    s_waitcnt lgkmcnt(0)
    v_add_f32 v11, v11, v12
    v_add_f32 v13, v13, v14
    v_add_f32 v11, v11, v13
    v_mul_f32 v11, v11, v8
    v_cvt_pk_bf16_f32 v11, v11, v11
    v_lshlrev_b32 v11, 16, v11
    v_lshlrev_b32 v10, 8, v3
    v_lshl_add_u32 v10, v2, 2, v10
    ds_write_b32 v10, v11 offset:2048
    s_waitcnt lgkmcnt(0)
    s_barrier
    v_lshrrev_b32 v10, 6, v0
    v_lshlrev_b32 v10, 5, v10
    ds_read_b32 v144, v10 offset:2048
    ds_read_b32 v145, v10 offset:2052
    ds_read_b32 v146, v10 offset:2056
    ds_read_b32 v147, v10 offset:2060
    ds_read_b32 v148, v10 offset:2064
    ds_read_b32 v149, v10 offset:2068
    ds_read_b32 v150, v10 offset:2072
    ds_read_b32 v151, v10 offset:2076
    ds_read_b32 v152, v10 offset:2304
    ds_read_b32 v153, v10 offset:2308
    ds_read_b32 v154, v10 offset:2312
    ds_read_b32 v155, v10 offset:2316
    ds_read_b32 v156, v10 offset:2320
    ds_read_b32 v157, v10 offset:2324
    ds_read_b32 v158, v10 offset:2328
    ds_read_b32 v159, v10 offset:2332
    v_mov_b32 v160, 0
    v_mov_b32 v161, 0
    v_mov_b32 v162, 0
    v_mov_b32 v163, 0
    v_mov_b32 v164, 0
    v_mov_b32 v165, 0
    v_mov_b32 v166, 0
    v_mov_b32 v167, 0
    v_mov_b32 v168, 0
    v_mov_b32 v169, 0
    v_mov_b32 v170, 0
    v_mov_b32 v171, 0
    v_mov_b32 v172, 0
    v_mov_b32 v173, 0
    v_mov_b32 v174, 0
    v_mov_b32 v175, 0
    s_waitcnt lgkmcnt(0)
    v_lshlrev_b32 v12, 16, v32
    v_and_b32 v13, 0xffff0000, v32
    v_fmac_f32 v160, v12, v144
    v_fmac_f32 v161, v13, v144
    v_fmac_f32 v168, v12, v152
    v_fmac_f32 v169, v13, v152
    v_lshlrev_b32 v12, 16, v33
    v_and_b32 v13, 0xffff0000, v33
    v_fmac_f32 v162, v12, v144
    v_fmac_f32 v163, v13, v144
    v_fmac_f32 v170, v12, v152
    v_fmac_f32 v171, v13, v152
    v_lshlrev_b32 v12, 16, v34
    v_and_b32 v13, 0xffff0000, v34
    v_fmac_f32 v164, v12, v144
    v_fmac_f32 v165, v13, v144
    v_fmac_f32 v172, v12, v152
    v_fmac_f32 v173, v13, v152
    v_lshlrev_b32 v12, 16, v35
    v_and_b32 v13, 0xffff0000, v35
    v_fmac_f32 v166, v12, v144
    v_fmac_f32 v167, v13, v144
    v_fmac_f32 v174, v12, v152
    v_fmac_f32 v175, v13, v152
    v_lshlrev_b32 v12, 16, v36
    v_and_b32 v13, 0xffff0000, v36
    v_fmac_f32 v160, v12, v145
    v_fmac_f32 v161, v13, v145
    v_fmac_f32 v168, v12, v153
    v_fmac_f32 v169, v13, v153
    v_lshlrev_b32 v12, 16, v37
    v_and_b32 v13, 0xffff0000, v37
    v_fmac_f32 v162, v12, v145
    v_fmac_f32 v163, v13, v145
    v_fmac_f32 v170, v12, v153
    v_fmac_f32 v171, v13, v153
    v_lshlrev_b32 v12, 16, v38
    v_and_b32 v13, 0xffff0000, v38
    v_fmac_f32 v164, v12, v145
    v_fmac_f32 v165, v13, v145
    v_fmac_f32 v172, v12, v153
    v_fmac_f32 v173, v13, v153
    v_lshlrev_b32 v12, 16, v39
    v_and_b32 v13, 0xffff0000, v39
    v_fmac_f32 v166, v12, v145
    v_fmac_f32 v167, v13, v145
    v_fmac_f32 v174, v12, v153
    v_fmac_f32 v175, v13, v153
    v_lshlrev_b32 v12, 16, v40
    v_and_b32 v13, 0xffff0000, v40
    v_fmac_f32 v160, v12, v146
    v_fmac_f32 v161, v13, v146
    v_fmac_f32 v168, v12, v154
    v_fmac_f32 v169, v13, v154
    v_lshlrev_b32 v12, 16, v41
    v_and_b32 v13, 0xffff0000, v41
    v_fmac_f32 v162, v12, v146
    v_fmac_f32 v163, v13, v146
    v_fmac_f32 v170, v12, v154
    v_fmac_f32 v171, v13, v154
    v_lshlrev_b32 v12, 16, v42
    v_and_b32 v13, 0xffff0000, v42
    v_fmac_f32 v164, v12, v146
    v_fmac_f32 v165, v13, v146
    v_fmac_f32 v172, v12, v154
    v_fmac_f32 v173, v13, v154
    v_lshlrev_b32 v12, 16, v43
    v_and_b32 v13, 0xffff0000, v43
    v_fmac_f32 v166, v12, v146
    v_fmac_f32 v167, v13, v146
    v_fmac_f32 v174, v12, v154
    v_fmac_f32 v175, v13, v154
    v_lshlrev_b32 v12, 16, v44
    v_and_b32 v13, 0xffff0000, v44
    v_fmac_f32 v160, v12, v147
    v_fmac_f32 v161, v13, v147
    v_fmac_f32 v168, v12, v155
    v_fmac_f32 v169, v13, v155
    v_lshlrev_b32 v12, 16, v45
    v_and_b32 v13, 0xffff0000, v45
    v_fmac_f32 v162, v12, v147
    v_fmac_f32 v163, v13, v147
    v_fmac_f32 v170, v12, v155
    v_fmac_f32 v171, v13, v155
    v_lshlrev_b32 v12, 16, v46
    v_and_b32 v13, 0xffff0000, v46
    v_fmac_f32 v164, v12, v147
    v_fmac_f32 v165, v13, v147
    v_fmac_f32 v172, v12, v155
    v_fmac_f32 v173, v13, v155
    v_lshlrev_b32 v12, 16, v47
    v_and_b32 v13, 0xffff0000, v47
    v_fmac_f32 v166, v12, v147
    v_fmac_f32 v167, v13, v147
    v_fmac_f32 v174, v12, v155
    v_fmac_f32 v175, v13, v155
    v_lshlrev_b32 v12, 16, v48
    v_and_b32 v13, 0xffff0000, v48
    v_fmac_f32 v160, v12, v148
    v_fmac_f32 v161, v13, v148
    v_fmac_f32 v168, v12, v156
    v_fmac_f32 v169, v13, v156
    v_lshlrev_b32 v12, 16, v49
    v_and_b32 v13, 0xffff0000, v49
    v_fmac_f32 v162, v12, v148
    v_fmac_f32 v163, v13, v148
    v_fmac_f32 v170, v12, v156
    v_fmac_f32 v171, v13, v156
    v_lshlrev_b32 v12, 16, v50
    v_and_b32 v13, 0xffff0000, v50
    v_fmac_f32 v164, v12, v148
    v_fmac_f32 v165, v13, v148
    v_fmac_f32 v172, v12, v156
    v_fmac_f32 v173, v13, v156
    v_lshlrev_b32 v12, 16, v51
    v_and_b32 v13, 0xffff0000, v51
    v_fmac_f32 v166, v12, v148
    v_fmac_f32 v167, v13, v148
    v_fmac_f32 v174, v12, v156
    v_fmac_f32 v175, v13, v156
    v_lshlrev_b32 v12, 16, v52
    v_and_b32 v13, 0xffff0000, v52
    v_fmac_f32 v160, v12, v149
    v_fmac_f32 v161, v13, v149
    v_fmac_f32 v168, v12, v157
    v_fmac_f32 v169, v13, v157
    v_lshlrev_b32 v12, 16, v53
    v_and_b32 v13, 0xffff0000, v53
    v_fmac_f32 v162, v12, v149
    v_fmac_f32 v163, v13, v149
    v_fmac_f32 v170, v12, v157
    v_fmac_f32 v171, v13, v157
    v_lshlrev_b32 v12, 16, v54
    v_and_b32 v13, 0xffff0000, v54
    v_fmac_f32 v164, v12, v149
    v_fmac_f32 v165, v13, v149
    v_fmac_f32 v172, v12, v157
    v_fmac_f32 v173, v13, v157
    v_lshlrev_b32 v12, 16, v55
    v_and_b32 v13, 0xffff0000, v55
    v_fmac_f32 v166, v12, v149
    v_fmac_f32 v167, v13, v149
    v_fmac_f32 v174, v12, v157
    v_fmac_f32 v175, v13, v157
    v_lshlrev_b32 v12, 16, v56
    v_and_b32 v13, 0xffff0000, v56
    v_fmac_f32 v160, v12, v150
    v_fmac_f32 v161, v13, v150
    v_fmac_f32 v168, v12, v158
    v_fmac_f32 v169, v13, v158
    v_lshlrev_b32 v12, 16, v57
    v_and_b32 v13, 0xffff0000, v57
    v_fmac_f32 v162, v12, v150
    v_fmac_f32 v163, v13, v150
    v_fmac_f32 v170, v12, v158
    v_fmac_f32 v171, v13, v158
    v_lshlrev_b32 v12, 16, v58
    v_and_b32 v13, 0xffff0000, v58
    v_fmac_f32 v164, v12, v150
    v_fmac_f32 v165, v13, v150
    v_fmac_f32 v172, v12, v158
    v_fmac_f32 v173, v13, v158
    v_lshlrev_b32 v12, 16, v59
    v_and_b32 v13, 0xffff0000, v59
    v_fmac_f32 v166, v12, v150
    v_fmac_f32 v167, v13, v150
    v_fmac_f32 v174, v12, v158
    v_fmac_f32 v175, v13, v158
    v_lshlrev_b32 v12, 16, v60
    v_and_b32 v13, 0xffff0000, v60
    v_fmac_f32 v160, v12, v151
    v_fmac_f32 v161, v13, v151
    v_fmac_f32 v168, v12, v159
    v_fmac_f32 v169, v13, v159
    v_lshlrev_b32 v12, 16, v61
    v_and_b32 v13, 0xffff0000, v61
    v_fmac_f32 v162, v12, v151
    v_fmac_f32 v163, v13, v151
    v_fmac_f32 v170, v12, v159
    v_fmac_f32 v171, v13, v159
    v_lshlrev_b32 v12, 16, v62
    v_and_b32 v13, 0xffff0000, v62
    v_fmac_f32 v164, v12, v151
    v_fmac_f32 v165, v13, v151
    v_fmac_f32 v172, v12, v159
    v_fmac_f32 v173, v13, v159
    v_lshlrev_b32 v12, 16, v63
    v_and_b32 v13, 0xffff0000, v63
    v_fmac_f32 v166, v12, v151
    v_fmac_f32 v167, v13, v151
    v_fmac_f32 v174, v12, v159
    v_fmac_f32 v175, v13, v159
    v_lshrrev_b32 v10, 6, v0
    v_lshlrev_b32 v10, 12, v10
    v_lshl_add_u32 v10, v2, 5, v10
    ds_write_b128 v10, v[160:163] offset:4096
    ds_write_b128 v10, v[164:167] offset:4112
    ds_write_b128 v10, v[168:171] offset:6144
    ds_write_b128 v10, v[172:175] offset:6160
    s_waitcnt lgkmcnt(0)
    s_barrier
    v_lshlrev_b32 v10, 2, v0
    ds_read_b32 v32, v10 offset:4096
    ds_read_b32 v33, v10 offset:8192
    ds_read_b32 v34, v10 offset:12288
    ds_read_b32 v35, v10 offset:16384
    ds_read_b32 v36, v10 offset:20480
    ds_read_b32 v37, v10 offset:24576
    ds_read_b32 v38, v10 offset:28672
    ds_read_b32 v39, v10 offset:32768
    ds_read_b32 v40, v10 offset:6144
    ds_read_b32 v41, v10 offset:10240
    ds_read_b32 v42, v10 offset:14336
    ds_read_b32 v43, v10 offset:18432
    ds_read_b32 v44, v10 offset:22528
    ds_read_b32 v45, v10 offset:26624
    ds_read_b32 v46, v10 offset:30720
    ds_read_b32 v47, v10 offset:34816
    s_waitcnt lgkmcnt(0)
    v_add_f32 v32, v32, v33
    v_add_f32 v32, v32, v34
    v_add_f32 v32, v32, v35
    v_add_f32 v32, v32, v36
    v_add_f32 v32, v32, v37
    v_add_f32 v32, v32, v38
    v_add_f32 v32, v32, v39
    v_add_f32 v40, v40, v41
    v_add_f32 v40, v40, v42
    v_add_f32 v40, v40, v43
    v_add_f32 v40, v40, v44
    v_add_f32 v40, v40, v45
    v_add_f32 v40, v40, v46
    v_add_f32 v40, v40, v47
    s_mov_b32 s20, 65536
    s_mov_b32 s21, 67584
    buffer_atomic_add_f32 v32, v10, s[12:15], s20 offen
    buffer_atomic_add_f32 v40, v10, s[12:15], s21 offen
k3_wo_kernel_end:
    s_endpgm
.globl k4_gu_kernel
.p2align 8
.type k4_gu_kernel,@function
k4_gu_kernel:
    s_cmp_ge_u32 s2, 112
    s_cbranch_scc1 k4_gu_kernel_end
    s_load_dwordx2 s[4:5], s[0:1], 0
    s_load_dwordx2 s[8:9], s[0:1], 48
    s_load_dwordx2 s[16:17], s[0:1], 56
    s_load_dwordx2 s[12:13], s[0:1], 104
    s_waitcnt lgkmcnt(0)
    s_mov_b32 s6, 2048
    s_mov_b32 s7, 0x00020000
    s_mov_b32 s10, 1835008
    s_mov_b32 s11, 0x00020000
    s_mov_b32 s18, 1835008
    s_mov_b32 s19, 0x00020000
    s_mov_b32 s14, 536870912
    s_mov_b32 s15, 0x00020000
    s_mul_i32 s20, s2, 9363
    s_lshr_b32 s20, s20, 16
    s_mul_i32 s21, s20, 7
    s_sub_u32 s21, s2, s21
    s_lshl_b32 s22, s20, 5
    v_lshrrev_b32 v1, 5, v0
    v_add_u32 v1, s22, v1
    s_movk_i32 s23, 3584
    v_mul_lo_u32 v1, v1, s23
    v_and_b32 v2, 31, v0
    v_lshl_add_u32 v1, v2, 4, v1
    s_lshl_b32 s23, s21, 9
    v_add_u32 v1, s23, v1
    s_mov_b32 s24, 0
    buffer_load_dwordx4 v[32:35], v1, s[8:11], s24 offen
    buffer_load_dwordx4 v[48:51], v1, s[16:19], s24 offen
    s_mov_b32 s24, 28672
    buffer_load_dwordx4 v[36:39], v1, s[8:11], s24 offen
    buffer_load_dwordx4 v[52:55], v1, s[16:19], s24 offen
    s_mov_b32 s24, 57344
    buffer_load_dwordx4 v[40:43], v1, s[8:11], s24 offen
    buffer_load_dwordx4 v[56:59], v1, s[16:19], s24 offen
    s_mov_b32 s24, 86016
    buffer_load_dwordx4 v[44:47], v1, s[8:11], s24 offen
    buffer_load_dwordx4 v[60:63], v1, s[16:19], s24 offen
    v_lshlrev_b32 v2, 3, v0
    buffer_load_dwordx2 v[4:5], v2, s[4:7], 0 offen
    v_lshlrev_b32 v2, 4, v0
    s_mov_b32 s24, 65536
    buffer_load_dwordx4 v[24:27], v2, s[12:15], s24 offen
    v_lshrrev_b32 v3, 7, v0
    v_mul_u32_u24 v3, 12288, v3
    v_and_b32 v6, 127, v0
    v_lshl_add_u32 v3, v6, 4, v3
    s_mov_b32 s25, 4096
    buffer_load_dwordx4 v[28:31], v3, s[12:15], s25 offen
    s_waitcnt vmcnt(0)
    v_and_b32 v9, 0xffff0000, v4
    v_lshlrev_b32 v8, 16, v4
    v_and_b32 v11, 0xffff0000, v5
    v_lshlrev_b32 v10, 16, v5
    v_cvt_pk_bf16_f32 v24, v24, v24
    v_lshlrev_b32 v24, 16, v24
    v_mul_f32 v24, v24, v28
    v_cvt_pk_bf16_f32 v24, v24, v24
    v_lshlrev_b32 v24, 16, v24
    v_add_f32 v8, v8, v24
    v_cvt_pk_bf16_f32 v8, v8, v8
    v_lshlrev_b32 v8, 16, v8
    v_cvt_pk_bf16_f32 v25, v25, v25
    v_lshlrev_b32 v25, 16, v25
    v_mul_f32 v25, v25, v29
    v_cvt_pk_bf16_f32 v25, v25, v25
    v_lshlrev_b32 v25, 16, v25
    v_add_f32 v9, v9, v25
    v_cvt_pk_bf16_f32 v9, v9, v9
    v_lshlrev_b32 v9, 16, v9
    v_cvt_pk_bf16_f32 v26, v26, v26
    v_lshlrev_b32 v26, 16, v26
    v_mul_f32 v26, v26, v30
    v_cvt_pk_bf16_f32 v26, v26, v26
    v_lshlrev_b32 v26, 16, v26
    v_add_f32 v10, v10, v26
    v_cvt_pk_bf16_f32 v10, v10, v10
    v_lshlrev_b32 v10, 16, v10
    v_cvt_pk_bf16_f32 v27, v27, v27
    v_lshlrev_b32 v27, 16, v27
    v_mul_f32 v27, v27, v31
    v_cvt_pk_bf16_f32 v27, v27, v27
    v_lshlrev_b32 v27, 16, v27
    v_add_f32 v11, v11, v27
    v_cvt_pk_bf16_f32 v11, v11, v11
    v_lshlrev_b32 v11, 16, v11
    s_cmp_lg_u32 s2, 0
    s_cbranch_scc1 k4_gu_kernel_nox1
    s_mov_b32 s24, 49152
    buffer_store_dwordx4 v[8:11], v2, s[12:15], s24 offen
k4_gu_kernel_nox1:
    v_lshrrev_b32 v12, 7, v0
    v_mul_u32_u24 v12, 12288, v12
    v_and_b32 v13, 127, v0
    v_lshl_add_u32 v12, v13, 4, v12
    s_mov_b32 s42, 6144
    s_mov_b32 s43, 8192
    buffer_load_dwordx4 v[16:19], v12, s[12:15], s42 offen
    buffer_load_dwordx4 v[20:23], v12, s[12:15], s43 offen
    v_add_f32 v12, v8, v9
    v_add_f32 v13, v10, v11
    v_add_f32 v12, v12, v13
    s_nop 1
    v_add_f32_dpp v12, v12, v12 quad_perm:[1,0,3,2] row_mask:0xf bank_mask:0xf
    s_nop 1
    v_add_f32_dpp v12, v12, v12 quad_perm:[2,3,0,1] row_mask:0xf bank_mask:0xf
    s_nop 1
    v_add_f32_dpp v12, v12, v12 row_half_mirror row_mask:0xf bank_mask:0xf
    s_nop 1
    v_add_f32_dpp v12, v12, v12 row_mirror row_mask:0xf bank_mask:0xf
    s_nop 1
    v_add_f32_dpp v12, v12, v12 row_bcast:15 row_mask:0xa bank_mask:0xf
    s_nop 1
    v_add_f32_dpp v12, v12, v12 row_bcast:31 row_mask:0xc bank_mask:0xf
    s_nop 1
    v_readlane_b32 s40, v12, 63
    v_lshrrev_b32 v13, 6, v0
    v_lshlrev_b32 v13, 2, v13
    v_mov_b32 v12, s40
    ds_write_b32 v13, v12 offset:40960
    s_waitcnt lgkmcnt(0)
    s_barrier
    v_lshrrev_b32 v13, 7, v0
    v_lshlrev_b32 v13, 3, v13
    ds_read_b64 v[14:15], v13 offset:40960
    s_waitcnt lgkmcnt(0)
    v_add_f32 v14, v14, v15
    v_mul_f32 v14, 0x3b000000, v14
    v_sub_f32 v15, v8, v14
    v_mul_f32 v12, v15, v15
    v_sub_f32 v15, v9, v14
    v_fmac_f32 v12, v15, v15
    v_sub_f32 v15, v10, v14
    v_fmac_f32 v12, v15, v15
    v_sub_f32 v15, v11, v14
    v_fmac_f32 v12, v15, v15
    s_nop 1
    v_add_f32_dpp v12, v12, v12 quad_perm:[1,0,3,2] row_mask:0xf bank_mask:0xf
    s_nop 1
    v_add_f32_dpp v12, v12, v12 quad_perm:[2,3,0,1] row_mask:0xf bank_mask:0xf
    s_nop 1
    v_add_f32_dpp v12, v12, v12 row_half_mirror row_mask:0xf bank_mask:0xf
    s_nop 1
    v_add_f32_dpp v12, v12, v12 row_mirror row_mask:0xf bank_mask:0xf
    s_nop 1
    v_add_f32_dpp v12, v12, v12 row_bcast:15 row_mask:0xa bank_mask:0xf
    s_nop 1
    v_add_f32_dpp v12, v12, v12 row_bcast:31 row_mask:0xc bank_mask:0xf
    s_nop 1
    v_readlane_b32 s41, v12, 63
    v_lshrrev_b32 v13, 6, v0
    v_lshlrev_b32 v13, 2, v13
    v_mov_b32 v12, s41
    ds_write_b32 v13, v12 offset:40976
    s_waitcnt lgkmcnt(0)
    s_barrier
    v_lshrrev_b32 v13, 7, v0
    v_lshlrev_b32 v13, 3, v13
    ds_read_b64 v[12:13], v13 offset:40976
    s_waitcnt lgkmcnt(0)
    v_add_f32 v12, v12, v13
    v_mul_f32 v12, 0x3b000000, v12
    v_cvt_pk_bf16_f32 v12, v12, v12
    v_lshlrev_b32 v12, 16, v12
    v_cvt_pk_bf16_f32 v14, v14, v14
    v_lshlrev_b32 v14, 16, v14
    v_add_f32 v12, 0x3727c5ac, v12
    v_cvt_pk_bf16_f32 v12, v12, v12
    v_lshlrev_b32 v12, 16, v12
    v_sqrt_f32 v12, v12
    s_nop 0
    v_cvt_pk_bf16_f32 v12, v12, v12
    v_lshlrev_b32 v12, 16, v12
    v_rcp_f32 v12, v12
    s_waitcnt vmcnt(0)
    v_sub_f32 v8, v8, v14
    v_cvt_pk_bf16_f32 v8, v8, v8
    v_lshlrev_b32 v8, 16, v8
    v_mul_f32 v8, v8, v12
    v_cvt_pk_bf16_f32 v8, v8, v8
    v_lshlrev_b32 v8, 16, v8
    v_add_f32 v20, 1.0, v20
    v_cvt_pk_bf16_f32 v20, v20, v20
    v_lshlrev_b32 v20, 16, v20
    v_mul_f32 v8, v8, v20
    v_cvt_pk_bf16_f32 v8, v8, v8
    v_lshlrev_b32 v8, 16, v8
    v_add_f32 v8, v8, v16
    v_cvt_pk_bf16_f32 v8, v8, v8
    v_lshlrev_b32 v8, 16, v8
    v_sub_f32 v9, v9, v14
    v_cvt_pk_bf16_f32 v9, v9, v9
    v_lshlrev_b32 v9, 16, v9
    v_mul_f32 v9, v9, v12
    v_cvt_pk_bf16_f32 v9, v9, v9
    v_lshlrev_b32 v9, 16, v9
    v_add_f32 v21, 1.0, v21
    v_cvt_pk_bf16_f32 v21, v21, v21
    v_lshlrev_b32 v21, 16, v21
    v_mul_f32 v9, v9, v21
    v_cvt_pk_bf16_f32 v9, v9, v9
    v_lshlrev_b32 v9, 16, v9
    v_add_f32 v9, v9, v17
    v_cvt_pk_bf16_f32 v9, v9, v9
    v_lshlrev_b32 v9, 16, v9
    v_sub_f32 v10, v10, v14
    v_cvt_pk_bf16_f32 v10, v10, v10
    v_lshlrev_b32 v10, 16, v10
    v_mul_f32 v10, v10, v12
    v_cvt_pk_bf16_f32 v10, v10, v10
    v_lshlrev_b32 v10, 16, v10
    v_add_f32 v22, 1.0, v22
    v_cvt_pk_bf16_f32 v22, v22, v22
    v_lshlrev_b32 v22, 16, v22
    v_mul_f32 v10, v10, v22
    v_cvt_pk_bf16_f32 v10, v10, v10
    v_lshlrev_b32 v10, 16, v10
    v_add_f32 v10, v10, v18
    v_cvt_pk_bf16_f32 v10, v10, v10
    v_lshlrev_b32 v10, 16, v10
    v_sub_f32 v11, v11, v14
    v_cvt_pk_bf16_f32 v11, v11, v11
    v_lshlrev_b32 v11, 16, v11
    v_mul_f32 v11, v11, v12
    v_cvt_pk_bf16_f32 v11, v11, v11
    v_lshlrev_b32 v11, 16, v11
    v_add_f32 v23, 1.0, v23
    v_cvt_pk_bf16_f32 v23, v23, v23
    v_lshlrev_b32 v23, 16, v23
    v_mul_f32 v11, v11, v23
    v_cvt_pk_bf16_f32 v11, v11, v11
    v_lshlrev_b32 v11, 16, v11
    v_add_f32 v11, v11, v19
    v_cvt_pk_bf16_f32 v11, v11, v11
    v_lshlrev_b32 v11, 16, v11
    v_lshlrev_b32 v2, 4, v0
    ds_write_b128 v2, v[8:11]
    s_waitcnt lgkmcnt(0)
    s_barrier
    v_lshrrev_b32 v2, 5, v0
    v_add_lshl_u32 v2, s22, v2, 2
    ds_read_b32 v80, v2 offset:0
    ds_read_b32 v81, v2 offset:32
    ds_read_b32 v82, v2 offset:64
    ds_read_b32 v83, v2 offset:96
    ds_read_b32 v84, v2 offset:2048
    ds_read_b32 v85, v2 offset:2080
    ds_read_b32 v86, v2 offset:2112
    ds_read_b32 v87, v2 offset:2144
    v_mov_b32 v96, 0
    v_mov_b32 v97, 0
    v_mov_b32 v98, 0
    v_mov_b32 v99, 0
    v_mov_b32 v100, 0
    v_mov_b32 v101, 0
    v_mov_b32 v102, 0
    v_mov_b32 v103, 0
    v_mov_b32 v104, 0
    v_mov_b32 v105, 0
    v_mov_b32 v106, 0
    v_mov_b32 v107, 0
    v_mov_b32 v108, 0
    v_mov_b32 v109, 0
    v_mov_b32 v110, 0
    v_mov_b32 v111, 0
    v_mov_b32 v112, 0
    v_mov_b32 v113, 0
    v_mov_b32 v114, 0
    v_mov_b32 v115, 0
    v_mov_b32 v116, 0
    v_mov_b32 v117, 0
    v_mov_b32 v118, 0
    v_mov_b32 v119, 0
    v_mov_b32 v120, 0
    v_mov_b32 v121, 0
    v_mov_b32 v122, 0
    v_mov_b32 v123, 0
    v_mov_b32 v124, 0
    v_mov_b32 v125, 0
    v_mov_b32 v126, 0
    v_mov_b32 v127, 0
    s_waitcnt lgkmcnt(0)
    v_lshlrev_b32 v12, 16, v32
    v_and_b32 v13, 0xffff0000, v32
    v_fmac_f32 v96, v12, v80
    v_fmac_f32 v97, v13, v80
    v_fmac_f32 v104, v12, v84
    v_fmac_f32 v105, v13, v84
    v_lshlrev_b32 v12, 16, v33
    v_and_b32 v13, 0xffff0000, v33
    v_fmac_f32 v98, v12, v80
    v_fmac_f32 v99, v13, v80
    v_fmac_f32 v106, v12, v84
    v_fmac_f32 v107, v13, v84
    v_lshlrev_b32 v12, 16, v34
    v_and_b32 v13, 0xffff0000, v34
    v_fmac_f32 v100, v12, v80
    v_fmac_f32 v101, v13, v80
    v_fmac_f32 v108, v12, v84
    v_fmac_f32 v109, v13, v84
    v_lshlrev_b32 v12, 16, v35
    v_and_b32 v13, 0xffff0000, v35
    v_fmac_f32 v102, v12, v80
    v_fmac_f32 v103, v13, v80
    v_fmac_f32 v110, v12, v84
    v_fmac_f32 v111, v13, v84
    v_lshlrev_b32 v12, 16, v36
    v_and_b32 v13, 0xffff0000, v36
    v_fmac_f32 v96, v12, v81
    v_fmac_f32 v97, v13, v81
    v_fmac_f32 v104, v12, v85
    v_fmac_f32 v105, v13, v85
    v_lshlrev_b32 v12, 16, v37
    v_and_b32 v13, 0xffff0000, v37
    v_fmac_f32 v98, v12, v81
    v_fmac_f32 v99, v13, v81
    v_fmac_f32 v106, v12, v85
    v_fmac_f32 v107, v13, v85
    v_lshlrev_b32 v12, 16, v38
    v_and_b32 v13, 0xffff0000, v38
    v_fmac_f32 v100, v12, v81
    v_fmac_f32 v101, v13, v81
    v_fmac_f32 v108, v12, v85
    v_fmac_f32 v109, v13, v85
    v_lshlrev_b32 v12, 16, v39
    v_and_b32 v13, 0xffff0000, v39
    v_fmac_f32 v102, v12, v81
    v_fmac_f32 v103, v13, v81
    v_fmac_f32 v110, v12, v85
    v_fmac_f32 v111, v13, v85
    v_lshlrev_b32 v12, 16, v40
    v_and_b32 v13, 0xffff0000, v40
    v_fmac_f32 v96, v12, v82
    v_fmac_f32 v97, v13, v82
    v_fmac_f32 v104, v12, v86
    v_fmac_f32 v105, v13, v86
    v_lshlrev_b32 v12, 16, v41
    v_and_b32 v13, 0xffff0000, v41
    v_fmac_f32 v98, v12, v82
    v_fmac_f32 v99, v13, v82
    v_fmac_f32 v106, v12, v86
    v_fmac_f32 v107, v13, v86
    v_lshlrev_b32 v12, 16, v42
    v_and_b32 v13, 0xffff0000, v42
    v_fmac_f32 v100, v12, v82
    v_fmac_f32 v101, v13, v82
    v_fmac_f32 v108, v12, v86
    v_fmac_f32 v109, v13, v86
    v_lshlrev_b32 v12, 16, v43
    v_and_b32 v13, 0xffff0000, v43
    v_fmac_f32 v102, v12, v82
    v_fmac_f32 v103, v13, v82
    v_fmac_f32 v110, v12, v86
    v_fmac_f32 v111, v13, v86
    v_lshlrev_b32 v12, 16, v44
    v_and_b32 v13, 0xffff0000, v44
    v_fmac_f32 v96, v12, v83
    v_fmac_f32 v97, v13, v83
    v_fmac_f32 v104, v12, v87
    v_fmac_f32 v105, v13, v87
    v_lshlrev_b32 v12, 16, v45
    v_and_b32 v13, 0xffff0000, v45
    v_fmac_f32 v98, v12, v83
    v_fmac_f32 v99, v13, v83
    v_fmac_f32 v106, v12, v87
    v_fmac_f32 v107, v13, v87
    v_lshlrev_b32 v12, 16, v46
    v_and_b32 v13, 0xffff0000, v46
    v_fmac_f32 v100, v12, v83
    v_fmac_f32 v101, v13, v83
    v_fmac_f32 v108, v12, v87
    v_fmac_f32 v109, v13, v87
    v_lshlrev_b32 v12, 16, v47
    v_and_b32 v13, 0xffff0000, v47
    v_fmac_f32 v102, v12, v83
    v_fmac_f32 v103, v13, v83
    v_fmac_f32 v110, v12, v87
    v_fmac_f32 v111, v13, v87
    v_lshlrev_b32 v12, 16, v48
    v_and_b32 v13, 0xffff0000, v48
    v_fmac_f32 v112, v12, v80
    v_fmac_f32 v113, v13, v80
    v_fmac_f32 v120, v12, v84
    v_fmac_f32 v121, v13, v84
    v_lshlrev_b32 v12, 16, v49
    v_and_b32 v13, 0xffff0000, v49
    v_fmac_f32 v114, v12, v80
    v_fmac_f32 v115, v13, v80
    v_fmac_f32 v122, v12, v84
    v_fmac_f32 v123, v13, v84
    v_lshlrev_b32 v12, 16, v50
    v_and_b32 v13, 0xffff0000, v50
    v_fmac_f32 v116, v12, v80
    v_fmac_f32 v117, v13, v80
    v_fmac_f32 v124, v12, v84
    v_fmac_f32 v125, v13, v84
    v_lshlrev_b32 v12, 16, v51
    v_and_b32 v13, 0xffff0000, v51
    v_fmac_f32 v118, v12, v80
    v_fmac_f32 v119, v13, v80
    v_fmac_f32 v126, v12, v84
    v_fmac_f32 v127, v13, v84
    v_lshlrev_b32 v12, 16, v52
    v_and_b32 v13, 0xffff0000, v52
    v_fmac_f32 v112, v12, v81
    v_fmac_f32 v113, v13, v81
    v_fmac_f32 v120, v12, v85
    v_fmac_f32 v121, v13, v85
    v_lshlrev_b32 v12, 16, v53
    v_and_b32 v13, 0xffff0000, v53
    v_fmac_f32 v114, v12, v81
    v_fmac_f32 v115, v13, v81
    v_fmac_f32 v122, v12, v85
    v_fmac_f32 v123, v13, v85
    v_lshlrev_b32 v12, 16, v54
    v_and_b32 v13, 0xffff0000, v54
    v_fmac_f32 v116, v12, v81
    v_fmac_f32 v117, v13, v81
    v_fmac_f32 v124, v12, v85
    v_fmac_f32 v125, v13, v85
    v_lshlrev_b32 v12, 16, v55
    v_and_b32 v13, 0xffff0000, v55
    v_fmac_f32 v118, v12, v81
    v_fmac_f32 v119, v13, v81
    v_fmac_f32 v126, v12, v85
    v_fmac_f32 v127, v13, v85
    v_lshlrev_b32 v12, 16, v56
    v_and_b32 v13, 0xffff0000, v56
    v_fmac_f32 v112, v12, v82
    v_fmac_f32 v113, v13, v82
    v_fmac_f32 v120, v12, v86
    v_fmac_f32 v121, v13, v86
    v_lshlrev_b32 v12, 16, v57
    v_and_b32 v13, 0xffff0000, v57
    v_fmac_f32 v114, v12, v82
    v_fmac_f32 v115, v13, v82
    v_fmac_f32 v122, v12, v86
    v_fmac_f32 v123, v13, v86
    v_lshlrev_b32 v12, 16, v58
    v_and_b32 v13, 0xffff0000, v58
    v_fmac_f32 v116, v12, v82
    v_fmac_f32 v117, v13, v82
    v_fmac_f32 v124, v12, v86
    v_fmac_f32 v125, v13, v86
    v_lshlrev_b32 v12, 16, v59
    v_and_b32 v13, 0xffff0000, v59
    v_fmac_f32 v118, v12, v82
    v_fmac_f32 v119, v13, v82
    v_fmac_f32 v126, v12, v86
    v_fmac_f32 v127, v13, v86
    v_lshlrev_b32 v12, 16, v60
    v_and_b32 v13, 0xffff0000, v60
    v_fmac_f32 v112, v12, v83
    v_fmac_f32 v113, v13, v83
    v_fmac_f32 v120, v12, v87
    v_fmac_f32 v121, v13, v87
    v_lshlrev_b32 v12, 16, v61
    v_and_b32 v13, 0xffff0000, v61
    v_fmac_f32 v114, v12, v83
    v_fmac_f32 v115, v13, v83
    v_fmac_f32 v122, v12, v87
    v_fmac_f32 v123, v13, v87
    v_lshlrev_b32 v12, 16, v62
    v_and_b32 v13, 0xffff0000, v62
    v_fmac_f32 v116, v12, v83
    v_fmac_f32 v117, v13, v83
    v_fmac_f32 v124, v12, v87
    v_fmac_f32 v125, v13, v87
    v_lshlrev_b32 v12, 16, v63
    v_and_b32 v13, 0xffff0000, v63
    v_fmac_f32 v118, v12, v83
    v_fmac_f32 v119, v13, v83
    v_fmac_f32 v126, v12, v87
    v_fmac_f32 v127, v13, v87
    v_lshrrev_b32 v2, 5, v0
    v_lshlrev_b32 v2, 12, v2
    v_and_b32 v3, 31, v0
    v_lshl_add_u32 v2, v3, 5, v2
    ds_write_b128 v2, v[96:99] offset:4096
    ds_write_b128 v2, v[100:103] offset:4112
    ds_write_b128 v2, v[104:107] offset:5120
    ds_write_b128 v2, v[108:111] offset:5136
    ds_write_b128 v2, v[112:115] offset:6144
    ds_write_b128 v2, v[116:119] offset:6160
    ds_write_b128 v2, v[120:123] offset:7168
    ds_write_b128 v2, v[124:127] offset:7184
    s_waitcnt lgkmcnt(0)
    s_barrier
    v_lshlrev_b32 v2, 2, v0
    ds_read_b32 v32, v2 offset:4096
    ds_read_b32 v33, v2 offset:8192
    ds_read_b32 v34, v2 offset:12288
    ds_read_b32 v35, v2 offset:16384
    ds_read_b32 v36, v2 offset:20480
    ds_read_b32 v37, v2 offset:24576
    ds_read_b32 v38, v2 offset:28672
    ds_read_b32 v39, v2 offset:32768
    ds_read_b32 v40, v2 offset:5120
    ds_read_b32 v41, v2 offset:9216
    ds_read_b32 v42, v2 offset:13312
    ds_read_b32 v43, v2 offset:17408
    ds_read_b32 v44, v2 offset:21504
    ds_read_b32 v45, v2 offset:25600
    ds_read_b32 v46, v2 offset:29696
    ds_read_b32 v47, v2 offset:33792
    ds_read_b32 v48, v2 offset:6144
    ds_read_b32 v49, v2 offset:10240
    ds_read_b32 v50, v2 offset:14336
    ds_read_b32 v51, v2 offset:18432
    ds_read_b32 v52, v2 offset:22528
    ds_read_b32 v53, v2 offset:26624
    ds_read_b32 v54, v2 offset:30720
    ds_read_b32 v55, v2 offset:34816
    ds_read_b32 v56, v2 offset:7168
    ds_read_b32 v57, v2 offset:11264
    ds_read_b32 v58, v2 offset:15360
    ds_read_b32 v59, v2 offset:19456
    ds_read_b32 v60, v2 offset:23552
    ds_read_b32 v61, v2 offset:27648
    ds_read_b32 v62, v2 offset:31744
    ds_read_b32 v63, v2 offset:35840
    s_waitcnt lgkmcnt(0)
    v_add_f32 v32, v32, v33
    v_add_f32 v32, v32, v34
    v_add_f32 v32, v32, v35
    v_add_f32 v32, v32, v36
    v_add_f32 v32, v32, v37
    v_add_f32 v32, v32, v38
    v_add_f32 v32, v32, v39
    v_add_f32 v40, v40, v41
    v_add_f32 v40, v40, v42
    v_add_f32 v40, v40, v43
    v_add_f32 v40, v40, v44
    v_add_f32 v40, v40, v45
    v_add_f32 v40, v40, v46
    v_add_f32 v40, v40, v47
    v_add_f32 v48, v48, v49
    v_add_f32 v48, v48, v50
    v_add_f32 v48, v48, v51
    v_add_f32 v48, v48, v52
    v_add_f32 v48, v48, v53
    v_add_f32 v48, v48, v54
    v_add_f32 v48, v48, v55
    v_add_f32 v56, v56, v57
    v_add_f32 v56, v56, v58
    v_add_f32 v56, v56, v59
    v_add_f32 v56, v56, v60
    v_add_f32 v56, v56, v61
    v_add_f32 v56, v56, v62
    v_add_f32 v56, v56, v63
    s_lshl_b32 s23, s21, 10
    s_add_u32 s24, s23, 73728
    buffer_atomic_add_f32 v32, v2, s[12:15], s24 offen
    s_add_u32 s24, s23, 80896
    buffer_atomic_add_f32 v40, v2, s[12:15], s24 offen
    s_add_u32 s24, s23, 88064
    buffer_atomic_add_f32 v48, v2, s[12:15], s24 offen
    s_add_u32 s24, s23, 95232
    buffer_atomic_add_f32 v56, v2, s[12:15], s24 offen
k4_gu_kernel_end:
    s_endpgm
.globl k5_dn_kernel
.p2align 8
.type k5_dn_kernel,@function
k5_dn_kernel:
    s_cmp_ge_u32 s2, 56
    s_cbranch_scc1 k5_dn_kernel_end
    s_load_dwordx2 s[8:9], s[0:1], 64
    s_load_dwordx2 s[12:13], s[0:1], 104
    s_load_dwordx2 s[16:17], s[0:1], 88
    s_load_dwordx2 s[4:5], s[0:1], 96
    s_waitcnt lgkmcnt(0)
    s_mov_b32 s10, 1835008
    s_mov_b32 s11, 0x00020000
    s_mov_b32 s14, 536870912
    s_mov_b32 s15, 0x00020000
    s_mov_b32 s18, 2048
    s_mov_b32 s19, 0x00020000
    s_mov_b32 s6, 256
    s_mov_b32 s7, 0x00020000
    v_lshrrev_b32 v1, 6, v0
    v_lshlrev_b32 v1, 13, v1
    v_and_b32 v2, 63, v0
    v_lshl_add_u32 v1, v2, 4, v1
    s_lshl_b32 s20, s2, 15
    s_add_u32 s21, s20, 4096
    buffer_load_dwordx4 v[32:35], v1, s[8:11], s20 offen offset:0
    buffer_load_dwordx4 v[36:39], v1, s[8:11], s20 offen offset:1024
    buffer_load_dwordx4 v[40:43], v1, s[8:11], s20 offen offset:2048
    buffer_load_dwordx4 v[44:47], v1, s[8:11], s20 offen offset:3072
    buffer_load_dwordx4 v[48:51], v1, s[8:11], s21 offen offset:0
    buffer_load_dwordx4 v[52:55], v1, s[8:11], s21 offen offset:1024
    buffer_load_dwordx4 v[56:59], v1, s[8:11], s21 offen offset:2048
    buffer_load_dwordx4 v[60:63], v1, s[8:11], s21 offen offset:3072
    v_lshrrev_b32 v3, 5, v0
    v_mul_u32_u24 v3, 7168, v3
    v_and_b32 v4, 31, v0
    v_lshl_add_u32 v3, v4, 2, v3
    s_lshl_b32 s22, s2, 7
    s_add_u32 s23, s22, 88064
    s_add_u32 s22, s22, 73728
    v_cmp_gt_u32 vcc, 64, v0
    s_and_saveexec_b64 s[24:25], vcc
    buffer_load_dword v5, v3, s[12:15], s22 offen
    buffer_load_dword v6, v3, s[12:15], s23 offen
    s_waitcnt vmcnt(0)
    v_cvt_pk_bf16_f32 v5, v5, v5
    v_lshlrev_b32 v5, 16, v5
    v_cvt_pk_bf16_f32 v6, v6, v6
    v_lshlrev_b32 v6, 16, v6
    v_mul_f32 v5, v5, v6
    v_cvt_pk_bf16_f32 v5, v5, v5
    v_lshlrev_b32 v5, 16, v5
    v_lshlrev_b32 v4, 2, v0
    ds_write_b32 v4, v5
    s_mov_b64 exec, s[24:25]
    s_waitcnt lgkmcnt(0)
    s_barrier
    v_lshrrev_b32 v10, 6, v0
    v_lshlrev_b32 v10, 5, v10
    ds_read_b32 v80, v10 offset:0
    ds_read_b32 v81, v10 offset:4
    ds_read_b32 v82, v10 offset:8
    ds_read_b32 v83, v10 offset:12
    ds_read_b32 v84, v10 offset:16
    ds_read_b32 v85, v10 offset:20
    ds_read_b32 v86, v10 offset:24
    ds_read_b32 v87, v10 offset:28
    ds_read_b32 v88, v10 offset:128
    ds_read_b32 v89, v10 offset:132
    ds_read_b32 v90, v10 offset:136
    ds_read_b32 v91, v10 offset:140
    ds_read_b32 v92, v10 offset:144
    ds_read_b32 v93, v10 offset:148
    ds_read_b32 v94, v10 offset:152
    ds_read_b32 v95, v10 offset:156
    v_mov_b32 v96, 0
    v_mov_b32 v97, 0
    v_mov_b32 v98, 0
    v_mov_b32 v99, 0
    v_mov_b32 v100, 0
    v_mov_b32 v101, 0
    v_mov_b32 v102, 0
    v_mov_b32 v103, 0
    v_mov_b32 v104, 0
    v_mov_b32 v105, 0
    v_mov_b32 v106, 0
    v_mov_b32 v107, 0
    v_mov_b32 v108, 0
    v_mov_b32 v109, 0
    v_mov_b32 v110, 0
    v_mov_b32 v111, 0
    s_waitcnt vmcnt(0) lgkmcnt(0)
    v_lshlrev_b32 v12, 16, v32
    v_and_b32 v13, 0xffff0000, v32
    v_fmac_f32 v96, v12, v80
    v_fmac_f32 v97, v13, v80
    v_fmac_f32 v104, v12, v88
    v_fmac_f32 v105, v13, v88
    v_lshlrev_b32 v12, 16, v33
    v_and_b32 v13, 0xffff0000, v33
    v_fmac_f32 v98, v12, v80
    v_fmac_f32 v99, v13, v80
    v_fmac_f32 v106, v12, v88
    v_fmac_f32 v107, v13, v88
    v_lshlrev_b32 v12, 16, v34
    v_and_b32 v13, 0xffff0000, v34
    v_fmac_f32 v100, v12, v80
    v_fmac_f32 v101, v13, v80
    v_fmac_f32 v108, v12, v88
    v_fmac_f32 v109, v13, v88
    v_lshlrev_b32 v12, 16, v35
    v_and_b32 v13, 0xffff0000, v35
    v_fmac_f32 v102, v12, v80
    v_fmac_f32 v103, v13, v80
    v_fmac_f32 v110, v12, v88
    v_fmac_f32 v111, v13, v88
    v_lshlrev_b32 v12, 16, v36
    v_and_b32 v13, 0xffff0000, v36
    v_fmac_f32 v96, v12, v81
    v_fmac_f32 v97, v13, v81
    v_fmac_f32 v104, v12, v89
    v_fmac_f32 v105, v13, v89
    v_lshlrev_b32 v12, 16, v37
    v_and_b32 v13, 0xffff0000, v37
    v_fmac_f32 v98, v12, v81
    v_fmac_f32 v99, v13, v81
    v_fmac_f32 v106, v12, v89
    v_fmac_f32 v107, v13, v89
    v_lshlrev_b32 v12, 16, v38
    v_and_b32 v13, 0xffff0000, v38
    v_fmac_f32 v100, v12, v81
    v_fmac_f32 v101, v13, v81
    v_fmac_f32 v108, v12, v89
    v_fmac_f32 v109, v13, v89
    v_lshlrev_b32 v12, 16, v39
    v_and_b32 v13, 0xffff0000, v39
    v_fmac_f32 v102, v12, v81
    v_fmac_f32 v103, v13, v81
    v_fmac_f32 v110, v12, v89
    v_fmac_f32 v111, v13, v89
    v_lshlrev_b32 v12, 16, v40
    v_and_b32 v13, 0xffff0000, v40
    v_fmac_f32 v96, v12, v82
    v_fmac_f32 v97, v13, v82
    v_fmac_f32 v104, v12, v90
    v_fmac_f32 v105, v13, v90
    v_lshlrev_b32 v12, 16, v41
    v_and_b32 v13, 0xffff0000, v41
    v_fmac_f32 v98, v12, v82
    v_fmac_f32 v99, v13, v82
    v_fmac_f32 v106, v12, v90
    v_fmac_f32 v107, v13, v90
    v_lshlrev_b32 v12, 16, v42
    v_and_b32 v13, 0xffff0000, v42
    v_fmac_f32 v100, v12, v82
    v_fmac_f32 v101, v13, v82
    v_fmac_f32 v108, v12, v90
    v_fmac_f32 v109, v13, v90
    v_lshlrev_b32 v12, 16, v43
    v_and_b32 v13, 0xffff0000, v43
    v_fmac_f32 v102, v12, v82
    v_fmac_f32 v103, v13, v82
    v_fmac_f32 v110, v12, v90
    v_fmac_f32 v111, v13, v90
    v_lshlrev_b32 v12, 16, v44
    v_and_b32 v13, 0xffff0000, v44
    v_fmac_f32 v96, v12, v83
    v_fmac_f32 v97, v13, v83
    v_fmac_f32 v104, v12, v91
    v_fmac_f32 v105, v13, v91
    v_lshlrev_b32 v12, 16, v45
    v_and_b32 v13, 0xffff0000, v45
    v_fmac_f32 v98, v12, v83
    v_fmac_f32 v99, v13, v83
    v_fmac_f32 v106, v12, v91
    v_fmac_f32 v107, v13, v91
    v_lshlrev_b32 v12, 16, v46
    v_and_b32 v13, 0xffff0000, v46
    v_fmac_f32 v100, v12, v83
    v_fmac_f32 v101, v13, v83
    v_fmac_f32 v108, v12, v91
    v_fmac_f32 v109, v13, v91
    v_lshlrev_b32 v12, 16, v47
    v_and_b32 v13, 0xffff0000, v47
    v_fmac_f32 v102, v12, v83
    v_fmac_f32 v103, v13, v83
    v_fmac_f32 v110, v12, v91
    v_fmac_f32 v111, v13, v91
    v_lshlrev_b32 v12, 16, v48
    v_and_b32 v13, 0xffff0000, v48
    v_fmac_f32 v96, v12, v84
    v_fmac_f32 v97, v13, v84
    v_fmac_f32 v104, v12, v92
    v_fmac_f32 v105, v13, v92
    v_lshlrev_b32 v12, 16, v49
    v_and_b32 v13, 0xffff0000, v49
    v_fmac_f32 v98, v12, v84
    v_fmac_f32 v99, v13, v84
    v_fmac_f32 v106, v12, v92
    v_fmac_f32 v107, v13, v92
    v_lshlrev_b32 v12, 16, v50
    v_and_b32 v13, 0xffff0000, v50
    v_fmac_f32 v100, v12, v84
    v_fmac_f32 v101, v13, v84
    v_fmac_f32 v108, v12, v92
    v_fmac_f32 v109, v13, v92
    v_lshlrev_b32 v12, 16, v51
    v_and_b32 v13, 0xffff0000, v51
    v_fmac_f32 v102, v12, v84
    v_fmac_f32 v103, v13, v84
    v_fmac_f32 v110, v12, v92
    v_fmac_f32 v111, v13, v92
    v_lshlrev_b32 v12, 16, v52
    v_and_b32 v13, 0xffff0000, v52
    v_fmac_f32 v96, v12, v85
    v_fmac_f32 v97, v13, v85
    v_fmac_f32 v104, v12, v93
    v_fmac_f32 v105, v13, v93
    v_lshlrev_b32 v12, 16, v53
    v_and_b32 v13, 0xffff0000, v53
    v_fmac_f32 v98, v12, v85
    v_fmac_f32 v99, v13, v85
    v_fmac_f32 v106, v12, v93
    v_fmac_f32 v107, v13, v93
    v_lshlrev_b32 v12, 16, v54
    v_and_b32 v13, 0xffff0000, v54
    v_fmac_f32 v100, v12, v85
    v_fmac_f32 v101, v13, v85
    v_fmac_f32 v108, v12, v93
    v_fmac_f32 v109, v13, v93
    v_lshlrev_b32 v12, 16, v55
    v_and_b32 v13, 0xffff0000, v55
    v_fmac_f32 v102, v12, v85
    v_fmac_f32 v103, v13, v85
    v_fmac_f32 v110, v12, v93
    v_fmac_f32 v111, v13, v93
    v_lshlrev_b32 v12, 16, v56
    v_and_b32 v13, 0xffff0000, v56
    v_fmac_f32 v96, v12, v86
    v_fmac_f32 v97, v13, v86
    v_fmac_f32 v104, v12, v94
    v_fmac_f32 v105, v13, v94
    v_lshlrev_b32 v12, 16, v57
    v_and_b32 v13, 0xffff0000, v57
    v_fmac_f32 v98, v12, v86
    v_fmac_f32 v99, v13, v86
    v_fmac_f32 v106, v12, v94
    v_fmac_f32 v107, v13, v94
    v_lshlrev_b32 v12, 16, v58
    v_and_b32 v13, 0xffff0000, v58
    v_fmac_f32 v100, v12, v86
    v_fmac_f32 v101, v13, v86
    v_fmac_f32 v108, v12, v94
    v_fmac_f32 v109, v13, v94
    v_lshlrev_b32 v12, 16, v59
    v_and_b32 v13, 0xffff0000, v59
    v_fmac_f32 v102, v12, v86
    v_fmac_f32 v103, v13, v86
    v_fmac_f32 v110, v12, v94
    v_fmac_f32 v111, v13, v94
    v_lshlrev_b32 v12, 16, v60
    v_and_b32 v13, 0xffff0000, v60
    v_fmac_f32 v96, v12, v87
    v_fmac_f32 v97, v13, v87
    v_fmac_f32 v104, v12, v95
    v_fmac_f32 v105, v13, v95
    v_lshlrev_b32 v12, 16, v61
    v_and_b32 v13, 0xffff0000, v61
    v_fmac_f32 v98, v12, v87
    v_fmac_f32 v99, v13, v87
    v_fmac_f32 v106, v12, v95
    v_fmac_f32 v107, v13, v95
    v_lshlrev_b32 v12, 16, v62
    v_and_b32 v13, 0xffff0000, v62
    v_fmac_f32 v100, v12, v87
    v_fmac_f32 v101, v13, v87
    v_fmac_f32 v108, v12, v95
    v_fmac_f32 v109, v13, v95
    v_lshlrev_b32 v12, 16, v63
    v_and_b32 v13, 0xffff0000, v63
    v_fmac_f32 v102, v12, v87
    v_fmac_f32 v103, v13, v87
    v_fmac_f32 v110, v12, v95
    v_fmac_f32 v111, v13, v95
    v_lshrrev_b32 v10, 6, v0
    v_lshlrev_b32 v10, 12, v10
    v_lshl_add_u32 v10, v2, 5, v10
    ds_write_b128 v10, v[96:99] offset:4096
    ds_write_b128 v10, v[100:103] offset:4112
    ds_write_b128 v10, v[104:107] offset:6144
    ds_write_b128 v10, v[108:111] offset:6160
    s_waitcnt lgkmcnt(0)
    s_barrier
    v_lshlrev_b32 v10, 2, v0
    ds_read_b32 v32, v10 offset:4096
    ds_read_b32 v33, v10 offset:8192
    ds_read_b32 v34, v10 offset:12288
    ds_read_b32 v35, v10 offset:16384
    ds_read_b32 v36, v10 offset:5120
    ds_read_b32 v37, v10 offset:9216
    ds_read_b32 v38, v10 offset:13312
    ds_read_b32 v39, v10 offset:17408
    ds_read_b32 v40, v10 offset:6144
    ds_read_b32 v41, v10 offset:10240
    ds_read_b32 v42, v10 offset:14336
    ds_read_b32 v43, v10 offset:18432
    ds_read_b32 v44, v10 offset:7168
    ds_read_b32 v45, v10 offset:11264
    ds_read_b32 v46, v10 offset:15360
    ds_read_b32 v47, v10 offset:19456
    s_waitcnt lgkmcnt(0)
    v_add_f32 v32, v32, v33
    v_add_f32 v32, v32, v34
    v_add_f32 v32, v32, v35
    v_add_f32 v36, v36, v37
    v_add_f32 v36, v36, v38
    v_add_f32 v36, v36, v39
    v_add_f32 v40, v40, v41
    v_add_f32 v40, v40, v42
    v_add_f32 v40, v40, v43
    v_add_f32 v44, v44, v45
    v_add_f32 v44, v44, v46
    v_add_f32 v44, v44, v47
    s_mov_b32 s20, 69632
    buffer_atomic_add_f32 v32, v10, s[12:15], s20 offen
    s_mov_b32 s20, 70656
    buffer_atomic_add_f32 v36, v10, s[12:15], s20 offen
    s_mov_b32 s20, 71680
    buffer_atomic_add_f32 v40, v10, s[12:15], s20 offen
    s_mov_b32 s20, 72704
    buffer_atomic_add_f32 v44, v10, s[12:15], s20 offen
    s_waitcnt vmcnt(0)
    s_barrier
    v_mov_b32 v11, 1
    v_mov_b32 v12, 0
    v_cmp_eq_u32 vcc, 0, v0
    s_and_saveexec_b64 s[24:25], vcc
    buffer_atomic_add v11, v12, s[4:7], 0 offen sc0
    s_waitcnt vmcnt(0)
    v_lshlrev_b32 v13, 0, v11
    ds_write_b32 v12, v13
    s_mov_b64 exec, s[24:25]
    s_waitcnt lgkmcnt(0)
    s_barrier
    ds_read_b32 v13, v12
    s_waitcnt lgkmcnt(0)
    s_nop 0
    v_readfirstlane_b32 s26, v13
    s_cmp_lg_u32 s26, 55
    s_cbranch_scc1 k5_dn_kernel_end
    v_lshlrev_b32 v2, 4, v0
    s_mov_b32 s20, 69632
    buffer_load_dwordx4 v[24:27], v2, s[12:15], s20 offen sc1
    s_mov_b32 s20, 49152
    buffer_load_dwordx4 v[8:11], v2, s[12:15], s20 offen
    v_lshrrev_b32 v3, 7, v0
    v_mul_u32_u24 v3, 12288, v3
    v_and_b32 v6, 127, v0
    v_lshl_add_u32 v3, v6, 4, v3
    s_mov_b32 s21, 10240
    buffer_load_dwordx4 v[28:31], v3, s[12:15], s21 offen
    s_waitcnt vmcnt(0)
    v_cvt_pk_bf16_f32 v24, v24, v24
    v_lshlrev_b32 v24, 16, v24
    v_mul_f32 v24, v24, v28
    v_cvt_pk_bf16_f32 v24, v24, v24
    v_lshlrev_b32 v24, 16, v24
    v_add_f32 v8, v8, v24
    v_cvt_pk_bf16_f32 v25, v25, v25
    v_lshlrev_b32 v25, 16, v25
    v_mul_f32 v25, v25, v29
    v_cvt_pk_bf16_f32 v25, v25, v25
    v_lshlrev_b32 v25, 16, v25
    v_add_f32 v9, v9, v25
    v_cvt_pk_bf16_f32 v26, v26, v26
    v_lshlrev_b32 v26, 16, v26
    v_mul_f32 v26, v26, v30
    v_cvt_pk_bf16_f32 v26, v26, v26
    v_lshlrev_b32 v26, 16, v26
    v_add_f32 v10, v10, v26
    v_cvt_pk_bf16_f32 v27, v27, v27
    v_lshlrev_b32 v27, 16, v27
    v_mul_f32 v27, v27, v31
    v_cvt_pk_bf16_f32 v27, v27, v27
    v_lshlrev_b32 v27, 16, v27
    v_add_f32 v11, v11, v27
    v_cvt_pk_bf16_f32 v8, v8, v9
    v_cvt_pk_bf16_f32 v9, v10, v11
    v_lshlrev_b32 v2, 3, v0
    buffer_store_dwordx2 v[8:9], v2, s[16:19], 0 offen
k5_dn_kernel_end:
    s_endpgm
.section .rodata,"a"
.p2align 6
.amdhsa_kernel k0_mod_kernel
  .amdhsa_next_free_vgpr 96
  .amdhsa_next_free_sgpr 96
  .amdhsa_accum_offset 96
  .amdhsa_group_segment_fixed_size 0
  .amdhsa_kernarg_size 112
  .amdhsa_user_sgpr_count 2
  .amdhsa_user_sgpr_kernarg_segment_ptr 1
  .amdhsa_system_sgpr_workgroup_id_x 1
.end_amdhsa_kernel
.p2align 6
.amdhsa_kernel k1_q_kernel
  .amdhsa_next_free_vgpr 96
  .amdhsa_next_free_sgpr 96
  .amdhsa_accum_offset 96
  .amdhsa_group_segment_fixed_size 0
  .amdhsa_kernarg_size 112
  .amdhsa_user_sgpr_count 2
  .amdhsa_user_sgpr_kernarg_segment_ptr 1
  .amdhsa_system_sgpr_workgroup_id_x 1
.end_amdhsa_kernel
.p2align 6
.amdhsa_kernel k2_attn_kernel
  .amdhsa_next_free_vgpr 208
  .amdhsa_next_free_sgpr 96
  .amdhsa_accum_offset 208
  .amdhsa_group_segment_fixed_size 0
  .amdhsa_kernarg_size 112
  .amdhsa_user_sgpr_count 2
  .amdhsa_user_sgpr_kernarg_segment_ptr 1
  .amdhsa_system_sgpr_workgroup_id_x 1
.end_amdhsa_kernel
.p2align 6
.amdhsa_kernel k3_wo_kernel
  .amdhsa_next_free_vgpr 176
  .amdhsa_next_free_sgpr 96
  .amdhsa_accum_offset 176
  .amdhsa_group_segment_fixed_size 0
  .amdhsa_kernarg_size 112
  .amdhsa_user_sgpr_count 2
  .amdhsa_user_sgpr_kernarg_segment_ptr 1
  .amdhsa_system_sgpr_workgroup_id_x 1
.end_amdhsa_kernel
.p2align 6
.amdhsa_kernel k4_gu_kernel
  .amdhsa_next_free_vgpr 128
  .amdhsa_next_free_sgpr 96
  .amdhsa_accum_offset 128
  .amdhsa_group_segment_fixed_size 0
  .amdhsa_kernarg_size 112
  .amdhsa_user_sgpr_count 2
  .amdhsa_user_sgpr_kernarg_segment_ptr 1
  .amdhsa_system_sgpr_workgroup_id_x 1
.end_amdhsa_kernel
.p2align 6
.amdhsa_kernel k5_dn_kernel
  .amdhsa_next_free_vgpr 112
  .amdhsa_next_free_sgpr 96
  .amdhsa_accum_offset 112
  .amdhsa_group_segment_fixed_size 0
  .amdhsa_kernarg_size 112
  .amdhsa_user_sgpr_count 2
  .amdhsa_user_sgpr_kernarg_segment_ptr 1
  .amdhsa_system_sgpr_workgroup_id_x 1
.end_amdhsa_kernel
```
